```python
import torch

def _softmax(x, axis=-1):
    return torch.softmax(x, dim=axis)
def _gelu(x):
    return torch.nn.functional.gelu(x, approximate="tanh")
def _silu(x):
    return torch.nn.functional.silu(x)
def _sigmoid(x):
    return torch.sigmoid(x)
def _layernorm(x, axis=-1, eps=1e-5):
    m = x.mean(dim=axis, keepdim=True)
    v = x.var(dim=axis, keepdim=True, unbiased=False)
    return (x - m) / torch.sqrt(v + eps)
def _scatter_add(tgt, idx, src, axis=0):
    return tgt.clone().index_add_(axis, idx, src)
def _segment_sum(src, seg, n):
    out = torch.zeros((n,) + src.shape[1:], dtype=src.dtype)
    return out.index_add_(0, seg, src)
def _pad(x, pw):
    flat = tuple(v for pair in reversed(pw) for v in pair)
    return torch.nn.functional.pad(x, flat)

kernel_name = 'standalone__gqa_block_cached__near_ridge'

def setup_inputs():

    _w = (lambda a: (lambda t: t.to(torch.bfloat16) if t.is_floating_point() else t)(torch.as_tensor(a)))
    B, Sq, D = 8, 192, 640
    Hq, Hkv, Sk, Dh = 32, 32, 512, 192
    assert Hq % Hkv == 0, (Hq, Hkv)
    return {
        "x": _w((lambda *s: torch.randn(*s, dtype=torch.bfloat16) * 0.8)(B, Sq, D)),
        "k_cache": _w((lambda *s: torch.randn(*s, dtype=torch.bfloat16) * 0.8)(B, Hkv, Sk, Dh)),
        "v_cache": _w((lambda *s: torch.randn(*s, dtype=torch.bfloat16) * 0.05)(B, Hkv, Sk, Dh)),
        "wq": _w((lambda *s: torch.randn(*s, dtype=torch.bfloat16) * 0.8)(D, Hq * Dh) * (D ** -0.5)),
        "wo": _w((lambda *s: torch.randn(*s, dtype=torch.bfloat16) * 0.05)(Hq * Dh, D) * ((Hq * Dh) ** -0.5)),
    }

def reference(x, k_cache, v_cache, wq, wo):
    B, Sq, D = x.shape
    Hq, Dh = 32, 192
    Hkv = k_cache.shape[1]
    rep = Hq // Hkv
    q = (lambda x, *d: x.permute(*d))((x @ wq).reshape(B, Sq, Hq, Dh), 0, 2, 1, 3)
    k = (lambda x, n, axis: torch.repeat_interleave(x, n, dim=axis))(k_cache, rep, axis=1)
    v = (lambda x, n, axis: torch.repeat_interleave(x, n, dim=axis))(v_cache, rep, axis=1)
    scores = torch.einsum("bhqd,bhkd->bhqk", q, k) * (Dh ** -0.5)
    p = _softmax(scores, axis=-1)
    o = torch.einsum("bhqk,bhkd->bhqd", p, v)
    return (lambda x, *d: x.permute(*d))(o, 0, 2, 1, 3).reshape(B, Sq, Hq * Dh) @ wo
```

```asm
; @launch grid=(256,1,1) block=(256,1,1) lds=163840
.amdgcn_target "amdgcn-amd-amdhsa--gfx950"
.text
.globl standalone__gqa_block_cached__near_ridge_kernel
.p2align 8
.type standalone__gqa_block_cached__near_ridge_kernel,@function
standalone__gqa_block_cached__near_ridge_kernel:
    s_load_dwordx16 s[40:55], s[0:1], 0
    s_getpc_b64 s[56:57]
L_PCBASE:
    s_cmp_ge_u32 s2, 256
    s_cbranch_scc1 L_END
    v_and_b32 v1, 63, v0
    v_lshrrev_b32 v2, 6, v0
    s_nop 0
    v_readfirstlane_b32 s24, v2
    s_and_b32 s28, s2, 7
    s_lshr_b32 s27, s2, 3
    s_and_b32 s27, s27, 3
    s_lshl_b32 s26, s28, 2
    s_add_u32 s26, s26, s27
    s_lshr_b32 s25, s2, 5
    s_mov_b32 s29, 0
    s_lshl_b32 s33, s29, 7
    s_mul_i32 s32, s29, 786432
    s_lshl_b32 s31, s24, 3
    v_lshrrev_b32 v29, 3, v1
    v_and_b32 v30, 2, v29
    v_lshlrev_b32 v30, 1, v30
    v_and_b32 v31, 7, v1
    v_xor_b32 v30, v30, v31
    v_add_u32 v29, s31, v29
    v_mul_u32_u24 v29, 0x3000, v29
    v_lshl_add_u32 v64, v30, 4, v29
    v_add_u32 v65, 128, v64
    v_add_u32 v66, 256, v64
    s_mul_i32 s99, s24, 3080
    s_mul_i32 s29, s24, 61440
    v_lshrrev_b32 v29, 3, v1
    v_lshrrev_b32 v30, 1, v29
    v_and_b32 v31, 7, v1
    v_xor_b32 v30, v30, v31
    v_lshlrev_b32 v30, 4, v30
    v_mul_u32_u24 v29, 0x500, v29
    v_add_u32 v29, s29, v29
    v_xor_b32 v31, 64, v30
    v_add_u32 v68, v29, v30
    v_add_u32 v69, v29, v31
    v_add_u32 v69, 9216, v69
    v_add_u32 v70, v29, v30
    v_add_u32 v70, 18432, v70
    v_add_u32 v71, v29, v31
    v_add_u32 v71, 30720, v71
    v_add_u32 v72, v29, v30
    v_add_u32 v72, 39936, v72
    v_add_u32 v73, v29, v31
    v_add_u32 v73, 49152, v73
    s_mul_i32 s58, s24, 6144
    s_mul_i32 s34, s24, 3072
    s_mul_i32 s29, s25, 245760
    s_waitcnt lgkmcnt(0)
    s_add_u32 s4, s40, s29
    s_addc_u32 s5, s41, 0
    s_mov_b32 s6, 245760
    s_mov_b32 s7, 0x20000
    s_mul_i32 s29, s26, 384
    s_sub_u32 s30, 7864320, s29
    s_add_u32 s8, s46, s29
    s_addc_u32 s9, s47, 0
    s_mov_b32 s10, s30
    s_mov_b32 s11, 0x20000
    s_add_u32 m0, s99, 147840
    s_nop 0
    buffer_load_dwordx4 v64, s[8:11], s32 offen  lds
    s_add_u32 m0, s99, 148864
    s_nop 0
    buffer_load_dwordx4 v65, s[8:11], s32 offen  lds
    s_add_u32 m0, s99, 149888
    s_nop 0
    buffer_load_dwordx4 v66, s[8:11], s32 offen  lds
    s_add_u32 s32, s32, 393216
    s_cmp_eq_u32 s32, 7864320
    s_cselect_b32 s32, 786432, s32
    s_add_u32 m0, s58, 36960
    s_nop 0
    buffer_load_dwordx4 v68, s[4:7], s33 offen offset:0  lds
    buffer_load_dwordx4 v69, s[4:7], s33 offen offset:1024  lds
    buffer_load_dwordx4 v70, s[4:7], s33 offen offset:2048  lds
    s_add_u32 m0, s58, 40032
    s_nop 0
    buffer_load_dwordx4 v71, s[4:7], s33 offen offset:0  lds
    buffer_load_dwordx4 v72, s[4:7], s33 offen offset:1024  lds
    buffer_load_dwordx4 v73, s[4:7], s33 offen offset:2048  lds
    s_add_u32 s33, s33, 128
    s_cmp_eq_u32 s33, 1280
    s_cselect_b32 s33, 128, s33
    s_add_u32 m0, s99, 86240
    s_nop 0
    buffer_load_dwordx4 v64, s[8:11], s32 offen  lds
    s_add_u32 m0, s99, 87264
    s_nop 0
    buffer_load_dwordx4 v65, s[8:11], s32 offen  lds
    s_add_u32 m0, s99, 88288
    s_nop 0
    buffer_load_dwordx4 v66, s[8:11], s32 offen  lds
    s_add_u32 s32, s32, 393216
    s_cmp_eq_u32 s32, 7864320
    s_cselect_b32 s32, 786432, s32
    s_add_u32 s29, s25, s27
    s_and_b32 s29, s29, 3
    s_mul_i32 s29, s29, 9
    s_add_u32 s29, s29, 6
    s_lshr_b32 s29, s29, 2
    s_lshl_b32 s33, s29, 7
    s_mul_i32 s32, s29, 786432
    s_mov_b32 s30, 2731
    s_and_b32 s29, s24, 1
    s_lshl_b32 s29, s29, 2
    s_lshl_b32 s31, s24, 3
    v_add_u32 v29, 0, v1
    v_mul_lo_u32 v30, v29, s30
    v_lshrrev_b32 v30, 16, v30
    v_mul_u32_u24 v31, 24, v30
    v_sub_u32 v29, v29, v31
    v_lshrrev_b32 v31, 1, v30
    v_xor_b32 v31, v29, v31
    v_xor_b32 v31, s29, v31
    v_mul_u32_u24 v32, 0x180, v30
    v_lshl_add_u32 v20, v31, 4, v32
    v_and_b32 v31, 6, v30
    v_xor_b32 v31, v29, v31
    v_lshl_add_u32 v23, v31, 4, v32
    v_add_u32 v32, s31, v30
    v_mul_u32_u24 v32, 0x500, v32
    v_lshl_add_u32 v33, v31, 4, v32
    v_add_u32 v29, 64, v1
    v_mul_lo_u32 v30, v29, s30
    v_lshrrev_b32 v30, 16, v30
    v_mul_u32_u24 v31, 24, v30
    v_sub_u32 v29, v29, v31
    v_lshrrev_b32 v31, 1, v30
    v_xor_b32 v31, v29, v31
    v_xor_b32 v31, s29, v31
    v_mul_u32_u24 v32, 0x180, v30
    v_lshl_add_u32 v21, v31, 4, v32
    v_subrev_u32 v21, 1024, v21
    v_and_b32 v31, 6, v30
    v_xor_b32 v31, v29, v31
    v_lshl_add_u32 v24, v31, 4, v32
    v_subrev_u32 v24, 1024, v24
    v_add_u32 v32, s31, v30
    v_mul_u32_u24 v32, 0x500, v32
    v_lshl_add_u32 v34, v31, 4, v32
    v_subrev_u32 v34, 1024, v34
    v_add_u32 v29, 128, v1
    v_mul_lo_u32 v30, v29, s30
    v_lshrrev_b32 v30, 16, v30
    v_mul_u32_u24 v31, 24, v30
    v_sub_u32 v29, v29, v31
    v_lshrrev_b32 v31, 1, v30
    v_xor_b32 v31, v29, v31
    v_xor_b32 v31, s29, v31
    v_mul_u32_u24 v32, 0x180, v30
    v_lshl_add_u32 v22, v31, 4, v32
    v_subrev_u32 v22, 2048, v22
    v_and_b32 v31, 6, v30
    v_xor_b32 v31, v29, v31
    v_lshl_add_u32 v25, v31, 4, v32
    v_subrev_u32 v25, 2048, v25
    v_add_u32 v32, s31, v30
    v_mul_u32_u24 v32, 0x500, v32
    v_lshl_add_u32 v35, v31, 4, v32
    v_subrev_u32 v35, 2048, v35
    s_add_u32 s80, s54, 100663296
    s_addc_u32 s81, s55, 0
    s_mov_b32 s82, 131200
    s_mov_b32 s83, 0x20000
    s_lshl_b32 s29, s2, 2
    s_add_u32 s29, s29, s24
    s_lshl_b32 s29, s29, 7
    v_mov_b32 v7, s29
    s_lshl_b32 s29, s25, 2
    s_add_u32 s29, s29, s24
    s_lshl_b32 s29, s29, 12
    s_mul_i32 s30, s25, 33
    s_cmp_lg_u32 s30, s2
    s_cbranch_scc1 L_NOINIT
    v_lshl_add_u32 v29, v1, 7, s29
    v_mov_b32 v40, 0
    v_mov_b32 v41, 0
    v_mov_b32 v42, 0
    v_mov_b32 v43, 0
    s_mov_b32 exec_hi, 0
    buffer_store_dwordx4 v[40:43], v29, s[80:83], 0 offen sc1
    s_mov_b64 exec, -1
L_NOINIT:
    s_lshr_b32 s29, s2, 3
    s_lshl_b32 s29, s29, 2
    s_add_u32 s29, s29, s24
    s_lshl_b32 s29, s29, 7
    v_mov_b32 v0, s29
    s_add_u32 s0, s56, 0
    s_addc_u32 s1, s57, 0
    global_load_dword a252, v0, s[0:1]
    s_lshl_b32 s30, s25, 5
    s_add_u32 s30, s30, s26
    s_mul_i32 s29, s30, 196608
    s_add_u32 s12, s42, s29
    s_addc_u32 s13, s43, 0
    s_mov_b32 s14, 196608
    s_mov_b32 s15, 0x20000
    s_add_u32 s16, s44, s29
    s_addc_u32 s17, s45, 0
    s_mov_b32 s18, 196608
    s_mov_b32 s19, 0x20000
    s_mul_i32 s29, s30, 73728
    s_mul_i32 s31, s24, 18432
    s_add_u32 s29, s29, s31
    s_add_u32 s20, s54, s29
    s_addc_u32 s21, s55, 0
    s_mov_b32 s22, 18432
    s_mov_b32 s23, 0x20000
    s_mul_i32 s30, s27, 73728
    s_sub_u32 s29, s29, s30
    s_add_u32 s64, s54, s29
    s_addc_u32 s65, s55, 0
    s_mov_b32 s66, 239616
    s_mov_b32 s67, 0x20000
    s_mul_i32 s29, s27, 320
    s_and_b32 s29, s29, 0xffffff80
    s_mul_i32 s30, s28, 983040
    s_add_u32 s29, s29, s30
    s_sub_u32 s30, 7864320, s29
    s_add_u32 s60, s48, s29
    s_addc_u32 s61, s49, 0
    s_mov_b32 s62, s30
    s_mov_b32 s63, 0x20000
    s_add_u32 s29, s27, 0
    s_and_b32 s29, s29, 3
    s_mul_i32 s84, s29, 245760
    s_mul_i32 s88, s29, 73728
    s_add_u32 s29, s27, 1
    s_and_b32 s29, s29, 3
    s_mul_i32 s85, s29, 245760
    s_mul_i32 s89, s29, 73728
    s_add_u32 s29, s27, 2
    s_and_b32 s29, s29, 3
    s_mul_i32 s86, s29, 245760
    s_mul_i32 s90, s29, 73728
    s_add_u32 s29, s27, 3
    s_and_b32 s29, s29, 3
    s_mul_i32 s87, s29, 245760
    s_mul_i32 s91, s29, 73728
    s_lshl_b32 s29, s25, 2
    s_add_u32 s29, s29, s27
    s_mul_i32 s29, s29, 491520
    s_add_u32 s29, s29, 33554432
    s_lshl_b32 s30, s28, 2
    s_add_u32 s30, s30, s24
    s_mul_i32 s31, s24, 15360
    s_add_u32 s31, s31, s29
    s_lshl_b32 s38, s28, 11
    s_add_u32 s31, s31, s38
    s_add_u32 s72, s54, s31
    s_addc_u32 s73, s55, 0
    s_mov_b32 s74, 432128
    s_mov_b32 s75, 0x20000
    s_mul_i32 s30, s30, 15360
    s_add_u32 s29, s29, s30
    s_add_u32 s68, s54, s29
    s_addc_u32 s69, s55, 0
    s_mov_b32 s70, 15360
    s_mov_b32 s71, 0x20000
    s_mov_b32 s76, s50
    s_mov_b32 s77, s51
    s_mov_b32 s78, 1966080
    s_mov_b32 s79, 0x20000
    s_lshl_b32 s98, s25, 2
    s_mov_b32 s35, 0
    s_mov_b32 s36, 0x3dd53b95
    s_mov_b32 s37, 0x3dd53b95
    v_lshrrev_b32 v2, 4, v1
    v_and_b32 v3, 15, v1
    v_lshrrev_b32 v4, 2, v3
    v_and_b32 v5, 3, v3
    v_lshrrev_b32 v29, 1, v3
    v_xor_b32 v29, v2, v29
    v_lshlrev_b32 v29, 4, v29
    s_add_u32 s29, s58, 36960
    v_lshl_add_u32 v30, v3, 7, s29
    v_add_u32 v80, v30, v29
    v_xor_b32 v29, 64, v29
    v_add_u32 v81, v30, v29
    v_lshrrev_b32 v29, 1, v3
    v_xor_b32 v29, v2, v29
    v_lshlrev_b32 v29, 4, v29
    v_mul_u32_u24 v30, 0x180, v3
    v_add_u32 v8, v30, v29
    v_xor_b32 v9, 64, v8
    v_add_u32 v10, 36960, v8
    v_add_u32 v11, 36960, v9
    v_and_b32 v29, 1, v2
    v_lshlrev_b32 v29, 1, v29
    v_lshrrev_b32 v30, 1, v4
    v_add_u32 v29, v29, v30
    v_lshlrev_b32 v29, 5, v29
    v_lshl_add_u32 v29, v5, 3, v29
    v_mul_u32_u24 v30, 3080, v2
    v_lshl_add_u32 v30, v4, 7, v30
    v_add_u32 v30, 86240, v30
    v_and_b32 v31, 2, v4
    v_lshlrev_b32 v31, 1, v31
    v_xor_b32 v31, v31, v5
    v_lshl_add_u32 v76, v31, 4, v30
    v_xor_b32 v31, 4, v31
    v_lshl_add_u32 v77, v31, 4, v30
    v_lshl_add_u32 v30, v2, 2, v4
    v_mul_u32_u24 v30, 0x180, v30
    v_xor_b32 v31, 0, v29
    v_add_u32 v31, v30, v31
    v_add_u32 v12, 123200, v31
    v_add_u32 v16, 86240, v31
    v_xor_b32 v31, 32, v29
    v_add_u32 v31, v30, v31
    v_add_u32 v13, 123200, v31
    v_add_u32 v17, 86240, v31
    v_xor_b32 v31, 64, v29
    v_add_u32 v31, v30, v31
    v_add_u32 v14, 123200, v31
    v_add_u32 v18, 86240, v31
    v_xor_b32 v31, 96, v29
    v_add_u32 v31, v30, v31
    v_add_u32 v15, 123200, v31
    v_add_u32 v19, 86240, v31
    v_mov_b32 v26, 0xff800000
    v_mov_b32 v27, 0xff800000
    v_mov_b32 v28, 0xff800000
    v_mul_u32_u24 v31, 0x556, v1
    v_lshrrev_b32 v31, 12, v31
    v_mul_u32_u24 v32, 3, v31
    v_sub_u32 v32, v1, v32
    v_min_u32 v31, 2, v31
    s_lshl_b32 s29, s25, 2
    s_add_u32 s29, s29, s24
    v_mul_u32_u24 v31, 0x500, v31
    v_lshl_add_u32 v31, v32, 7, v31
    s_mul_i32 s29, s29, 30720
    v_add_u32 v31, s29, v31
    s_add_u32 m0, s99, 98560
    s_nop 0
    buffer_load_dwordx4 v64, s[8:11], s32 offen  lds
    s_add_u32 m0, s99, 99584
    s_nop 0
    buffer_load_dwordx4 v65, s[8:11], s32 offen  lds
    s_add_u32 m0, s99, 100608
    s_nop 0
    buffer_load_dwordx4 v66, s[8:11], s32 offen  lds
    s_add_u32 s32, s32, 393216
    s_cmp_eq_u32 s32, 7864320
    s_cselect_b32 s32, 786432, s32
    s_add_u32 m0, s58, 61600
    s_nop 0
    buffer_load_dwordx4 v68, s[4:7], s33 offen offset:0  lds
    buffer_load_dwordx4 v69, s[4:7], s33 offen offset:1024  lds
    buffer_load_dwordx4 v70, s[4:7], s33 offen offset:2048  lds
    s_add_u32 m0, s58, 64672
    s_nop 0
    buffer_load_dwordx4 v71, s[4:7], s33 offen offset:0  lds
    buffer_load_dwordx4 v72, s[4:7], s33 offen offset:1024  lds
    buffer_load_dwordx4 v73, s[4:7], s33 offen offset:2048  lds
    s_add_u32 s33, s33, 128
    s_cmp_eq_u32 s33, 1280
    s_cselect_b32 s33, 128, s33
    s_add_u32 m0, s99, 110880
    s_nop 0
    buffer_load_dwordx4 v64, s[8:11], s32 offen  lds
    s_add_u32 m0, s99, 111904
    s_nop 0
    buffer_load_dwordx4 v65, s[8:11], s32 offen  lds
    s_add_u32 m0, s99, 112928
    s_nop 0
    buffer_load_dwordx4 v66, s[8:11], s32 offen  lds
    s_add_u32 s32, s32, 393216
    s_cmp_eq_u32 s32, 7864320
    s_cselect_b32 s32, 786432, s32
    s_waitcnt vmcnt(16)
    s_barrier
    ds_read_b128 a[120:123], v80 offset:0
    ds_read_b128 a[124:127], v80 offset:2048
    ds_read_b128 a[128:131], v80 offset:4096
    ds_read_b64_tr_b16 a[72:73], v76 offset:61600
    ds_read_b64_tr_b16 a[74:75], v76 offset:62112
    ds_read_b64_tr_b16 a[76:77], v76 offset:61608
    ds_read_b64_tr_b16 a[78:79], v76 offset:62120
    ds_read_b64_tr_b16 a[80:81], v77 offset:61600
    ds_read_b64_tr_b16 a[82:83], v77 offset:62112
    s_waitcnt lgkmcnt(4)
    v_mfma_f32_16x16x32_bf16 v[112:115], a[72:75], a[120:123], 0
    ds_read_b64_tr_b16 a[84:85], v77 offset:61608
    ds_read_b64_tr_b16 a[86:87], v77 offset:62120
    v_mfma_f32_16x16x32_bf16 v[116:119], a[72:75], a[124:127], 0
    v_mfma_f32_16x16x32_bf16 v[120:123], a[72:75], a[128:131], 0
    s_waitcnt lgkmcnt(4)
    ds_read_b64_tr_b16 a[88:89], v76 offset:62624
    ds_read_b64_tr_b16 a[90:91], v76 offset:63136
    v_mfma_f32_16x16x32_bf16 v[132:135], a[76:79], a[128:131], 0
    v_mfma_f32_16x16x32_bf16 v[128:131], a[76:79], a[124:127], 0
    ds_read_b64_tr_b16 a[92:93], v76 offset:62632
    ds_read_b64_tr_b16 a[94:95], v76 offset:63144
    v_mfma_f32_16x16x32_bf16 v[124:127], a[76:79], a[120:123], 0
    s_waitcnt lgkmcnt(6)
    v_mfma_f32_16x16x32_bf16 v[136:139], a[80:83], a[120:123], 0
    ds_read_b64_tr_b16 a[96:97], v77 offset:62624
    ds_read_b64_tr_b16 a[98:99], v77 offset:63136
    v_mfma_f32_16x16x32_bf16 v[140:143], a[80:83], a[124:127], 0
    v_mfma_f32_16x16x32_bf16 v[144:147], a[80:83], a[128:131], 0
    s_waitcnt lgkmcnt(6)
    ds_read_b64_tr_b16 a[100:101], v77 offset:62632
    ds_read_b64_tr_b16 a[102:103], v77 offset:63144
    v_mfma_f32_16x16x32_bf16 v[156:159], a[84:87], a[128:131], 0
    v_mfma_f32_16x16x32_bf16 v[152:155], a[84:87], a[124:127], 0
    ds_read_b64_tr_b16 a[104:105], v76 offset:63648
    ds_read_b64_tr_b16 a[106:107], v76 offset:64160
    v_mfma_f32_16x16x32_bf16 v[148:151], a[84:87], a[120:123], 0
    s_waitcnt lgkmcnt(8)
    v_mfma_f32_16x16x32_bf16 v[160:163], a[88:91], a[120:123], 0
    ds_read_b64_tr_b16 a[108:109], v76 offset:63656
    ds_read_b64_tr_b16 a[110:111], v76 offset:64168
    v_mfma_f32_16x16x32_bf16 v[164:167], a[88:91], a[124:127], 0
    v_mfma_f32_16x16x32_bf16 v[168:171], a[88:91], a[128:131], 0
    s_waitcnt lgkmcnt(8)
    ds_read_b64_tr_b16 a[112:113], v77 offset:63648
    ds_read_b64_tr_b16 a[114:115], v77 offset:64160
    v_mfma_f32_16x16x32_bf16 v[180:183], a[92:95], a[128:131], 0
    v_mfma_f32_16x16x32_bf16 v[176:179], a[92:95], a[124:127], 0
    ds_read_b64_tr_b16 a[116:117], v77 offset:63656
    ds_read_b64_tr_b16 a[118:119], v77 offset:64168
    v_mfma_f32_16x16x32_bf16 v[172:175], a[92:95], a[120:123], 0
    s_waitcnt lgkmcnt(10)
    v_mfma_f32_16x16x32_bf16 v[184:187], a[96:99], a[120:123], 0
    ds_read_b128 a[132:135], v81 offset:0
    ds_read_b128 a[136:139], v81 offset:2048
    v_mfma_f32_16x16x32_bf16 v[188:191], a[96:99], a[124:127], 0
    v_mfma_f32_16x16x32_bf16 v[192:195], a[96:99], a[128:131], 0
    s_waitcnt lgkmcnt(10)
    ds_read_b128 a[140:143], v81 offset:4096
    v_mfma_f32_16x16x32_bf16 v[204:207], a[100:103], a[128:131], 0
    v_mfma_f32_16x16x32_bf16 v[200:203], a[100:103], a[124:127], 0
    v_mfma_f32_16x16x32_bf16 v[196:199], a[100:103], a[120:123], 0
    s_waitcnt lgkmcnt(9)
    v_mfma_f32_16x16x32_bf16 v[208:211], a[104:107], a[120:123], 0
    s_waitcnt vmcnt(13) lgkmcnt(0)
    s_barrier
    v_mfma_f32_16x16x32_bf16 v[212:215], a[104:107], a[124:127], 0
    s_add_u32 m0, s99, 147840
    ds_read_b64_tr_b16 a[72:73], v76 offset:0
    ds_read_b64_tr_b16 a[74:75], v76 offset:512
    v_mfma_f32_16x16x32_bf16 v[216:219], a[104:107], a[128:131], 0
    buffer_load_dwordx4 v64, s[8:11], s32 offen  lds
    v_mfma_f32_16x16x32_bf16 v[228:231], a[108:111], a[128:131], 0
    s_add_u32 m0, s99, 148864
    ds_read_b64_tr_b16 a[76:77], v76 offset:8
    ds_read_b64_tr_b16 a[78:79], v76 offset:520
    v_mfma_f32_16x16x32_bf16 v[224:227], a[108:111], a[124:127], 0
    buffer_load_dwordx4 v65, s[8:11], s32 offen  lds
    v_mfma_f32_16x16x32_bf16 v[220:223], a[108:111], a[120:123], 0
    ds_read_b64_tr_b16 a[80:81], v77 offset:0
    ds_read_b64_tr_b16 a[82:83], v77 offset:512
    v_mfma_f32_16x16x32_bf16 v[232:235], a[112:115], a[120:123], 0
    v_mfma_f32_16x16x32_bf16 v[236:239], a[112:115], a[124:127], 0
    s_add_u32 m0, s99, 149888
    ds_read_b64_tr_b16 a[84:85], v77 offset:8
    ds_read_b64_tr_b16 a[86:87], v77 offset:520
    v_mfma_f32_16x16x32_bf16 v[240:243], a[112:115], a[128:131], 0
    buffer_load_dwordx4 v66, s[8:11], s32 offen  lds
    v_mfma_f32_16x16x32_bf16 v[252:255], a[116:119], a[128:131], 0
    s_add_u32 s32, s32, 393216
    ds_read_b64_tr_b16 a[88:89], v76 offset:1024
    ds_read_b64_tr_b16 a[90:91], v76 offset:1536
    v_mfma_f32_16x16x32_bf16 v[248:251], a[116:119], a[124:127], 0
    s_cmp_eq_u32 s32, 7864320
    s_cselect_b32 s32, 786432, s32
    v_mfma_f32_16x16x32_bf16 v[244:247], a[116:119], a[120:123], 0
    s_waitcnt lgkmcnt(8)
    ds_read_b64_tr_b16 a[92:93], v76 offset:1032
    ds_read_b64_tr_b16 a[94:95], v76 offset:1544
    v_mfma_f32_16x16x32_bf16 v[112:115], a[72:75], a[132:135], v[112:115]
    s_add_u32 m0, s58, 36960
    s_nop 0
    buffer_load_dwordx4 v68, s[4:7], s33 offen offset:0  lds
    v_mfma_f32_16x16x32_bf16 v[116:119], a[72:75], a[136:139], v[116:119]
    ds_read_b64_tr_b16 a[96:97], v77 offset:1024
    ds_read_b64_tr_b16 a[98:99], v77 offset:1536
    v_mfma_f32_16x16x32_bf16 v[120:123], a[72:75], a[140:143], v[120:123]
    s_waitcnt lgkmcnt(10)
    v_mfma_f32_16x16x32_bf16 v[132:135], a[76:79], a[140:143], v[132:135]
    ds_read_b64_tr_b16 a[100:101], v77 offset:1032
    ds_read_b64_tr_b16 a[102:103], v77 offset:1544
    v_mfma_f32_16x16x32_bf16 v[128:131], a[76:79], a[136:139], v[128:131]
    buffer_load_dwordx4 v69, s[4:7], s33 offen offset:1024  lds
    v_mfma_f32_16x16x32_bf16 v[124:127], a[76:79], a[132:135], v[124:127]
    s_waitcnt lgkmcnt(10)
    ds_read_b64_tr_b16 a[104:105], v76 offset:2048
    ds_read_b64_tr_b16 a[106:107], v76 offset:2560
    v_mfma_f32_16x16x32_bf16 v[136:139], a[80:83], a[132:135], v[136:139]
    v_mfma_f32_16x16x32_bf16 v[140:143], a[80:83], a[136:139], v[140:143]
    ds_read_b64_tr_b16 a[108:109], v76 offset:2056
    ds_read_b64_tr_b16 a[110:111], v76 offset:2568
    v_mfma_f32_16x16x32_bf16 v[144:147], a[80:83], a[140:143], v[144:147]
    s_waitcnt lgkmcnt(12)
    v_mfma_f32_16x16x32_bf16 v[156:159], a[84:87], a[140:143], v[156:159]
    ds_read_b64_tr_b16 a[112:113], v77 offset:2048
    ds_read_b64_tr_b16 a[114:115], v77 offset:2560
    v_mfma_f32_16x16x32_bf16 v[152:155], a[84:87], a[136:139], v[152:155]
    buffer_load_dwordx4 v70, s[4:7], s33 offen offset:2048  lds
    v_mfma_f32_16x16x32_bf16 v[148:151], a[84:87], a[132:135], v[148:151]
    s_waitcnt lgkmcnt(12)
    ds_read_b64_tr_b16 a[116:117], v77 offset:2056
    ds_read_b64_tr_b16 a[118:119], v77 offset:2568
    v_mfma_f32_16x16x32_bf16 v[160:163], a[88:91], a[132:135], v[160:163]
    v_mfma_f32_16x16x32_bf16 v[164:167], a[88:91], a[136:139], v[164:167]
    s_add_u32 m0, s58, 40032
    v_mfma_f32_16x16x32_bf16 v[168:171], a[88:91], a[140:143], v[168:171]
    s_waitcnt lgkmcnt(12)
    buffer_load_dwordx4 v71, s[4:7], s33 offen offset:0  lds
    v_mfma_f32_16x16x32_bf16 v[180:183], a[92:95], a[140:143], v[180:183]
    v_mfma_f32_16x16x32_bf16 v[176:179], a[92:95], a[136:139], v[176:179]
    v_mfma_f32_16x16x32_bf16 v[172:175], a[92:95], a[132:135], v[172:175]
    s_waitcnt lgkmcnt(10)
    buffer_load_dwordx4 v72, s[4:7], s33 offen offset:1024  lds
    v_mfma_f32_16x16x32_bf16 v[184:187], a[96:99], a[132:135], v[184:187]
    v_mfma_f32_16x16x32_bf16 v[188:191], a[96:99], a[136:139], v[188:191]
    v_mfma_f32_16x16x32_bf16 v[192:195], a[96:99], a[140:143], v[192:195]
    s_waitcnt lgkmcnt(8)
    buffer_load_dwordx4 v73, s[4:7], s33 offen offset:2048  lds
    v_mfma_f32_16x16x32_bf16 v[204:207], a[100:103], a[140:143], v[204:207]
    s_add_u32 s33, s33, 128
    v_mfma_f32_16x16x32_bf16 v[200:203], a[100:103], a[136:139], v[200:203]
    s_cmp_eq_u32 s33, 1280
    s_cselect_b32 s33, 128, s33
    v_mfma_f32_16x16x32_bf16 v[196:199], a[100:103], a[132:135], v[196:199]
    s_waitcnt lgkmcnt(6)
    v_mfma_f32_16x16x32_bf16 v[208:211], a[104:107], a[132:135], v[208:211]
    s_waitcnt vmcnt(12) lgkmcnt(0)
    s_barrier
    s_mul_i32 s30, s25, 132
    s_lshl_b32 s29, s2, 2
    s_add_u32 s29, s29, s24
    s_cmp_lg_u32 s30, s29
    s_cbranch_scc1 L_NOPUB
    v_mov_b32 v29, s98
    v_mov_b32 v30, 32
    s_mov_b64 exec, 1
    global_store_dword v29, v30, s[52:53] sc1
    s_mov_b64 exec, -1
L_NOPUB:
    v_mfma_f32_16x16x32_bf16 v[212:215], a[104:107], a[136:139], v[212:215]
    s_add_u32 m0, s99, 86240
    ds_read_b128 a[144:147], v80 offset:24640
    ds_read_b128 a[148:151], v80 offset:26688
    v_mfma_f32_16x16x32_bf16 v[216:219], a[104:107], a[140:143], v[216:219]
    buffer_load_dwordx4 v64, s[8:11], s32 offen  lds
    v_mfma_f32_16x16x32_bf16 v[228:231], a[108:111], a[140:143], v[228:231]
    s_add_u32 m0, s99, 87264
    ds_read_b128 a[152:155], v80 offset:28736
    v_mfma_f32_16x16x32_bf16 v[224:227], a[108:111], a[136:139], v[224:227]
    buffer_load_dwordx4 v65, s[8:11], s32 offen  lds
    v_mfma_f32_16x16x32_bf16 v[220:223], a[108:111], a[132:135], v[220:223]
    ds_read_b64_tr_b16 a[72:73], v76 offset:12320
    ds_read_b64_tr_b16 a[74:75], v76 offset:12832
    v_mfma_f32_16x16x32_bf16 v[232:235], a[112:115], a[132:135], v[232:235]
    v_mfma_f32_16x16x32_bf16 v[236:239], a[112:115], a[136:139], v[236:239]
    s_add_u32 m0, s99, 88288
    ds_read_b64_tr_b16 a[76:77], v76 offset:12328
    ds_read_b64_tr_b16 a[78:79], v76 offset:12840
    v_mfma_f32_16x16x32_bf16 v[240:243], a[112:115], a[140:143], v[240:243]
    buffer_load_dwordx4 v66, s[8:11], s32 offen  lds
    v_mfma_f32_16x16x32_bf16 v[252:255], a[116:119], a[140:143], v[252:255]
    s_add_u32 s32, s32, 393216
    ds_read_b64_tr_b16 a[80:81], v77 offset:12320
    ds_read_b64_tr_b16 a[82:83], v77 offset:12832
    v_mfma_f32_16x16x32_bf16 v[248:251], a[116:119], a[136:139], v[248:251]
    s_cmp_eq_u32 s32, 7864320
    s_cselect_b32 s32, 786432, s32
    v_mfma_f32_16x16x32_bf16 v[244:247], a[116:119], a[132:135], v[244:247]
    s_waitcnt lgkmcnt(4)
    ds_read_b64_tr_b16 a[84:85], v77 offset:12328
    ds_read_b64_tr_b16 a[86:87], v77 offset:12840
    v_mfma_f32_16x16x32_bf16 v[112:115], a[72:75], a[144:147], v[112:115]
    v_mfma_f32_16x16x32_bf16 v[116:119], a[72:75], a[148:151], v[116:119]
    ds_read_b64_tr_b16 a[88:89], v76 offset:13344
    ds_read_b64_tr_b16 a[90:91], v76 offset:13856
    v_mfma_f32_16x16x32_bf16 v[120:123], a[72:75], a[152:155], v[120:123]
    s_waitcnt lgkmcnt(6)
    v_mfma_f32_16x16x32_bf16 v[132:135], a[76:79], a[152:155], v[132:135]
    ds_read_b64_tr_b16 a[92:93], v76 offset:13352
    ds_read_b64_tr_b16 a[94:95], v76 offset:13864
    v_mfma_f32_16x16x32_bf16 v[128:131], a[76:79], a[148:151], v[128:131]
    v_mfma_f32_16x16x32_bf16 v[124:127], a[76:79], a[144:147], v[124:127]
    s_waitcnt lgkmcnt(6)
    ds_read_b64_tr_b16 a[96:97], v77 offset:13344
    ds_read_b64_tr_b16 a[98:99], v77 offset:13856
    v_mfma_f32_16x16x32_bf16 v[136:139], a[80:83], a[144:147], v[136:139]
    v_mfma_f32_16x16x32_bf16 v[140:143], a[80:83], a[148:151], v[140:143]
    ds_read_b64_tr_b16 a[100:101], v77 offset:13352
    ds_read_b64_tr_b16 a[102:103], v77 offset:13864
    v_mfma_f32_16x16x32_bf16 v[144:147], a[80:83], a[152:155], v[144:147]
    s_waitcnt lgkmcnt(8)
    v_mfma_f32_16x16x32_bf16 v[156:159], a[84:87], a[152:155], v[156:159]
    ds_read_b64_tr_b16 a[104:105], v76 offset:14368
    ds_read_b64_tr_b16 a[106:107], v76 offset:14880
    v_mfma_f32_16x16x32_bf16 v[152:155], a[84:87], a[148:151], v[152:155]
    v_mfma_f32_16x16x32_bf16 v[148:151], a[84:87], a[144:147], v[148:151]
    s_waitcnt lgkmcnt(8)
    ds_read_b64_tr_b16 a[108:109], v76 offset:14376
    ds_read_b64_tr_b16 a[110:111], v76 offset:14888
    v_mfma_f32_16x16x32_bf16 v[160:163], a[88:91], a[144:147], v[160:163]
    v_mfma_f32_16x16x32_bf16 v[164:167], a[88:91], a[148:151], v[164:167]
    ds_read_b64_tr_b16 a[112:113], v77 offset:14368
    ds_read_b64_tr_b16 a[114:115], v77 offset:14880
    v_mfma_f32_16x16x32_bf16 v[168:171], a[88:91], a[152:155], v[168:171]
    s_waitcnt lgkmcnt(10)
    v_mfma_f32_16x16x32_bf16 v[180:183], a[92:95], a[152:155], v[180:183]
    ds_read_b64_tr_b16 a[116:117], v77 offset:14376
    ds_read_b64_tr_b16 a[118:119], v77 offset:14888
    v_mfma_f32_16x16x32_bf16 v[176:179], a[92:95], a[148:151], v[176:179]
    v_mfma_f32_16x16x32_bf16 v[172:175], a[92:95], a[144:147], v[172:175]
    s_waitcnt lgkmcnt(10)
    ds_read_b128 a[156:159], v81 offset:24640
    ds_read_b128 a[160:163], v81 offset:26688
    v_mfma_f32_16x16x32_bf16 v[184:187], a[96:99], a[144:147], v[184:187]
    v_mfma_f32_16x16x32_bf16 v[188:191], a[96:99], a[148:151], v[188:191]
    ds_read_b128 a[164:167], v81 offset:28736
    v_mfma_f32_16x16x32_bf16 v[192:195], a[96:99], a[152:155], v[192:195]
    s_waitcnt lgkmcnt(11)
    v_mfma_f32_16x16x32_bf16 v[204:207], a[100:103], a[152:155], v[204:207]
    v_mfma_f32_16x16x32_bf16 v[200:203], a[100:103], a[148:151], v[200:203]
    v_mfma_f32_16x16x32_bf16 v[196:199], a[100:103], a[144:147], v[196:199]
    s_waitcnt lgkmcnt(9)
    v_mfma_f32_16x16x32_bf16 v[208:211], a[104:107], a[144:147], v[208:211]
    s_waitcnt vmcnt(12) lgkmcnt(0)
    s_barrier
    v_mfma_f32_16x16x32_bf16 v[212:215], a[104:107], a[148:151], v[212:215]
    s_add_u32 m0, s99, 98560
    ds_read_b64_tr_b16 a[72:73], v76 offset:24640
    ds_read_b64_tr_b16 a[74:75], v76 offset:25152
    v_mfma_f32_16x16x32_bf16 v[216:219], a[104:107], a[152:155], v[216:219]
    buffer_load_dwordx4 v64, s[8:11], s32 offen  lds
    v_mfma_f32_16x16x32_bf16 v[228:231], a[108:111], a[152:155], v[228:231]
    s_add_u32 m0, s99, 99584
    ds_read_b64_tr_b16 a[76:77], v76 offset:24648
    ds_read_b64_tr_b16 a[78:79], v76 offset:25160
    v_mfma_f32_16x16x32_bf16 v[224:227], a[108:111], a[148:151], v[224:227]
    buffer_load_dwordx4 v65, s[8:11], s32 offen  lds
    v_mfma_f32_16x16x32_bf16 v[220:223], a[108:111], a[144:147], v[220:223]
    ds_read_b64_tr_b16 a[80:81], v77 offset:24640
    ds_read_b64_tr_b16 a[82:83], v77 offset:25152
    v_mfma_f32_16x16x32_bf16 v[232:235], a[112:115], a[144:147], v[232:235]
    v_mfma_f32_16x16x32_bf16 v[236:239], a[112:115], a[148:151], v[236:239]
    s_add_u32 m0, s99, 100608
    ds_read_b64_tr_b16 a[84:85], v77 offset:24648
    ds_read_b64_tr_b16 a[86:87], v77 offset:25160
    v_mfma_f32_16x16x32_bf16 v[240:243], a[112:115], a[152:155], v[240:243]
    buffer_load_dwordx4 v66, s[8:11], s32 offen  lds
    v_mfma_f32_16x16x32_bf16 v[252:255], a[116:119], a[152:155], v[252:255]
    s_add_u32 s32, s32, 393216
    ds_read_b64_tr_b16 a[88:89], v76 offset:25664
    ds_read_b64_tr_b16 a[90:91], v76 offset:26176
    v_mfma_f32_16x16x32_bf16 v[248:251], a[116:119], a[148:151], v[248:251]
    s_cmp_eq_u32 s32, 7864320
    s_cselect_b32 s32, 786432, s32
    v_mfma_f32_16x16x32_bf16 v[244:247], a[116:119], a[144:147], v[244:247]
    s_waitcnt lgkmcnt(8)
    ds_read_b64_tr_b16 a[92:93], v76 offset:25672
    ds_read_b64_tr_b16 a[94:95], v76 offset:26184
    v_mfma_f32_16x16x32_bf16 v[112:115], a[72:75], a[156:159], v[112:115]
    s_add_u32 m0, s58, 61600
    s_nop 0
    buffer_load_dwordx4 v68, s[4:7], s33 offen offset:0  lds
    v_mfma_f32_16x16x32_bf16 v[116:119], a[72:75], a[160:163], v[116:119]
    ds_read_b64_tr_b16 a[96:97], v77 offset:25664
    ds_read_b64_tr_b16 a[98:99], v77 offset:26176
    v_mfma_f32_16x16x32_bf16 v[120:123], a[72:75], a[164:167], v[120:123]
    s_waitcnt lgkmcnt(10)
    v_mfma_f32_16x16x32_bf16 v[132:135], a[76:79], a[164:167], v[132:135]
    ds_read_b64_tr_b16 a[100:101], v77 offset:25672
    ds_read_b64_tr_b16 a[102:103], v77 offset:26184
    v_mfma_f32_16x16x32_bf16 v[128:131], a[76:79], a[160:163], v[128:131]
    buffer_load_dwordx4 v69, s[4:7], s33 offen offset:1024  lds
    v_mfma_f32_16x16x32_bf16 v[124:127], a[76:79], a[156:159], v[124:127]
    s_waitcnt lgkmcnt(10)
    ds_read_b64_tr_b16 a[104:105], v76 offset:26688
    ds_read_b64_tr_b16 a[106:107], v76 offset:27200
    v_mfma_f32_16x16x32_bf16 v[136:139], a[80:83], a[156:159], v[136:139]
    v_mfma_f32_16x16x32_bf16 v[140:143], a[80:83], a[160:163], v[140:143]
    ds_read_b64_tr_b16 a[108:109], v76 offset:26696
    ds_read_b64_tr_b16 a[110:111], v76 offset:27208
    v_mfma_f32_16x16x32_bf16 v[144:147], a[80:83], a[164:167], v[144:147]
    s_waitcnt lgkmcnt(12)
    v_mfma_f32_16x16x32_bf16 v[156:159], a[84:87], a[164:167], v[156:159]
    ds_read_b64_tr_b16 a[112:113], v77 offset:26688
    ds_read_b64_tr_b16 a[114:115], v77 offset:27200
    v_mfma_f32_16x16x32_bf16 v[152:155], a[84:87], a[160:163], v[152:155]
    buffer_load_dwordx4 v70, s[4:7], s33 offen offset:2048  lds
    v_mfma_f32_16x16x32_bf16 v[148:151], a[84:87], a[156:159], v[148:151]
    s_waitcnt lgkmcnt(12)
    ds_read_b64_tr_b16 a[116:117], v77 offset:26696
    ds_read_b64_tr_b16 a[118:119], v77 offset:27208
    v_mfma_f32_16x16x32_bf16 v[160:163], a[88:91], a[156:159], v[160:163]
    v_mfma_f32_16x16x32_bf16 v[164:167], a[88:91], a[160:163], v[164:167]
    s_add_u32 m0, s58, 64672
    v_mfma_f32_16x16x32_bf16 v[168:171], a[88:91], a[164:167], v[168:171]
    s_waitcnt lgkmcnt(12)
    buffer_load_dwordx4 v71, s[4:7], s33 offen offset:0  lds
    v_mfma_f32_16x16x32_bf16 v[180:183], a[92:95], a[164:167], v[180:183]
    v_mfma_f32_16x16x32_bf16 v[176:179], a[92:95], a[160:163], v[176:179]
    v_mfma_f32_16x16x32_bf16 v[172:175], a[92:95], a[156:159], v[172:175]
    s_waitcnt lgkmcnt(10)
    buffer_load_dwordx4 v72, s[4:7], s33 offen offset:1024  lds
    v_mfma_f32_16x16x32_bf16 v[184:187], a[96:99], a[156:159], v[184:187]
    v_mfma_f32_16x16x32_bf16 v[188:191], a[96:99], a[160:163], v[188:191]
    v_mfma_f32_16x16x32_bf16 v[192:195], a[96:99], a[164:167], v[192:195]
    s_waitcnt lgkmcnt(8)
    buffer_load_dwordx4 v73, s[4:7], s33 offen offset:2048  lds
    v_mfma_f32_16x16x32_bf16 v[204:207], a[100:103], a[164:167], v[204:207]
    s_add_u32 s33, s33, 128
    v_mfma_f32_16x16x32_bf16 v[200:203], a[100:103], a[160:163], v[200:203]
    s_cmp_eq_u32 s33, 1280
    s_cselect_b32 s33, 128, s33
    v_mfma_f32_16x16x32_bf16 v[196:199], a[100:103], a[156:159], v[196:199]
    s_waitcnt lgkmcnt(6)
    v_mfma_f32_16x16x32_bf16 v[208:211], a[104:107], a[156:159], v[208:211]
    s_waitcnt vmcnt(12) lgkmcnt(0)
    s_barrier
    v_mfma_f32_16x16x32_bf16 v[212:215], a[104:107], a[160:163], v[212:215]
    s_add_u32 m0, s99, 110880
    ds_read_b128 a[120:123], v80 offset:0
    ds_read_b128 a[124:127], v80 offset:2048
    v_mfma_f32_16x16x32_bf16 v[216:219], a[104:107], a[164:167], v[216:219]
    buffer_load_dwordx4 v64, s[8:11], s32 offen  lds
    v_mfma_f32_16x16x32_bf16 v[228:231], a[108:111], a[164:167], v[228:231]
    s_add_u32 m0, s99, 111904
    ds_read_b128 a[128:131], v80 offset:4096
    v_mfma_f32_16x16x32_bf16 v[224:227], a[108:111], a[160:163], v[224:227]
    buffer_load_dwordx4 v65, s[8:11], s32 offen  lds
    v_mfma_f32_16x16x32_bf16 v[220:223], a[108:111], a[156:159], v[220:223]
    ds_read_b64_tr_b16 a[72:73], v76 offset:61600
    ds_read_b64_tr_b16 a[74:75], v76 offset:62112
    v_mfma_f32_16x16x32_bf16 v[232:235], a[112:115], a[156:159], v[232:235]
    v_mfma_f32_16x16x32_bf16 v[236:239], a[112:115], a[160:163], v[236:239]
    s_add_u32 m0, s99, 112928
    ds_read_b64_tr_b16 a[76:77], v76 offset:61608
    ds_read_b64_tr_b16 a[78:79], v76 offset:62120
    v_mfma_f32_16x16x32_bf16 v[240:243], a[112:115], a[164:167], v[240:243]
    buffer_load_dwordx4 v66, s[8:11], s32 offen  lds
    v_mfma_f32_16x16x32_bf16 v[252:255], a[116:119], a[164:167], v[252:255]
    s_add_u32 s32, s32, 393216
    ds_read_b64_tr_b16 a[80:81], v77 offset:61600
    ds_read_b64_tr_b16 a[82:83], v77 offset:62112
    v_mfma_f32_16x16x32_bf16 v[248:251], a[116:119], a[160:163], v[248:251]
    s_cmp_eq_u32 s32, 7864320
    s_cselect_b32 s32, 786432, s32
    v_mfma_f32_16x16x32_bf16 v[244:247], a[116:119], a[156:159], v[244:247]
    s_waitcnt lgkmcnt(4)
    ds_read_b64_tr_b16 a[84:85], v77 offset:61608
    ds_read_b64_tr_b16 a[86:87], v77 offset:62120
    v_mfma_f32_16x16x32_bf16 v[112:115], a[72:75], a[120:123], v[112:115]
    v_mfma_f32_16x16x32_bf16 v[116:119], a[72:75], a[124:127], v[116:119]
    ds_read_b64_tr_b16 a[88:89], v76 offset:62624
    ds_read_b64_tr_b16 a[90:91], v76 offset:63136
    v_mfma_f32_16x16x32_bf16 v[120:123], a[72:75], a[128:131], v[120:123]
    s_waitcnt lgkmcnt(6)
    v_mfma_f32_16x16x32_bf16 v[132:135], a[76:79], a[128:131], v[132:135]
    ds_read_b64_tr_b16 a[92:93], v76 offset:62632
    ds_read_b64_tr_b16 a[94:95], v76 offset:63144
    v_mfma_f32_16x16x32_bf16 v[128:131], a[76:79], a[124:127], v[128:131]
    v_mfma_f32_16x16x32_bf16 v[124:127], a[76:79], a[120:123], v[124:127]
    s_waitcnt lgkmcnt(6)
    ds_read_b64_tr_b16 a[96:97], v77 offset:62624
    ds_read_b64_tr_b16 a[98:99], v77 offset:63136
    v_mfma_f32_16x16x32_bf16 v[136:139], a[80:83], a[120:123], v[136:139]
    v_mfma_f32_16x16x32_bf16 v[140:143], a[80:83], a[124:127], v[140:143]
    ds_read_b64_tr_b16 a[100:101], v77 offset:62632
    ds_read_b64_tr_b16 a[102:103], v77 offset:63144
    v_mfma_f32_16x16x32_bf16 v[144:147], a[80:83], a[128:131], v[144:147]
    s_waitcnt lgkmcnt(8)
    v_mfma_f32_16x16x32_bf16 v[156:159], a[84:87], a[128:131], v[156:159]
    ds_read_b64_tr_b16 a[104:105], v76 offset:63648
    ds_read_b64_tr_b16 a[106:107], v76 offset:64160
    v_mfma_f32_16x16x32_bf16 v[152:155], a[84:87], a[124:127], v[152:155]
    v_mfma_f32_16x16x32_bf16 v[148:151], a[84:87], a[120:123], v[148:151]
    s_waitcnt lgkmcnt(8)
    ds_read_b64_tr_b16 a[108:109], v76 offset:63656
    ds_read_b64_tr_b16 a[110:111], v76 offset:64168
    v_mfma_f32_16x16x32_bf16 v[160:163], a[88:91], a[120:123], v[160:163]
    v_mfma_f32_16x16x32_bf16 v[164:167], a[88:91], a[124:127], v[164:167]
    ds_read_b64_tr_b16 a[112:113], v77 offset:63648
    ds_read_b64_tr_b16 a[114:115], v77 offset:64160
    v_mfma_f32_16x16x32_bf16 v[168:171], a[88:91], a[128:131], v[168:171]
    s_waitcnt lgkmcnt(10)
    v_mfma_f32_16x16x32_bf16 v[180:183], a[92:95], a[128:131], v[180:183]
    ds_read_b64_tr_b16 a[116:117], v77 offset:63656
    ds_read_b64_tr_b16 a[118:119], v77 offset:64168
    v_mfma_f32_16x16x32_bf16 v[176:179], a[92:95], a[124:127], v[176:179]
    v_mfma_f32_16x16x32_bf16 v[172:175], a[92:95], a[120:123], v[172:175]
    s_waitcnt lgkmcnt(10)
    ds_read_b128 a[132:135], v81 offset:0
    ds_read_b128 a[136:139], v81 offset:2048
    v_mfma_f32_16x16x32_bf16 v[184:187], a[96:99], a[120:123], v[184:187]
    v_mfma_f32_16x16x32_bf16 v[188:191], a[96:99], a[124:127], v[188:191]
    ds_read_b128 a[140:143], v81 offset:4096
    v_mfma_f32_16x16x32_bf16 v[192:195], a[96:99], a[128:131], v[192:195]
    s_waitcnt lgkmcnt(11)
    v_mfma_f32_16x16x32_bf16 v[204:207], a[100:103], a[128:131], v[204:207]
    v_mfma_f32_16x16x32_bf16 v[200:203], a[100:103], a[124:127], v[200:203]
    v_mfma_f32_16x16x32_bf16 v[196:199], a[100:103], a[120:123], v[196:199]
    s_waitcnt lgkmcnt(9)
    v_mfma_f32_16x16x32_bf16 v[208:211], a[104:107], a[120:123], v[208:211]
    s_waitcnt vmcnt(12) lgkmcnt(0)
    s_barrier
    v_mfma_f32_16x16x32_bf16 v[212:215], a[104:107], a[124:127], v[212:215]
    s_add_u32 m0, s99, 147840
    ds_read_b64_tr_b16 a[72:73], v76 offset:0
    ds_read_b64_tr_b16 a[74:75], v76 offset:512
    v_mfma_f32_16x16x32_bf16 v[216:219], a[104:107], a[128:131], v[216:219]
    buffer_load_dwordx4 v64, s[8:11], s32 offen  lds
    v_mfma_f32_16x16x32_bf16 v[228:231], a[108:111], a[128:131], v[228:231]
    s_add_u32 m0, s99, 148864
    ds_read_b64_tr_b16 a[76:77], v76 offset:8
    ds_read_b64_tr_b16 a[78:79], v76 offset:520
    v_mfma_f32_16x16x32_bf16 v[224:227], a[108:111], a[124:127], v[224:227]
    buffer_load_dwordx4 v65, s[8:11], s32 offen  lds
    v_mfma_f32_16x16x32_bf16 v[220:223], a[108:111], a[120:123], v[220:223]
    ds_read_b64_tr_b16 a[80:81], v77 offset:0
    ds_read_b64_tr_b16 a[82:83], v77 offset:512
    v_mfma_f32_16x16x32_bf16 v[232:235], a[112:115], a[120:123], v[232:235]
    v_mfma_f32_16x16x32_bf16 v[236:239], a[112:115], a[124:127], v[236:239]
    s_add_u32 m0, s99, 149888
    ds_read_b64_tr_b16 a[84:85], v77 offset:8
    ds_read_b64_tr_b16 a[86:87], v77 offset:520
    v_mfma_f32_16x16x32_bf16 v[240:243], a[112:115], a[128:131], v[240:243]
    buffer_load_dwordx4 v66, s[8:11], s32 offen  lds
    v_mfma_f32_16x16x32_bf16 v[252:255], a[116:119], a[128:131], v[252:255]
    s_add_u32 s32, s32, 393216
    ds_read_b64_tr_b16 a[88:89], v76 offset:1024
    ds_read_b64_tr_b16 a[90:91], v76 offset:1536
    v_mfma_f32_16x16x32_bf16 v[248:251], a[116:119], a[124:127], v[248:251]
    s_cmp_eq_u32 s32, 7864320
    s_cselect_b32 s32, 786432, s32
    v_mfma_f32_16x16x32_bf16 v[244:247], a[116:119], a[120:123], v[244:247]
    s_waitcnt lgkmcnt(8)
    ds_read_b64_tr_b16 a[92:93], v76 offset:1032
    ds_read_b64_tr_b16 a[94:95], v76 offset:1544
    v_mfma_f32_16x16x32_bf16 v[112:115], a[72:75], a[132:135], v[112:115]
    s_add_u32 m0, s58, 36960
    s_nop 0
    buffer_load_dwordx4 v68, s[4:7], s33 offen offset:0  lds
    v_mfma_f32_16x16x32_bf16 v[116:119], a[72:75], a[136:139], v[116:119]
    ds_read_b64_tr_b16 a[96:97], v77 offset:1024
    ds_read_b64_tr_b16 a[98:99], v77 offset:1536
    v_mfma_f32_16x16x32_bf16 v[120:123], a[72:75], a[140:143], v[120:123]
    s_waitcnt lgkmcnt(10)
    buffer_load_dwordx4 v69, s[4:7], s33 offen offset:1024  lds
    v_mfma_f32_16x16x32_bf16 v[132:135], a[76:79], a[140:143], v[132:135]
    ds_read_b64_tr_b16 a[100:101], v77 offset:1032
    ds_read_b64_tr_b16 a[102:103], v77 offset:1544
    v_mfma_f32_16x16x32_bf16 v[128:131], a[76:79], a[136:139], v[128:131]
    v_mfma_f32_16x16x32_bf16 v[124:127], a[76:79], a[132:135], v[124:127]
    s_waitcnt lgkmcnt(10)
    ds_read_b64_tr_b16 a[104:105], v76 offset:2048
    ds_read_b64_tr_b16 a[106:107], v76 offset:2560
    v_mfma_f32_16x16x32_bf16 v[136:139], a[80:83], a[132:135], v[136:139]
    buffer_load_dwordx4 v70, s[4:7], s33 offen offset:2048  lds
    v_mfma_f32_16x16x32_bf16 v[140:143], a[80:83], a[136:139], v[140:143]
    ds_read_b64_tr_b16 a[108:109], v76 offset:2056
    ds_read_b64_tr_b16 a[110:111], v76 offset:2568
    v_mfma_f32_16x16x32_bf16 v[144:147], a[80:83], a[140:143], v[144:147]
    s_waitcnt lgkmcnt(12)
    v_mfma_f32_16x16x32_bf16 v[156:159], a[84:87], a[140:143], v[156:159]
    s_add_u32 m0, s58, 40032
    ds_read_b64_tr_b16 a[112:113], v77 offset:2048
    ds_read_b64_tr_b16 a[114:115], v77 offset:2560
    v_mfma_f32_16x16x32_bf16 v[152:155], a[84:87], a[136:139], v[152:155]
    buffer_load_dwordx4 v71, s[4:7], s33 offen offset:0  lds
    v_mfma_f32_16x16x32_bf16 v[148:151], a[84:87], a[132:135], v[148:151]
    s_waitcnt lgkmcnt(12)
    ds_read_b64_tr_b16 a[116:117], v77 offset:2056
    ds_read_b64_tr_b16 a[118:119], v77 offset:2568
    v_mfma_f32_16x16x32_bf16 v[160:163], a[88:91], a[132:135], v[160:163]
    v_mfma_f32_16x16x32_bf16 v[164:167], a[88:91], a[136:139], v[164:167]
    buffer_load_dwordx4 v72, s[4:7], s33 offen offset:1024  lds
    v_mfma_f32_16x16x32_bf16 v[168:171], a[88:91], a[140:143], v[168:171]
    s_waitcnt lgkmcnt(12)
    v_mfma_f32_16x16x32_bf16 v[180:183], a[92:95], a[140:143], v[180:183]
    buffer_load_dwordx4 v73, s[4:7], s33 offen offset:2048  lds
    v_mfma_f32_16x16x32_bf16 v[176:179], a[92:95], a[136:139], v[176:179]
    s_add_u32 s33, s33, 128
    v_mfma_f32_16x16x32_bf16 v[172:175], a[92:95], a[132:135], v[172:175]
    s_waitcnt lgkmcnt(10)
    s_cmp_eq_u32 s33, 1280
    s_cselect_b32 s33, 128, s33
    s_add_u32 s39, s34, 0
    s_add_u32 m0, s34, 0
    s_nop 0
    buffer_load_dwordx4 v20, s[12:15], s39 offen offset:0 nt lds
    v_mfma_f32_16x16x32_bf16 v[184:187], a[96:99], a[132:135], v[184:187]
    v_mfma_f32_16x16x32_bf16 v[188:191], a[96:99], a[136:139], v[188:191]
    buffer_load_dwordx4 v21, s[12:15], s39 offen offset:1024 nt lds
    v_mfma_f32_16x16x32_bf16 v[192:195], a[96:99], a[140:143], v[192:195]
    s_waitcnt lgkmcnt(8)
    v_mfma_f32_16x16x32_bf16 v[204:207], a[100:103], a[140:143], v[204:207]
    buffer_load_dwordx4 v22, s[12:15], s39 offen offset:2048 nt lds
    v_mfma_f32_16x16x32_bf16 v[200:203], a[100:103], a[136:139], v[200:203]
    v_mfma_f32_16x16x32_bf16 v[196:199], a[100:103], a[132:135], v[196:199]
    s_waitcnt lgkmcnt(6)
    v_mfma_f32_16x16x32_bf16 v[208:211], a[104:107], a[132:135], v[208:211]
    s_waitcnt vmcnt(15) lgkmcnt(0)
    s_barrier
    s_add_u32 s39, s34, 12288
    v_mfma_f32_16x16x32_bf16 v[212:215], a[104:107], a[136:139], v[212:215]
    s_add_u32 m0, s34, 12320
    ds_read_b128 a[144:147], v80 offset:24640
    ds_read_b128 a[148:151], v80 offset:26688
    v_mfma_f32_16x16x32_bf16 v[216:219], a[104:107], a[140:143], v[216:219]
    buffer_load_dwordx4 v20, s[12:15], s39 offen offset:0 nt lds
    v_mfma_f32_16x16x32_bf16 v[228:231], a[108:111], a[140:143], v[228:231]
    ds_read_b128 a[152:155], v80 offset:28736
    v_mfma_f32_16x16x32_bf16 v[224:227], a[108:111], a[136:139], v[224:227]
    buffer_load_dwordx4 v21, s[12:15], s39 offen offset:1024 nt lds
    v_mfma_f32_16x16x32_bf16 v[220:223], a[108:111], a[132:135], v[220:223]
    ds_read_b64_tr_b16 a[72:73], v76 offset:12320
    ds_read_b64_tr_b16 a[74:75], v76 offset:12832
    v_mfma_f32_16x16x32_bf16 v[232:235], a[112:115], a[132:135], v[232:235]
    v_mfma_f32_16x16x32_bf16 v[236:239], a[112:115], a[136:139], v[236:239]
    ds_read_b64_tr_b16 a[76:77], v76 offset:12328
    ds_read_b64_tr_b16 a[78:79], v76 offset:12840
    v_mfma_f32_16x16x32_bf16 v[240:243], a[112:115], a[140:143], v[240:243]
    buffer_load_dwordx4 v22, s[12:15], s39 offen offset:2048 nt lds
    v_mfma_f32_16x16x32_bf16 v[252:255], a[116:119], a[140:143], v[252:255]
    ds_read_b64_tr_b16 a[80:81], v77 offset:12320
    ds_read_b64_tr_b16 a[82:83], v77 offset:12832
    v_mfma_f32_16x16x32_bf16 v[248:251], a[116:119], a[136:139], v[248:251]
    v_mfma_f32_16x16x32_bf16 v[244:247], a[116:119], a[132:135], v[244:247]
    s_waitcnt lgkmcnt(4)
    ds_read_b64_tr_b16 a[84:85], v77 offset:12328
    ds_read_b64_tr_b16 a[86:87], v77 offset:12840
    v_mfma_f32_16x16x32_bf16 v[112:115], a[72:75], a[144:147], v[112:115]
    s_add_u32 s39, s34, 0
    s_add_u32 m0, s34, 123200
    s_nop 0
    buffer_load_dwordx4 v23, s[16:19], s39 offen offset:0 nt lds
    v_mfma_f32_16x16x32_bf16 v[116:119], a[72:75], a[148:151], v[116:119]
    ds_read_b64_tr_b16 a[88:89], v76 offset:13344
    ds_read_b64_tr_b16 a[90:91], v76 offset:13856
    v_mfma_f32_16x16x32_bf16 v[120:123], a[72:75], a[152:155], v[120:123]
    s_waitcnt lgkmcnt(6)
    v_mfma_f32_16x16x32_bf16 v[132:135], a[76:79], a[152:155], v[132:135]
    ds_read_b64_tr_b16 a[92:93], v76 offset:13352
    ds_read_b64_tr_b16 a[94:95], v76 offset:13864
    v_mfma_f32_16x16x32_bf16 v[128:131], a[76:79], a[148:151], v[128:131]
    v_mfma_f32_16x16x32_bf16 v[124:127], a[76:79], a[144:147], v[124:127]
    s_waitcnt lgkmcnt(6)
    s_add_u32 m0, s99, 86240
    ds_read_b64_tr_b16 a[96:97], v77 offset:13344
    ds_read_b64_tr_b16 a[98:99], v77 offset:13856
    v_mfma_f32_16x16x32_bf16 v[136:139], a[80:83], a[144:147], v[136:139]
    buffer_load_dwordx4 v64, s[8:11], s32 offen  lds
    v_mfma_f32_16x16x32_bf16 v[140:143], a[80:83], a[148:151], v[140:143]
    ds_read_b64_tr_b16 a[100:101], v77 offset:13352
    ds_read_b64_tr_b16 a[102:103], v77 offset:13864
    v_mfma_f32_16x16x32_bf16 v[144:147], a[80:83], a[152:155], v[144:147]
    s_waitcnt lgkmcnt(8)
    v_mfma_f32_16x16x32_bf16 v[156:159], a[84:87], a[152:155], v[156:159]
    ds_read_b64_tr_b16 a[104:105], v76 offset:14368
    ds_read_b64_tr_b16 a[106:107], v76 offset:14880
    v_mfma_f32_16x16x32_bf16 v[152:155], a[84:87], a[148:151], v[152:155]
    v_mfma_f32_16x16x32_bf16 v[148:151], a[84:87], a[144:147], v[148:151]
    s_waitcnt lgkmcnt(8)
    s_add_u32 m0, s99, 87264
    ds_read_b64_tr_b16 a[108:109], v76 offset:14376
    ds_read_b64_tr_b16 a[110:111], v76 offset:14888
    v_mfma_f32_16x16x32_bf16 v[160:163], a[88:91], a[144:147], v[160:163]
    buffer_load_dwordx4 v65, s[8:11], s32 offen  lds
    v_mfma_f32_16x16x32_bf16 v[164:167], a[88:91], a[148:151], v[164:167]
    ds_read_b64_tr_b16 a[112:113], v77 offset:14368
    ds_read_b64_tr_b16 a[114:115], v77 offset:14880
    v_mfma_f32_16x16x32_bf16 v[168:171], a[88:91], a[152:155], v[168:171]
    s_waitcnt lgkmcnt(10)
    v_mfma_f32_16x16x32_bf16 v[180:183], a[92:95], a[152:155], v[180:183]
    ds_read_b64_tr_b16 a[116:117], v77 offset:14376
    ds_read_b64_tr_b16 a[118:119], v77 offset:14888
    v_mfma_f32_16x16x32_bf16 v[176:179], a[92:95], a[148:151], v[176:179]
    v_mfma_f32_16x16x32_bf16 v[172:175], a[92:95], a[144:147], v[172:175]
    s_waitcnt lgkmcnt(10)
    s_add_u32 m0, s99, 88288
    ds_read_b128 a[156:159], v81 offset:24640
    ds_read_b128 a[160:163], v81 offset:26688
    v_mfma_f32_16x16x32_bf16 v[184:187], a[96:99], a[144:147], v[184:187]
    buffer_load_dwordx4 v66, s[8:11], s32 offen  lds
    v_mfma_f32_16x16x32_bf16 v[188:191], a[96:99], a[148:151], v[188:191]
    s_add_u32 s32, s32, 393216
    ds_read_b128 a[164:167], v81 offset:28736
    v_mfma_f32_16x16x32_bf16 v[192:195], a[96:99], a[152:155], v[192:195]
    s_waitcnt lgkmcnt(11)
    s_cmp_eq_u32 s32, 7864320
    s_cselect_b32 s32, 786432, s32
    v_mfma_f32_16x16x32_bf16 v[204:207], a[100:103], a[152:155], v[204:207]
    v_mfma_f32_16x16x32_bf16 v[200:203], a[100:103], a[148:151], v[200:203]
    v_mfma_f32_16x16x32_bf16 v[196:199], a[100:103], a[144:147], v[196:199]
    s_waitcnt lgkmcnt(9)
    v_mfma_f32_16x16x32_bf16 v[208:211], a[104:107], a[144:147], v[208:211]
    s_waitcnt vmcnt(19) lgkmcnt(0)
    s_barrier
    v_mfma_f32_16x16x32_bf16 v[212:215], a[104:107], a[148:151], v[212:215]
    s_add_u32 m0, s99, 98560
    ds_read_b64_tr_b16 a[72:73], v76 offset:24640
    ds_read_b64_tr_b16 a[74:75], v76 offset:25152
    v_mfma_f32_16x16x32_bf16 v[216:219], a[104:107], a[152:155], v[216:219]
    buffer_load_dwordx4 v64, s[8:11], s32 offen  lds
    v_mfma_f32_16x16x32_bf16 v[228:231], a[108:111], a[152:155], v[228:231]
    s_add_u32 m0, s99, 99584
    ds_read_b64_tr_b16 a[76:77], v76 offset:24648
    ds_read_b64_tr_b16 a[78:79], v76 offset:25160
    v_mfma_f32_16x16x32_bf16 v[224:227], a[108:111], a[148:151], v[224:227]
    buffer_load_dwordx4 v65, s[8:11], s32 offen  lds
    v_mfma_f32_16x16x32_bf16 v[220:223], a[108:111], a[144:147], v[220:223]
    ds_read_b64_tr_b16 a[80:81], v77 offset:24640
    ds_read_b64_tr_b16 a[82:83], v77 offset:25152
    v_mfma_f32_16x16x32_bf16 v[232:235], a[112:115], a[144:147], v[232:235]
    v_mfma_f32_16x16x32_bf16 v[236:239], a[112:115], a[148:151], v[236:239]
    s_add_u32 m0, s99, 100608
    ds_read_b64_tr_b16 a[84:85], v77 offset:24648
    ds_read_b64_tr_b16 a[86:87], v77 offset:25160
    v_mfma_f32_16x16x32_bf16 v[240:243], a[112:115], a[152:155], v[240:243]
    buffer_load_dwordx4 v66, s[8:11], s32 offen  lds
    v_mfma_f32_16x16x32_bf16 v[252:255], a[116:119], a[152:155], v[252:255]
    s_add_u32 s32, s32, 393216
    ds_read_b64_tr_b16 a[88:89], v76 offset:25664
    ds_read_b64_tr_b16 a[90:91], v76 offset:26176
    v_mfma_f32_16x16x32_bf16 v[248:251], a[116:119], a[148:151], v[248:251]
    s_cmp_eq_u32 s32, 7864320
    s_cselect_b32 s32, 786432, s32
    v_mfma_f32_16x16x32_bf16 v[244:247], a[116:119], a[144:147], v[244:247]
    s_waitcnt lgkmcnt(8)
    ds_read_b64_tr_b16 a[92:93], v76 offset:25672
    ds_read_b64_tr_b16 a[94:95], v76 offset:26184
    v_mfma_f32_16x16x32_bf16 v[112:115], a[72:75], a[156:159], v[112:115]
    s_add_u32 m0, s58, 61600
    s_nop 0
    buffer_load_dwordx4 v68, s[4:7], s33 offen offset:0  lds
    v_mfma_f32_16x16x32_bf16 v[116:119], a[72:75], a[160:163], v[116:119]
    ds_read_b64_tr_b16 a[96:97], v77 offset:25664
    ds_read_b64_tr_b16 a[98:99], v77 offset:26176
    v_mfma_f32_16x16x32_bf16 v[120:123], a[72:75], a[164:167], v[120:123]
    s_waitcnt lgkmcnt(10)
    v_mfma_f32_16x16x32_bf16 v[132:135], a[76:79], a[164:167], v[132:135]
    ds_read_b64_tr_b16 a[100:101], v77 offset:25672
    ds_read_b64_tr_b16 a[102:103], v77 offset:26184
    v_mfma_f32_16x16x32_bf16 v[128:131], a[76:79], a[160:163], v[128:131]
    buffer_load_dwordx4 v69, s[4:7], s33 offen offset:1024  lds
    v_mfma_f32_16x16x32_bf16 v[124:127], a[76:79], a[156:159], v[124:127]
    s_waitcnt lgkmcnt(10)
    ds_read_b64_tr_b16 a[104:105], v76 offset:26688
    ds_read_b64_tr_b16 a[106:107], v76 offset:27200
    v_mfma_f32_16x16x32_bf16 v[136:139], a[80:83], a[156:159], v[136:139]
    v_mfma_f32_16x16x32_bf16 v[140:143], a[80:83], a[160:163], v[140:143]
    ds_read_b64_tr_b16 a[108:109], v76 offset:26696
    ds_read_b64_tr_b16 a[110:111], v76 offset:27208
    v_mfma_f32_16x16x32_bf16 v[144:147], a[80:83], a[164:167], v[144:147]
    s_waitcnt lgkmcnt(12)
    v_mfma_f32_16x16x32_bf16 v[156:159], a[84:87], a[164:167], v[156:159]
    ds_read_b64_tr_b16 a[112:113], v77 offset:26688
    ds_read_b64_tr_b16 a[114:115], v77 offset:27200
    v_mfma_f32_16x16x32_bf16 v[152:155], a[84:87], a[160:163], v[152:155]
    buffer_load_dwordx4 v70, s[4:7], s33 offen offset:2048  lds
    v_mfma_f32_16x16x32_bf16 v[148:151], a[84:87], a[156:159], v[148:151]
    s_waitcnt lgkmcnt(12)
    ds_read_b64_tr_b16 a[116:117], v77 offset:26696
    ds_read_b64_tr_b16 a[118:119], v77 offset:27208
    v_mfma_f32_16x16x32_bf16 v[160:163], a[88:91], a[156:159], v[160:163]
    v_mfma_f32_16x16x32_bf16 v[164:167], a[88:91], a[160:163], v[164:167]
    s_add_u32 m0, s58, 64672
    v_mfma_f32_16x16x32_bf16 v[168:171], a[88:91], a[164:167], v[168:171]
    s_waitcnt lgkmcnt(12)
    buffer_load_dwordx4 v71, s[4:7], s33 offen offset:0  lds
    v_mfma_f32_16x16x32_bf16 v[180:183], a[92:95], a[164:167], v[180:183]
    v_mfma_f32_16x16x32_bf16 v[176:179], a[92:95], a[160:163], v[176:179]
    v_mfma_f32_16x16x32_bf16 v[172:175], a[92:95], a[156:159], v[172:175]
    s_waitcnt lgkmcnt(10)
    buffer_load_dwordx4 v72, s[4:7], s33 offen offset:1024  lds
    v_mfma_f32_16x16x32_bf16 v[184:187], a[96:99], a[156:159], v[184:187]
    v_mfma_f32_16x16x32_bf16 v[188:191], a[96:99], a[160:163], v[188:191]
    v_mfma_f32_16x16x32_bf16 v[192:195], a[96:99], a[164:167], v[192:195]
    s_waitcnt lgkmcnt(8)
    buffer_load_dwordx4 v73, s[4:7], s33 offen offset:2048  lds
    v_mfma_f32_16x16x32_bf16 v[204:207], a[100:103], a[164:167], v[204:207]
    s_add_u32 s33, s33, 128
    v_mfma_f32_16x16x32_bf16 v[200:203], a[100:103], a[160:163], v[200:203]
    s_cmp_eq_u32 s33, 1280
    s_cselect_b32 s33, 128, s33
    v_mfma_f32_16x16x32_bf16 v[196:199], a[100:103], a[156:159], v[196:199]
    s_waitcnt lgkmcnt(6)
    v_mfma_f32_16x16x32_bf16 v[208:211], a[104:107], a[156:159], v[208:211]
    s_waitcnt vmcnt(19) lgkmcnt(0)
    s_barrier
    v_mfma_f32_16x16x32_bf16 v[212:215], a[104:107], a[160:163], v[212:215]
    s_add_u32 m0, s99, 110880
    ds_read_b128 a[120:123], v80 offset:0
    ds_read_b128 a[124:127], v80 offset:2048
    v_mfma_f32_16x16x32_bf16 v[216:219], a[104:107], a[164:167], v[216:219]
    buffer_load_dwordx4 v64, s[8:11], s32 offen  lds
    v_mfma_f32_16x16x32_bf16 v[228:231], a[108:111], a[164:167], v[228:231]
    s_add_u32 m0, s99, 111904
    ds_read_b128 a[128:131], v80 offset:4096
    v_mfma_f32_16x16x32_bf16 v[224:227], a[108:111], a[160:163], v[224:227]
    buffer_load_dwordx4 v65, s[8:11], s32 offen  lds
    v_mfma_f32_16x16x32_bf16 v[220:223], a[108:111], a[156:159], v[220:223]
    ds_read_b64_tr_b16 a[72:73], v76 offset:61600
    ds_read_b64_tr_b16 a[74:75], v76 offset:62112
    v_mfma_f32_16x16x32_bf16 v[232:235], a[112:115], a[156:159], v[232:235]
    v_mfma_f32_16x16x32_bf16 v[236:239], a[112:115], a[160:163], v[236:239]
    s_add_u32 m0, s99, 112928
    ds_read_b64_tr_b16 a[76:77], v76 offset:61608
    ds_read_b64_tr_b16 a[78:79], v76 offset:62120
    v_mfma_f32_16x16x32_bf16 v[240:243], a[112:115], a[164:167], v[240:243]
    buffer_load_dwordx4 v66, s[8:11], s32 offen  lds
    v_mfma_f32_16x16x32_bf16 v[252:255], a[116:119], a[164:167], v[252:255]
    s_add_u32 s32, s32, 393216
    ds_read_b64_tr_b16 a[80:81], v77 offset:61600
    ds_read_b64_tr_b16 a[82:83], v77 offset:62112
    v_mfma_f32_16x16x32_bf16 v[248:251], a[116:119], a[160:163], v[248:251]
    s_cmp_eq_u32 s32, 7864320
    s_cselect_b32 s32, 786432, s32
    v_mfma_f32_16x16x32_bf16 v[244:247], a[116:119], a[156:159], v[244:247]
    s_waitcnt lgkmcnt(4)
    ds_read_b64_tr_b16 a[84:85], v77 offset:61608
    ds_read_b64_tr_b16 a[86:87], v77 offset:62120
    v_mfma_f32_16x16x32_bf16 v[112:115], a[72:75], a[120:123], v[112:115]
    s_add_u32 s39, s34, 0
    s_add_u32 m0, s34, 123200
    s_nop 0
    buffer_load_dwordx4 v24, s[16:19], s39 offen offset:1024 nt lds
    v_mfma_f32_16x16x32_bf16 v[116:119], a[72:75], a[124:127], v[116:119]
    ds_read_b64_tr_b16 a[88:89], v76 offset:62624
    ds_read_b64_tr_b16 a[90:91], v76 offset:63136
    v_mfma_f32_16x16x32_bf16 v[120:123], a[72:75], a[128:131], v[120:123]
    s_waitcnt lgkmcnt(6)
    buffer_load_dwordx4 v25, s[16:19], s39 offen offset:2048 nt lds
    v_mfma_f32_16x16x32_bf16 v[132:135], a[76:79], a[128:131], v[132:135]
    ds_read_b64_tr_b16 a[92:93], v76 offset:62632
    ds_read_b64_tr_b16 a[94:95], v76 offset:63144
    v_mfma_f32_16x16x32_bf16 v[128:131], a[76:79], a[124:127], v[128:131]
    s_add_u32 s39, s34, 24576
    v_mfma_f32_16x16x32_bf16 v[124:127], a[76:79], a[120:123], v[124:127]
    s_waitcnt lgkmcnt(6)
    s_add_u32 m0, s34, 24640
    ds_read_b64_tr_b16 a[96:97], v77 offset:62624
    ds_read_b64_tr_b16 a[98:99], v77 offset:63136
    v_mfma_f32_16x16x32_bf16 v[136:139], a[80:83], a[120:123], v[136:139]
    buffer_load_dwordx4 v20, s[12:15], s39 offen offset:0 nt lds
    v_mfma_f32_16x16x32_bf16 v[140:143], a[80:83], a[124:127], v[140:143]
    ds_read_b64_tr_b16 a[100:101], v77 offset:62632
    ds_read_b64_tr_b16 a[102:103], v77 offset:63144
    v_mfma_f32_16x16x32_bf16 v[144:147], a[80:83], a[128:131], v[144:147]
    s_waitcnt lgkmcnt(8)
    v_mfma_f32_16x16x32_bf16 v[156:159], a[84:87], a[128:131], v[156:159]
    ds_read_b64_tr_b16 a[104:105], v76 offset:63648
    ds_read_b64_tr_b16 a[106:107], v76 offset:64160
    v_mfma_f32_16x16x32_bf16 v[152:155], a[84:87], a[124:127], v[152:155]
    buffer_load_dwordx4 v21, s[12:15], s39 offen offset:1024 nt lds
    v_mfma_f32_16x16x32_bf16 v[148:151], a[84:87], a[120:123], v[148:151]
    s_waitcnt lgkmcnt(8)
    ds_read_b64_tr_b16 a[108:109], v76 offset:63656
    ds_read_b64_tr_b16 a[110:111], v76 offset:64168
    v_mfma_f32_16x16x32_bf16 v[160:163], a[88:91], a[120:123], v[160:163]
    v_mfma_f32_16x16x32_bf16 v[164:167], a[88:91], a[124:127], v[164:167]
    ds_read_b64_tr_b16 a[112:113], v77 offset:63648
    ds_read_b64_tr_b16 a[114:115], v77 offset:64160
    v_mfma_f32_16x16x32_bf16 v[168:171], a[88:91], a[128:131], v[168:171]
    s_waitcnt lgkmcnt(10)
    buffer_load_dwordx4 v22, s[12:15], s39 offen offset:2048 nt lds
    v_mfma_f32_16x16x32_bf16 v[180:183], a[92:95], a[128:131], v[180:183]
    ds_read_b64_tr_b16 a[116:117], v77 offset:63656
    ds_read_b64_tr_b16 a[118:119], v77 offset:64168
    v_mfma_f32_16x16x32_bf16 v[176:179], a[92:95], a[124:127], v[176:179]
    s_add_u32 s39, s34, 12288
    v_mfma_f32_16x16x32_bf16 v[172:175], a[92:95], a[120:123], v[172:175]
    s_waitcnt lgkmcnt(10)
    s_add_u32 m0, s34, 135520
    ds_read_b128 a[132:135], v81 offset:0
    ds_read_b128 a[136:139], v81 offset:2048
    v_mfma_f32_16x16x32_bf16 v[184:187], a[96:99], a[120:123], v[184:187]
    buffer_load_dwordx4 v23, s[16:19], s39 offen offset:0 nt lds
    v_mfma_f32_16x16x32_bf16 v[188:191], a[96:99], a[124:127], v[188:191]
    ds_read_b128 a[140:143], v81 offset:4096
    v_mfma_f32_16x16x32_bf16 v[192:195], a[96:99], a[128:131], v[192:195]
    s_waitcnt lgkmcnt(11)
    v_mfma_f32_16x16x32_bf16 v[204:207], a[100:103], a[128:131], v[204:207]
    buffer_load_dwordx4 v24, s[16:19], s39 offen offset:1024 nt lds
    v_mfma_f32_16x16x32_bf16 v[200:203], a[100:103], a[124:127], v[200:203]
    v_mfma_f32_16x16x32_bf16 v[196:199], a[100:103], a[120:123], v[196:199]
    s_waitcnt lgkmcnt(9)
    v_mfma_f32_16x16x32_bf16 v[208:211], a[104:107], a[120:123], v[208:211]
    s_waitcnt vmcnt(19) lgkmcnt(0)
    s_barrier
    v_mfma_f32_16x16x32_bf16 v[212:215], a[104:107], a[124:127], v[212:215]
    s_add_u32 m0, s99, 147840
    ds_read_b64_tr_b16 a[72:73], v76 offset:0
    ds_read_b64_tr_b16 a[74:75], v76 offset:512
    v_mfma_f32_16x16x32_bf16 v[216:219], a[104:107], a[128:131], v[216:219]
    buffer_load_dwordx4 v64, s[8:11], s32 offen  lds
    v_mfma_f32_16x16x32_bf16 v[228:231], a[108:111], a[128:131], v[228:231]
    s_add_u32 m0, s99, 148864
    ds_read_b64_tr_b16 a[76:77], v76 offset:8
    ds_read_b64_tr_b16 a[78:79], v76 offset:520
    v_mfma_f32_16x16x32_bf16 v[224:227], a[108:111], a[124:127], v[224:227]
    buffer_load_dwordx4 v65, s[8:11], s32 offen  lds
    v_mfma_f32_16x16x32_bf16 v[220:223], a[108:111], a[120:123], v[220:223]
    ds_read_b64_tr_b16 a[80:81], v77 offset:0
    ds_read_b64_tr_b16 a[82:83], v77 offset:512
    v_mfma_f32_16x16x32_bf16 v[232:235], a[112:115], a[120:123], v[232:235]
    v_mfma_f32_16x16x32_bf16 v[236:239], a[112:115], a[124:127], v[236:239]
    s_add_u32 m0, s99, 149888
    ds_read_b64_tr_b16 a[84:85], v77 offset:8
    ds_read_b64_tr_b16 a[86:87], v77 offset:520
    v_mfma_f32_16x16x32_bf16 v[240:243], a[112:115], a[128:131], v[240:243]
    buffer_load_dwordx4 v66, s[8:11], s32 offen  lds
    v_mfma_f32_16x16x32_bf16 v[252:255], a[116:119], a[128:131], v[252:255]
    s_add_u32 s32, s32, 393216
    ds_read_b64_tr_b16 a[88:89], v76 offset:1024
    ds_read_b64_tr_b16 a[90:91], v76 offset:1536
    v_mfma_f32_16x16x32_bf16 v[248:251], a[116:119], a[124:127], v[248:251]
    s_cmp_eq_u32 s32, 7864320
    s_cselect_b32 s32, 786432, s32
    v_mfma_f32_16x16x32_bf16 v[244:247], a[116:119], a[120:123], v[244:247]
    s_waitcnt lgkmcnt(8)
    ds_read_b64_tr_b16 a[92:93], v76 offset:1032
    ds_read_b64_tr_b16 a[94:95], v76 offset:1544
    v_mfma_f32_16x16x32_bf16 v[112:115], a[72:75], a[132:135], v[112:115]
    s_add_u32 m0, s58, 36960
    s_nop 0
    buffer_load_dwordx4 v68, s[4:7], s33 offen offset:0  lds
    v_mfma_f32_16x16x32_bf16 v[116:119], a[72:75], a[136:139], v[116:119]
    ds_read_b64_tr_b16 a[96:97], v77 offset:1024
    ds_read_b64_tr_b16 a[98:99], v77 offset:1536
    v_mfma_f32_16x16x32_bf16 v[120:123], a[72:75], a[140:143], v[120:123]
    s_waitcnt lgkmcnt(10)
    v_mfma_f32_16x16x32_bf16 v[132:135], a[76:79], a[140:143], v[132:135]
    ds_read_b64_tr_b16 a[100:101], v77 offset:1032
    ds_read_b64_tr_b16 a[102:103], v77 offset:1544
    v_mfma_f32_16x16x32_bf16 v[128:131], a[76:79], a[136:139], v[128:131]
    buffer_load_dwordx4 v69, s[4:7], s33 offen offset:1024  lds
    v_mfma_f32_16x16x32_bf16 v[124:127], a[76:79], a[132:135], v[124:127]
    s_waitcnt lgkmcnt(10)
    ds_read_b64_tr_b16 a[104:105], v76 offset:2048
    ds_read_b64_tr_b16 a[106:107], v76 offset:2560
    v_mfma_f32_16x16x32_bf16 v[136:139], a[80:83], a[132:135], v[136:139]
    v_mfma_f32_16x16x32_bf16 v[140:143], a[80:83], a[136:139], v[140:143]
    ds_read_b64_tr_b16 a[108:109], v76 offset:2056
    ds_read_b64_tr_b16 a[110:111], v76 offset:2568
    v_mfma_f32_16x16x32_bf16 v[144:147], a[80:83], a[140:143], v[144:147]
    s_waitcnt lgkmcnt(12)
    v_mfma_f32_16x16x32_bf16 v[156:159], a[84:87], a[140:143], v[156:159]
    ds_read_b64_tr_b16 a[112:113], v77 offset:2048
    ds_read_b64_tr_b16 a[114:115], v77 offset:2560
    v_mfma_f32_16x16x32_bf16 v[152:155], a[84:87], a[136:139], v[152:155]
    buffer_load_dwordx4 v70, s[4:7], s33 offen offset:2048  lds
    v_mfma_f32_16x16x32_bf16 v[148:151], a[84:87], a[132:135], v[148:151]
    s_waitcnt lgkmcnt(12)
    ds_read_b64_tr_b16 a[116:117], v77 offset:2056
    ds_read_b64_tr_b16 a[118:119], v77 offset:2568
    v_mfma_f32_16x16x32_bf16 v[160:163], a[88:91], a[132:135], v[160:163]
    v_mfma_f32_16x16x32_bf16 v[164:167], a[88:91], a[136:139], v[164:167]
    s_add_u32 m0, s58, 40032
    v_mfma_f32_16x16x32_bf16 v[168:171], a[88:91], a[140:143], v[168:171]
    s_waitcnt lgkmcnt(12)
    buffer_load_dwordx4 v71, s[4:7], s33 offen offset:0  lds
    v_mfma_f32_16x16x32_bf16 v[180:183], a[92:95], a[140:143], v[180:183]
    v_mfma_f32_16x16x32_bf16 v[176:179], a[92:95], a[136:139], v[176:179]
    v_mfma_f32_16x16x32_bf16 v[172:175], a[92:95], a[132:135], v[172:175]
    s_waitcnt lgkmcnt(10)
    buffer_load_dwordx4 v72, s[4:7], s33 offen offset:1024  lds
    v_mfma_f32_16x16x32_bf16 v[184:187], a[96:99], a[132:135], v[184:187]
    v_mfma_f32_16x16x32_bf16 v[188:191], a[96:99], a[136:139], v[188:191]
    v_mfma_f32_16x16x32_bf16 v[192:195], a[96:99], a[140:143], v[192:195]
    s_waitcnt lgkmcnt(8)
    buffer_load_dwordx4 v73, s[4:7], s33 offen offset:2048  lds
    v_mfma_f32_16x16x32_bf16 v[204:207], a[100:103], a[140:143], v[204:207]
    s_add_u32 s33, s33, 128
    v_mfma_f32_16x16x32_bf16 v[200:203], a[100:103], a[136:139], v[200:203]
    s_cmp_eq_u32 s33, 1280
    s_cselect_b32 s33, 128, s33
    v_mfma_f32_16x16x32_bf16 v[196:199], a[100:103], a[132:135], v[196:199]
    s_waitcnt lgkmcnt(6)
    v_mfma_f32_16x16x32_bf16 v[208:211], a[104:107], a[132:135], v[208:211]
    s_waitcnt vmcnt(19) lgkmcnt(0)
    s_barrier
    v_mfma_f32_16x16x32_bf16 v[212:215], a[104:107], a[136:139], v[212:215]
    s_add_u32 m0, s99, 86240
    ds_read_b128 a[144:147], v80 offset:24640
    ds_read_b128 a[148:151], v80 offset:26688
    v_mfma_f32_16x16x32_bf16 v[216:219], a[104:107], a[140:143], v[216:219]
    buffer_load_dwordx4 v64, s[8:11], s32 offen  lds
    v_mfma_f32_16x16x32_bf16 v[228:231], a[108:111], a[140:143], v[228:231]
    s_add_u32 m0, s99, 87264
    ds_read_b128 a[152:155], v80 offset:28736
    v_mfma_f32_16x16x32_bf16 v[224:227], a[108:111], a[136:139], v[224:227]
    buffer_load_dwordx4 v65, s[8:11], s32 offen  lds
    v_mfma_f32_16x16x32_bf16 v[220:223], a[108:111], a[132:135], v[220:223]
    ds_read_b64_tr_b16 a[72:73], v76 offset:12320
    ds_read_b64_tr_b16 a[74:75], v76 offset:12832
    v_mfma_f32_16x16x32_bf16 v[232:235], a[112:115], a[132:135], v[232:235]
    v_mfma_f32_16x16x32_bf16 v[236:239], a[112:115], a[136:139], v[236:239]
    s_add_u32 m0, s99, 88288
    ds_read_b64_tr_b16 a[76:77], v76 offset:12328
    ds_read_b64_tr_b16 a[78:79], v76 offset:12840
    v_mfma_f32_16x16x32_bf16 v[240:243], a[112:115], a[140:143], v[240:243]
    buffer_load_dwordx4 v66, s[8:11], s32 offen  lds
    v_mfma_f32_16x16x32_bf16 v[252:255], a[116:119], a[140:143], v[252:255]
    s_add_u32 s32, s32, 393216
    ds_read_b64_tr_b16 a[80:81], v77 offset:12320
    ds_read_b64_tr_b16 a[82:83], v77 offset:12832
    v_mfma_f32_16x16x32_bf16 v[248:251], a[116:119], a[136:139], v[248:251]
    s_cmp_eq_u32 s32, 7864320
    s_cselect_b32 s32, 786432, s32
    v_mfma_f32_16x16x32_bf16 v[244:247], a[116:119], a[132:135], v[244:247]
    s_waitcnt lgkmcnt(4)
    ds_read_b64_tr_b16 a[84:85], v77 offset:12328
    ds_read_b64_tr_b16 a[86:87], v77 offset:12840
    v_mfma_f32_16x16x32_bf16 v[112:115], a[72:75], a[144:147], v[112:115]
    v_mfma_f32_16x16x32_bf16 v[116:119], a[72:75], a[148:151], v[116:119]
    ds_read_b64_tr_b16 a[88:89], v76 offset:13344
    ds_read_b64_tr_b16 a[90:91], v76 offset:13856
    v_mfma_f32_16x16x32_bf16 v[120:123], a[72:75], a[152:155], v[120:123]
    s_waitcnt lgkmcnt(6)
    v_mfma_f32_16x16x32_bf16 v[132:135], a[76:79], a[152:155], v[132:135]
    ds_read_b64_tr_b16 a[92:93], v76 offset:13352
    ds_read_b64_tr_b16 a[94:95], v76 offset:13864
    v_mfma_f32_16x16x32_bf16 v[128:131], a[76:79], a[148:151], v[128:131]
    v_mfma_f32_16x16x32_bf16 v[124:127], a[76:79], a[144:147], v[124:127]
    s_waitcnt lgkmcnt(6)
    ds_read_b64_tr_b16 a[96:97], v77 offset:13344
    ds_read_b64_tr_b16 a[98:99], v77 offset:13856
    v_mfma_f32_16x16x32_bf16 v[136:139], a[80:83], a[144:147], v[136:139]
    v_mfma_f32_16x16x32_bf16 v[140:143], a[80:83], a[148:151], v[140:143]
    ds_read_b64_tr_b16 a[100:101], v77 offset:13352
    ds_read_b64_tr_b16 a[102:103], v77 offset:13864
    v_mfma_f32_16x16x32_bf16 v[144:147], a[80:83], a[152:155], v[144:147]
    s_waitcnt lgkmcnt(8)
    v_mfma_f32_16x16x32_bf16 v[156:159], a[84:87], a[152:155], v[156:159]
    ds_read_b64_tr_b16 a[104:105], v76 offset:14368
    ds_read_b64_tr_b16 a[106:107], v76 offset:14880
    v_mfma_f32_16x16x32_bf16 v[152:155], a[84:87], a[148:151], v[152:155]
    v_mfma_f32_16x16x32_bf16 v[148:151], a[84:87], a[144:147], v[148:151]
    s_waitcnt lgkmcnt(8)
    ds_read_b64_tr_b16 a[108:109], v76 offset:14376
    ds_read_b64_tr_b16 a[110:111], v76 offset:14888
    v_mfma_f32_16x16x32_bf16 v[160:163], a[88:91], a[144:147], v[160:163]
    v_mfma_f32_16x16x32_bf16 v[164:167], a[88:91], a[148:151], v[164:167]
    ds_read_b64_tr_b16 a[112:113], v77 offset:14368
    ds_read_b64_tr_b16 a[114:115], v77 offset:14880
    v_mfma_f32_16x16x32_bf16 v[168:171], a[88:91], a[152:155], v[168:171]
    s_waitcnt lgkmcnt(10)
    v_mfma_f32_16x16x32_bf16 v[180:183], a[92:95], a[152:155], v[180:183]
    ds_read_b64_tr_b16 a[116:117], v77 offset:14376
    ds_read_b64_tr_b16 a[118:119], v77 offset:14888
    v_mfma_f32_16x16x32_bf16 v[176:179], a[92:95], a[148:151], v[176:179]
    v_mfma_f32_16x16x32_bf16 v[172:175], a[92:95], a[144:147], v[172:175]
    s_waitcnt lgkmcnt(10)
    ds_read_b128 a[156:159], v81 offset:24640
    ds_read_b128 a[160:163], v81 offset:26688
    v_mfma_f32_16x16x32_bf16 v[184:187], a[96:99], a[144:147], v[184:187]
    v_mfma_f32_16x16x32_bf16 v[188:191], a[96:99], a[148:151], v[188:191]
    ds_read_b128 a[164:167], v81 offset:28736
    v_mfma_f32_16x16x32_bf16 v[192:195], a[96:99], a[152:155], v[192:195]
    s_waitcnt lgkmcnt(11)
    v_mfma_f32_16x16x32_bf16 v[204:207], a[100:103], a[152:155], v[204:207]
    v_mfma_f32_16x16x32_bf16 v[200:203], a[100:103], a[148:151], v[200:203]
    v_mfma_f32_16x16x32_bf16 v[196:199], a[100:103], a[144:147], v[196:199]
    s_waitcnt lgkmcnt(9)
    v_mfma_f32_16x16x32_bf16 v[208:211], a[104:107], a[144:147], v[208:211]
    s_waitcnt vmcnt(19) lgkmcnt(0)
    s_barrier
    v_mfma_f32_16x16x32_bf16 v[212:215], a[104:107], a[148:151], v[212:215]
    s_add_u32 m0, s99, 98560
    ds_read_b64_tr_b16 a[72:73], v76 offset:24640
    ds_read_b64_tr_b16 a[74:75], v76 offset:25152
    v_mfma_f32_16x16x32_bf16 v[216:219], a[104:107], a[152:155], v[216:219]
    buffer_load_dwordx4 v64, s[8:11], s32 offen  lds
    v_mfma_f32_16x16x32_bf16 v[228:231], a[108:111], a[152:155], v[228:231]
    s_add_u32 m0, s99, 99584
    ds_read_b64_tr_b16 a[76:77], v76 offset:24648
    ds_read_b64_tr_b16 a[78:79], v76 offset:25160
    v_mfma_f32_16x16x32_bf16 v[224:227], a[108:111], a[148:151], v[224:227]
    buffer_load_dwordx4 v65, s[8:11], s32 offen  lds
    v_mfma_f32_16x16x32_bf16 v[220:223], a[108:111], a[144:147], v[220:223]
    ds_read_b64_tr_b16 a[80:81], v77 offset:24640
    ds_read_b64_tr_b16 a[82:83], v77 offset:25152
    v_mfma_f32_16x16x32_bf16 v[232:235], a[112:115], a[144:147], v[232:235]
    v_mfma_f32_16x16x32_bf16 v[236:239], a[112:115], a[148:151], v[236:239]
    s_add_u32 m0, s99, 100608
    ds_read_b64_tr_b16 a[84:85], v77 offset:24648
    ds_read_b64_tr_b16 a[86:87], v77 offset:25160
    v_mfma_f32_16x16x32_bf16 v[240:243], a[112:115], a[152:155], v[240:243]
    buffer_load_dwordx4 v66, s[8:11], s32 offen  lds
    v_mfma_f32_16x16x32_bf16 v[252:255], a[116:119], a[152:155], v[252:255]
    s_add_u32 s32, s32, 393216
    ds_read_b64_tr_b16 a[88:89], v76 offset:25664
    ds_read_b64_tr_b16 a[90:91], v76 offset:26176
    v_mfma_f32_16x16x32_bf16 v[248:251], a[116:119], a[148:151], v[248:251]
    s_cmp_eq_u32 s32, 7864320
    s_cselect_b32 s32, 786432, s32
    v_mfma_f32_16x16x32_bf16 v[244:247], a[116:119], a[144:147], v[244:247]
    s_waitcnt lgkmcnt(8)
    ds_read_b64_tr_b16 a[92:93], v76 offset:25672
    ds_read_b64_tr_b16 a[94:95], v76 offset:26184
    v_mfma_f32_16x16x32_bf16 v[112:115], a[72:75], a[156:159], v[112:115]
    s_add_u32 m0, s58, 61600
    s_nop 0
    buffer_load_dwordx4 v68, s[4:7], s33 offen offset:0  lds
    v_mfma_f32_16x16x32_bf16 v[116:119], a[72:75], a[160:163], v[116:119]
    ds_read_b64_tr_b16 a[96:97], v77 offset:25664
    ds_read_b64_tr_b16 a[98:99], v77 offset:26176
    v_mfma_f32_16x16x32_bf16 v[120:123], a[72:75], a[164:167], v[120:123]
    s_waitcnt lgkmcnt(10)
    buffer_load_dwordx4 v69, s[4:7], s33 offen offset:1024  lds
    v_mfma_f32_16x16x32_bf16 v[132:135], a[76:79], a[164:167], v[132:135]
    ds_read_b64_tr_b16 a[100:101], v77 offset:25672
    ds_read_b64_tr_b16 a[102:103], v77 offset:26184
    v_mfma_f32_16x16x32_bf16 v[128:131], a[76:79], a[160:163], v[128:131]
    v_mfma_f32_16x16x32_bf16 v[124:127], a[76:79], a[156:159], v[124:127]
    s_waitcnt lgkmcnt(10)
    ds_read_b64_tr_b16 a[104:105], v76 offset:26688
    ds_read_b64_tr_b16 a[106:107], v76 offset:27200
    v_mfma_f32_16x16x32_bf16 v[136:139], a[80:83], a[156:159], v[136:139]
    buffer_load_dwordx4 v70, s[4:7], s33 offen offset:2048  lds
    v_mfma_f32_16x16x32_bf16 v[140:143], a[80:83], a[160:163], v[140:143]
    ds_read_b64_tr_b16 a[108:109], v76 offset:26696
    ds_read_b64_tr_b16 a[110:111], v76 offset:27208
    v_mfma_f32_16x16x32_bf16 v[144:147], a[80:83], a[164:167], v[144:147]
    s_waitcnt lgkmcnt(12)
    v_mfma_f32_16x16x32_bf16 v[156:159], a[84:87], a[164:167], v[156:159]
    s_add_u32 m0, s58, 64672
    ds_read_b64_tr_b16 a[112:113], v77 offset:26688
    ds_read_b64_tr_b16 a[114:115], v77 offset:27200
    v_mfma_f32_16x16x32_bf16 v[152:155], a[84:87], a[160:163], v[152:155]
    buffer_load_dwordx4 v71, s[4:7], s33 offen offset:0  lds
    v_mfma_f32_16x16x32_bf16 v[148:151], a[84:87], a[156:159], v[148:151]
    s_waitcnt lgkmcnt(12)
    ds_read_b64_tr_b16 a[116:117], v77 offset:26696
    ds_read_b64_tr_b16 a[118:119], v77 offset:27208
    v_mfma_f32_16x16x32_bf16 v[160:163], a[88:91], a[156:159], v[160:163]
    v_mfma_f32_16x16x32_bf16 v[164:167], a[88:91], a[160:163], v[164:167]
    buffer_load_dwordx4 v72, s[4:7], s33 offen offset:1024  lds
    v_mfma_f32_16x16x32_bf16 v[168:171], a[88:91], a[164:167], v[168:171]
    s_waitcnt lgkmcnt(12)
    v_mfma_f32_16x16x32_bf16 v[180:183], a[92:95], a[164:167], v[180:183]
    buffer_load_dwordx4 v73, s[4:7], s33 offen offset:2048  lds
    v_mfma_f32_16x16x32_bf16 v[176:179], a[92:95], a[160:163], v[176:179]
    s_add_u32 s33, s33, 128
    v_mfma_f32_16x16x32_bf16 v[172:175], a[92:95], a[156:159], v[172:175]
    s_waitcnt lgkmcnt(10)
    s_cmp_eq_u32 s33, 1280
    s_cselect_b32 s33, 128, s33
    s_add_u32 s39, s34, 12288
    s_add_u32 m0, s34, 135520
    s_nop 0
    buffer_load_dwordx4 v25, s[16:19], s39 offen offset:2048 nt lds
    v_mfma_f32_16x16x32_bf16 v[184:187], a[96:99], a[156:159], v[184:187]
    s_add_u32 s38, s34, 36864
    v_mfma_f32_16x16x32_bf16 v[188:191], a[96:99], a[160:163], v[188:191]
    buffer_load_dwordx4 a[168:171], v20, s[12:15], s38 offen offset:0 nt
    v_mfma_f32_16x16x32_bf16 v[192:195], a[96:99], a[164:167], v[192:195]
    s_waitcnt lgkmcnt(8)
    s_add_u32 s38, s34, 36864
    v_mfma_f32_16x16x32_bf16 v[204:207], a[100:103], a[164:167], v[204:207]
    buffer_load_dwordx4 a[172:175], v21, s[12:15], s38 offen offset:1024 nt
    v_mfma_f32_16x16x32_bf16 v[200:203], a[100:103], a[160:163], v[200:203]
    v_mfma_f32_16x16x32_bf16 v[196:199], a[100:103], a[156:159], v[196:199]
    s_waitcnt lgkmcnt(6)
    v_mfma_f32_16x16x32_bf16 v[208:211], a[104:107], a[156:159], v[208:211]
    s_waitcnt vmcnt(15) lgkmcnt(0)
    s_barrier
    v_mfma_f32_16x16x32_bf16 v[212:215], a[104:107], a[160:163], v[212:215]
    s_add_u32 s38, s34, 36864
    ds_read_b128 a[120:123], v80 offset:0
    ds_read_b128 a[124:127], v80 offset:2048
    v_mfma_f32_16x16x32_bf16 v[216:219], a[104:107], a[164:167], v[216:219]
    buffer_load_dwordx4 a[176:179], v22, s[12:15], s38 offen offset:2048 nt
    v_mfma_f32_16x16x32_bf16 v[228:231], a[108:111], a[164:167], v[228:231]
    s_add_u32 s38, s34, 24576
    ds_read_b128 a[128:131], v80 offset:4096
    v_mfma_f32_16x16x32_bf16 v[224:227], a[108:111], a[160:163], v[224:227]
    buffer_load_dwordx4 a[180:183], v23, s[16:19], s38 offen offset:0 nt
    v_mfma_f32_16x16x32_bf16 v[220:223], a[108:111], a[156:159], v[220:223]
    ds_read_b64_tr_b16 a[72:73], v76 offset:61600
    ds_read_b64_tr_b16 a[74:75], v76 offset:62112
    v_mfma_f32_16x16x32_bf16 v[232:235], a[112:115], a[156:159], v[232:235]
    v_mfma_f32_16x16x32_bf16 v[236:239], a[112:115], a[160:163], v[236:239]
    s_add_u32 s38, s34, 24576
    ds_read_b64_tr_b16 a[76:77], v76 offset:61608
    ds_read_b64_tr_b16 a[78:79], v76 offset:62120
    v_mfma_f32_16x16x32_bf16 v[240:243], a[112:115], a[164:167], v[240:243]
    buffer_load_dwordx4 a[184:187], v24, s[16:19], s38 offen offset:1024 nt
    v_mfma_f32_16x16x32_bf16 v[252:255], a[116:119], a[164:167], v[252:255]
    ds_read_b64_tr_b16 a[80:81], v77 offset:61600
    ds_read_b64_tr_b16 a[82:83], v77 offset:62112
    v_mfma_f32_16x16x32_bf16 v[248:251], a[116:119], a[160:163], v[248:251]
    v_mfma_f32_16x16x32_bf16 v[244:247], a[116:119], a[156:159], v[244:247]
    s_waitcnt lgkmcnt(4)
    ds_read_b64_tr_b16 a[84:85], v77 offset:61608
    ds_read_b64_tr_b16 a[86:87], v77 offset:62120
    v_mfma_f32_16x16x32_bf16 v[112:115], a[72:75], a[120:123], v[112:115]
    s_add_u32 s38, s34, 24576
    buffer_load_dwordx4 a[188:191], v25, s[16:19], s38 offen offset:2048 nt
    v_mfma_f32_16x16x32_bf16 v[116:119], a[72:75], a[124:127], v[116:119]
    ds_read_b64_tr_b16 a[88:89], v76 offset:62624
    ds_read_b64_tr_b16 a[90:91], v76 offset:63136
    v_mfma_f32_16x16x32_bf16 v[120:123], a[72:75], a[128:131], v[120:123]
    s_waitcnt lgkmcnt(6)
    v_mfma_f32_16x16x32_bf16 v[132:135], a[76:79], a[128:131], v[132:135]
    ds_read_b64_tr_b16 a[92:93], v76 offset:62632
    ds_read_b64_tr_b16 a[94:95], v76 offset:63144
    v_mfma_f32_16x16x32_bf16 v[128:131], a[76:79], a[124:127], v[128:131]
    v_mfma_f32_16x16x32_bf16 v[124:127], a[76:79], a[120:123], v[124:127]
    s_waitcnt lgkmcnt(6)
    s_add_u32 m0, s99, 110880
    ds_read_b64_tr_b16 a[96:97], v77 offset:62624
    ds_read_b64_tr_b16 a[98:99], v77 offset:63136
    v_mfma_f32_16x16x32_bf16 v[136:139], a[80:83], a[120:123], v[136:139]
    buffer_load_dwordx4 v64, s[8:11], s32 offen  lds
    v_mfma_f32_16x16x32_bf16 v[140:143], a[80:83], a[124:127], v[140:143]
    ds_read_b64_tr_b16 a[100:101], v77 offset:62632
    ds_read_b64_tr_b16 a[102:103], v77 offset:63144
    v_mfma_f32_16x16x32_bf16 v[144:147], a[80:83], a[128:131], v[144:147]
    s_waitcnt lgkmcnt(8)
    v_mfma_f32_16x16x32_bf16 v[156:159], a[84:87], a[128:131], v[156:159]
    ds_read_b64_tr_b16 a[104:105], v76 offset:63648
    ds_read_b64_tr_b16 a[106:107], v76 offset:64160
    v_mfma_f32_16x16x32_bf16 v[152:155], a[84:87], a[124:127], v[152:155]
    v_mfma_f32_16x16x32_bf16 v[148:151], a[84:87], a[120:123], v[148:151]
    s_waitcnt lgkmcnt(8)
    s_add_u32 m0, s99, 111904
    ds_read_b64_tr_b16 a[108:109], v76 offset:63656
    ds_read_b64_tr_b16 a[110:111], v76 offset:64168
    v_mfma_f32_16x16x32_bf16 v[160:163], a[88:91], a[120:123], v[160:163]
    buffer_load_dwordx4 v65, s[8:11], s32 offen  lds
    v_mfma_f32_16x16x32_bf16 v[164:167], a[88:91], a[124:127], v[164:167]
    ds_read_b64_tr_b16 a[112:113], v77 offset:63648
    ds_read_b64_tr_b16 a[114:115], v77 offset:64160
    v_mfma_f32_16x16x32_bf16 v[168:171], a[88:91], a[128:131], v[168:171]
    s_waitcnt lgkmcnt(10)
    v_mfma_f32_16x16x32_bf16 v[180:183], a[92:95], a[128:131], v[180:183]
    ds_read_b64_tr_b16 a[116:117], v77 offset:63656
    ds_read_b64_tr_b16 a[118:119], v77 offset:64168
    v_mfma_f32_16x16x32_bf16 v[176:179], a[92:95], a[124:127], v[176:179]
    v_mfma_f32_16x16x32_bf16 v[172:175], a[92:95], a[120:123], v[172:175]
    s_waitcnt lgkmcnt(10)
    s_add_u32 m0, s99, 112928
    ds_read_b128 a[132:135], v81 offset:0
    ds_read_b128 a[136:139], v81 offset:2048
    v_mfma_f32_16x16x32_bf16 v[184:187], a[96:99], a[120:123], v[184:187]
    buffer_load_dwordx4 v66, s[8:11], s32 offen  lds
    v_mfma_f32_16x16x32_bf16 v[188:191], a[96:99], a[124:127], v[188:191]
    s_add_u32 s32, s32, 393216
    ds_read_b128 a[140:143], v81 offset:4096
    v_mfma_f32_16x16x32_bf16 v[192:195], a[96:99], a[128:131], v[192:195]
    s_waitcnt lgkmcnt(11)
    s_cmp_eq_u32 s32, 7864320
    s_cselect_b32 s32, 786432, s32
    v_mfma_f32_16x16x32_bf16 v[204:207], a[100:103], a[128:131], v[204:207]
    v_mfma_f32_16x16x32_bf16 v[200:203], a[100:103], a[124:127], v[200:203]
    v_mfma_f32_16x16x32_bf16 v[196:199], a[100:103], a[120:123], v[196:199]
    s_waitcnt lgkmcnt(9)
    v_mfma_f32_16x16x32_bf16 v[208:211], a[104:107], a[120:123], v[208:211]
    s_waitcnt vmcnt(19) lgkmcnt(0)
    s_barrier
    v_mfma_f32_16x16x32_bf16 v[212:215], a[104:107], a[124:127], v[212:215]
    s_add_u32 m0, s99, 147840
    ds_read_b64_tr_b16 a[72:73], v76 offset:0
    ds_read_b64_tr_b16 a[74:75], v76 offset:512
    v_mfma_f32_16x16x32_bf16 v[216:219], a[104:107], a[128:131], v[216:219]
    buffer_load_dwordx4 v64, s[8:11], s32 offen  lds
    v_mfma_f32_16x16x32_bf16 v[228:231], a[108:111], a[128:131], v[228:231]
    s_add_u32 m0, s99, 148864
    ds_read_b64_tr_b16 a[76:77], v76 offset:8
    ds_read_b64_tr_b16 a[78:79], v76 offset:520
    v_mfma_f32_16x16x32_bf16 v[224:227], a[108:111], a[124:127], v[224:227]
    buffer_load_dwordx4 v65, s[8:11], s32 offen  lds
    v_mfma_f32_16x16x32_bf16 v[220:223], a[108:111], a[120:123], v[220:223]
    ds_read_b64_tr_b16 a[80:81], v77 offset:0
    ds_read_b64_tr_b16 a[82:83], v77 offset:512
    v_mfma_f32_16x16x32_bf16 v[232:235], a[112:115], a[120:123], v[232:235]
    v_mfma_f32_16x16x32_bf16 v[236:239], a[112:115], a[124:127], v[236:239]
    s_add_u32 m0, s99, 149888
    ds_read_b64_tr_b16 a[84:85], v77 offset:8
    ds_read_b64_tr_b16 a[86:87], v77 offset:520
    v_mfma_f32_16x16x32_bf16 v[240:243], a[112:115], a[128:131], v[240:243]
    buffer_load_dwordx4 v66, s[8:11], s32 offen  lds
    v_mfma_f32_16x16x32_bf16 v[252:255], a[116:119], a[128:131], v[252:255]
    s_add_u32 s32, s32, 393216
    ds_read_b64_tr_b16 a[88:89], v76 offset:1024
    ds_read_b64_tr_b16 a[90:91], v76 offset:1536
    v_mfma_f32_16x16x32_bf16 v[248:251], a[116:119], a[124:127], v[248:251]
    s_cmp_eq_u32 s32, 7864320
    s_cselect_b32 s32, 786432, s32
    v_mfma_f32_16x16x32_bf16 v[244:247], a[116:119], a[120:123], v[244:247]
    s_waitcnt lgkmcnt(8)
    ds_read_b64_tr_b16 a[92:93], v76 offset:1032
    ds_read_b64_tr_b16 a[94:95], v76 offset:1544
    v_mfma_f32_16x16x32_bf16 v[112:115], a[72:75], a[132:135], v[112:115]
    s_add_u32 m0, s58, 36960
    s_nop 0
    buffer_load_dwordx4 v68, s[4:7], s33 offen offset:0  lds
    v_mfma_f32_16x16x32_bf16 v[116:119], a[72:75], a[136:139], v[116:119]
    ds_read_b64_tr_b16 a[96:97], v77 offset:1024
    ds_read_b64_tr_b16 a[98:99], v77 offset:1536
    v_mfma_f32_16x16x32_bf16 v[120:123], a[72:75], a[140:143], v[120:123]
    s_waitcnt lgkmcnt(10)
    v_mfma_f32_16x16x32_bf16 v[132:135], a[76:79], a[140:143], v[132:135]
    ds_read_b64_tr_b16 a[100:101], v77 offset:1032
    ds_read_b64_tr_b16 a[102:103], v77 offset:1544
    v_mfma_f32_16x16x32_bf16 v[128:131], a[76:79], a[136:139], v[128:131]
    buffer_load_dwordx4 v69, s[4:7], s33 offen offset:1024  lds
    v_mfma_f32_16x16x32_bf16 v[124:127], a[76:79], a[132:135], v[124:127]
    s_waitcnt lgkmcnt(10)
    ds_read_b64_tr_b16 a[104:105], v76 offset:2048
    ds_read_b64_tr_b16 a[106:107], v76 offset:2560
    v_mfma_f32_16x16x32_bf16 v[136:139], a[80:83], a[132:135], v[136:139]
    v_mfma_f32_16x16x32_bf16 v[140:143], a[80:83], a[136:139], v[140:143]
    ds_read_b64_tr_b16 a[108:109], v76 offset:2056
    ds_read_b64_tr_b16 a[110:111], v76 offset:2568
    v_mfma_f32_16x16x32_bf16 v[144:147], a[80:83], a[140:143], v[144:147]
    s_waitcnt lgkmcnt(12)
    buffer_load_dwordx4 v70, s[4:7], s33 offen offset:2048  lds
    v_mfma_f32_16x16x32_bf16 v[156:159], a[84:87], a[140:143], v[156:159]
    ds_read_b64_tr_b16 a[112:113], v77 offset:2048
    ds_read_b64_tr_b16 a[114:115], v77 offset:2560
    v_mfma_f32_16x16x32_bf16 v[152:155], a[84:87], a[136:139], v[152:155]
    v_mfma_f32_16x16x32_bf16 v[148:151], a[84:87], a[132:135], v[148:151]
    s_waitcnt lgkmcnt(12)
    ds_read_b64_tr_b16 a[116:117], v77 offset:2056
    ds_read_b64_tr_b16 a[118:119], v77 offset:2568
    v_mfma_f32_16x16x32_bf16 v[160:163], a[88:91], a[132:135], v[160:163]
    s_add_u32 m0, s58, 40032
    v_mfma_f32_16x16x32_bf16 v[164:167], a[88:91], a[136:139], v[164:167]
    buffer_load_dwordx4 v71, s[4:7], s33 offen offset:0  lds
    v_mfma_f32_16x16x32_bf16 v[168:171], a[88:91], a[140:143], v[168:171]
    s_waitcnt lgkmcnt(12)
    v_mfma_f32_16x16x32_bf16 v[180:183], a[92:95], a[140:143], v[180:183]
    buffer_load_dwordx4 v72, s[4:7], s33 offen offset:1024  lds
    v_mfma_f32_16x16x32_bf16 v[176:179], a[92:95], a[136:139], v[176:179]
    v_mfma_f32_16x16x32_bf16 v[172:175], a[92:95], a[132:135], v[172:175]
    s_waitcnt lgkmcnt(10)
    v_mfma_f32_16x16x32_bf16 v[184:187], a[96:99], a[132:135], v[184:187]
    buffer_load_dwordx4 v73, s[4:7], s33 offen offset:2048  lds
    v_mfma_f32_16x16x32_bf16 v[188:191], a[96:99], a[136:139], v[188:191]
    s_add_u32 s33, s33, 128
    v_mfma_f32_16x16x32_bf16 v[192:195], a[96:99], a[140:143], v[192:195]
    s_waitcnt lgkmcnt(8)
    s_cmp_eq_u32 s33, 1280
    s_cselect_b32 s33, 128, s33
    s_add_u32 s0, s56, 16384
    s_addc_u32 s1, s57, 0
    global_load_dword a253, v0, s[0:1]
    v_mfma_f32_16x16x32_bf16 v[204:207], a[100:103], a[140:143], v[204:207]
    v_mfma_f32_16x16x32_bf16 v[200:203], a[100:103], a[136:139], v[200:203]
    v_mfma_f32_16x16x32_bf16 v[196:199], a[100:103], a[132:135], v[196:199]
    s_waitcnt lgkmcnt(6)
    v_mfma_f32_16x16x32_bf16 v[208:211], a[104:107], a[132:135], v[208:211]
    s_waitcnt vmcnt(20) lgkmcnt(0)
    s_barrier
    v_mfma_f32_16x16x32_bf16 v[212:215], a[104:107], a[136:139], v[212:215]
    s_add_u32 m0, s99, 86240
    ds_read_b128 a[144:147], v80 offset:24640
    ds_read_b128 a[148:151], v80 offset:26688
    v_mfma_f32_16x16x32_bf16 v[216:219], a[104:107], a[140:143], v[216:219]
    buffer_load_dwordx4 v64, s[8:11], s32 offen  lds
    v_mfma_f32_16x16x32_bf16 v[228:231], a[108:111], a[140:143], v[228:231]
    s_add_u32 m0, s99, 87264
    ds_read_b128 a[152:155], v80 offset:28736
    v_mfma_f32_16x16x32_bf16 v[224:227], a[108:111], a[136:139], v[224:227]
    buffer_load_dwordx4 v65, s[8:11], s32 offen  lds
    v_mfma_f32_16x16x32_bf16 v[220:223], a[108:111], a[132:135], v[220:223]
    ds_read_b64_tr_b16 a[72:73], v76 offset:12320
    ds_read_b64_tr_b16 a[74:75], v76 offset:12832
    v_mfma_f32_16x16x32_bf16 v[232:235], a[112:115], a[132:135], v[232:235]
    v_mfma_f32_16x16x32_bf16 v[236:239], a[112:115], a[136:139], v[236:239]
    s_add_u32 m0, s99, 88288
    ds_read_b64_tr_b16 a[76:77], v76 offset:12328
    ds_read_b64_tr_b16 a[78:79], v76 offset:12840
    v_mfma_f32_16x16x32_bf16 v[240:243], a[112:115], a[140:143], v[240:243]
    buffer_load_dwordx4 v66, s[8:11], s32 offen  lds
    v_mfma_f32_16x16x32_bf16 v[252:255], a[116:119], a[140:143], v[252:255]
    s_add_u32 s32, s32, 393216
    ds_read_b64_tr_b16 a[80:81], v77 offset:12320
    ds_read_b64_tr_b16 a[82:83], v77 offset:12832
    v_mfma_f32_16x16x32_bf16 v[248:251], a[116:119], a[136:139], v[248:251]
    s_cmp_eq_u32 s32, 7864320
    s_cselect_b32 s32, 786432, s32
    v_mfma_f32_16x16x32_bf16 v[244:247], a[116:119], a[132:135], v[244:247]
    s_waitcnt lgkmcnt(4)
    ds_read_b64_tr_b16 a[84:85], v77 offset:12328
    ds_read_b64_tr_b16 a[86:87], v77 offset:12840
    v_mfma_f32_16x16x32_bf16 v[112:115], a[72:75], a[144:147], v[112:115]
    s_add_u32 s38, s34, 49152
    buffer_load_dwordx4 a[192:195], v20, s[12:15], s38 offen offset:0 nt
    v_mfma_f32_16x16x32_bf16 v[116:119], a[72:75], a[148:151], v[116:119]
    s_add_u32 s38, s34, 49152
    ds_read_b64_tr_b16 a[88:89], v76 offset:13344
    ds_read_b64_tr_b16 a[90:91], v76 offset:13856
    v_mfma_f32_16x16x32_bf16 v[120:123], a[72:75], a[152:155], v[120:123]
    s_waitcnt lgkmcnt(6)
    buffer_load_dwordx4 a[196:199], v21, s[12:15], s38 offen offset:1024 nt
    v_mfma_f32_16x16x32_bf16 v[132:135], a[76:79], a[152:155], v[132:135]
    ds_read_b64_tr_b16 a[92:93], v76 offset:13352
    ds_read_b64_tr_b16 a[94:95], v76 offset:13864
    v_mfma_f32_16x16x32_bf16 v[128:131], a[76:79], a[148:151], v[128:131]
    v_mfma_f32_16x16x32_bf16 v[124:127], a[76:79], a[144:147], v[124:127]
    s_waitcnt lgkmcnt(6)
    s_add_u32 s38, s34, 49152
    ds_read_b64_tr_b16 a[96:97], v77 offset:13344
    ds_read_b64_tr_b16 a[98:99], v77 offset:13856
    v_mfma_f32_16x16x32_bf16 v[136:139], a[80:83], a[144:147], v[136:139]
    buffer_load_dwordx4 a[200:203], v22, s[12:15], s38 offen offset:2048 nt
    v_mfma_f32_16x16x32_bf16 v[140:143], a[80:83], a[148:151], v[140:143]
    ds_read_b64_tr_b16 a[100:101], v77 offset:13352
    ds_read_b64_tr_b16 a[102:103], v77 offset:13864
    v_mfma_f32_16x16x32_bf16 v[144:147], a[80:83], a[152:155], v[144:147]
    s_waitcnt lgkmcnt(8)
    v_mfma_f32_16x16x32_bf16 v[156:159], a[84:87], a[152:155], v[156:159]
    s_add_u32 s38, s34, 36864
    ds_read_b64_tr_b16 a[104:105], v76 offset:14368
    ds_read_b64_tr_b16 a[106:107], v76 offset:14880
    v_mfma_f32_16x16x32_bf16 v[152:155], a[84:87], a[148:151], v[152:155]
    buffer_load_dwordx4 a[204:207], v23, s[16:19], s38 offen offset:0 nt
    v_mfma_f32_16x16x32_bf16 v[148:151], a[84:87], a[144:147], v[148:151]
    s_waitcnt lgkmcnt(8)
    ds_read_b64_tr_b16 a[108:109], v76 offset:14376
    ds_read_b64_tr_b16 a[110:111], v76 offset:14888
    v_mfma_f32_16x16x32_bf16 v[160:163], a[88:91], a[144:147], v[160:163]
    v_mfma_f32_16x16x32_bf16 v[164:167], a[88:91], a[148:151], v[164:167]
    s_add_u32 s38, s34, 36864
    ds_read_b64_tr_b16 a[112:113], v77 offset:14368
    ds_read_b64_tr_b16 a[114:115], v77 offset:14880
    v_mfma_f32_16x16x32_bf16 v[168:171], a[88:91], a[152:155], v[168:171]
    s_waitcnt lgkmcnt(10)
    buffer_load_dwordx4 a[208:211], v24, s[16:19], s38 offen offset:1024 nt
    v_mfma_f32_16x16x32_bf16 v[180:183], a[92:95], a[152:155], v[180:183]
    ds_read_b64_tr_b16 a[116:117], v77 offset:14376
    ds_read_b64_tr_b16 a[118:119], v77 offset:14888
    v_mfma_f32_16x16x32_bf16 v[176:179], a[92:95], a[148:151], v[176:179]
    v_mfma_f32_16x16x32_bf16 v[172:175], a[92:95], a[144:147], v[172:175]
    s_waitcnt lgkmcnt(10)
    s_add_u32 s38, s34, 36864
    ds_read_b128 a[156:159], v81 offset:24640
    ds_read_b128 a[160:163], v81 offset:26688
    v_mfma_f32_16x16x32_bf16 v[184:187], a[96:99], a[144:147], v[184:187]
    buffer_load_dwordx4 a[212:215], v25, s[16:19], s38 offen offset:2048 nt
    v_mfma_f32_16x16x32_bf16 v[188:191], a[96:99], a[148:151], v[188:191]
    ds_read_b128 a[164:167], v81 offset:28736
    v_mfma_f32_16x16x32_bf16 v[192:195], a[96:99], a[152:155], v[192:195]
    s_waitcnt lgkmcnt(11)
    s_add_u32 s38, s34, 61440
    v_mfma_f32_16x16x32_bf16 v[204:207], a[100:103], a[152:155], v[204:207]
    buffer_load_dwordx4 a[216:219], v20, s[12:15], s38 offen offset:0 nt
    v_mfma_f32_16x16x32_bf16 v[200:203], a[100:103], a[148:151], v[200:203]
    v_mfma_f32_16x16x32_bf16 v[196:199], a[100:103], a[144:147], v[196:199]
    s_waitcnt lgkmcnt(9)
    v_mfma_f32_16x16x32_bf16 v[208:211], a[104:107], a[144:147], v[208:211]
    s_waitcnt vmcnt(20) lgkmcnt(0)
    s_barrier
    v_mfma_f32_16x16x32_bf16 v[212:215], a[104:107], a[148:151], v[212:215]
    s_add_u32 m0, s99, 98560
    ds_read_b64_tr_b16 a[72:73], v76 offset:24640
    ds_read_b64_tr_b16 a[74:75], v76 offset:25152
    v_mfma_f32_16x16x32_bf16 v[216:219], a[104:107], a[152:155], v[216:219]
    buffer_load_dwordx4 v64, s[8:11], s32 offen  lds
    v_mfma_f32_16x16x32_bf16 v[228:231], a[108:111], a[152:155], v[228:231]
    s_add_u32 m0, s99, 99584
    ds_read_b64_tr_b16 a[76:77], v76 offset:24648
    ds_read_b64_tr_b16 a[78:79], v76 offset:25160
    v_mfma_f32_16x16x32_bf16 v[224:227], a[108:111], a[148:151], v[224:227]
    buffer_load_dwordx4 v65, s[8:11], s32 offen  lds
    v_mfma_f32_16x16x32_bf16 v[220:223], a[108:111], a[144:147], v[220:223]
    ds_read_b64_tr_b16 a[80:81], v77 offset:24640
    ds_read_b64_tr_b16 a[82:83], v77 offset:25152
    v_mfma_f32_16x16x32_bf16 v[232:235], a[112:115], a[144:147], v[232:235]
    v_mfma_f32_16x16x32_bf16 v[236:239], a[112:115], a[148:151], v[236:239]
    s_add_u32 m0, s99, 100608
    ds_read_b64_tr_b16 a[84:85], v77 offset:24648
    ds_read_b64_tr_b16 a[86:87], v77 offset:25160
    v_mfma_f32_16x16x32_bf16 v[240:243], a[112:115], a[152:155], v[240:243]
    buffer_load_dwordx4 v66, s[8:11], s32 offen  lds
    v_mfma_f32_16x16x32_bf16 v[252:255], a[116:119], a[152:155], v[252:255]
    s_add_u32 s32, s32, 393216
    ds_read_b64_tr_b16 a[88:89], v76 offset:25664
    ds_read_b64_tr_b16 a[90:91], v76 offset:26176
    v_mfma_f32_16x16x32_bf16 v[248:251], a[116:119], a[148:151], v[248:251]
    s_cmp_eq_u32 s32, 7864320
    s_cselect_b32 s32, 786432, s32
    v_mfma_f32_16x16x32_bf16 v[244:247], a[116:119], a[144:147], v[244:247]
    s_waitcnt lgkmcnt(8)
    ds_read_b64_tr_b16 a[92:93], v76 offset:25672
    ds_read_b64_tr_b16 a[94:95], v76 offset:26184
    v_mfma_f32_16x16x32_bf16 v[112:115], a[72:75], a[156:159], v[112:115]
    s_add_u32 m0, s58, 61600
    s_nop 0
    buffer_load_dwordx4 v68, s[4:7], s33 offen offset:0  lds
    v_mfma_f32_16x16x32_bf16 v[116:119], a[72:75], a[160:163], v[116:119]
    ds_read_b64_tr_b16 a[96:97], v77 offset:25664
    ds_read_b64_tr_b16 a[98:99], v77 offset:26176
    v_mfma_f32_16x16x32_bf16 v[120:123], a[72:75], a[164:167], v[120:123]
    s_waitcnt lgkmcnt(10)
    v_mfma_f32_16x16x32_bf16 v[132:135], a[76:79], a[164:167], v[132:135]
    ds_read_b64_tr_b16 a[100:101], v77 offset:25672
    ds_read_b64_tr_b16 a[102:103], v77 offset:26184
    v_mfma_f32_16x16x32_bf16 v[128:131], a[76:79], a[160:163], v[128:131]
    buffer_load_dwordx4 v69, s[4:7], s33 offen offset:1024  lds
    v_mfma_f32_16x16x32_bf16 v[124:127], a[76:79], a[156:159], v[124:127]
    s_waitcnt lgkmcnt(10)
    ds_read_b64_tr_b16 a[104:105], v76 offset:26688
    ds_read_b64_tr_b16 a[106:107], v76 offset:27200
    v_mfma_f32_16x16x32_bf16 v[136:139], a[80:83], a[156:159], v[136:139]
    v_mfma_f32_16x16x32_bf16 v[140:143], a[80:83], a[160:163], v[140:143]
    ds_read_b64_tr_b16 a[108:109], v76 offset:26696
    ds_read_b64_tr_b16 a[110:111], v76 offset:27208
    v_mfma_f32_16x16x32_bf16 v[144:147], a[80:83], a[164:167], v[144:147]
    s_waitcnt lgkmcnt(12)
    v_mfma_f32_16x16x32_bf16 v[156:159], a[84:87], a[164:167], v[156:159]
    ds_read_b64_tr_b16 a[112:113], v77 offset:26688
    ds_read_b64_tr_b16 a[114:115], v77 offset:27200
    v_mfma_f32_16x16x32_bf16 v[152:155], a[84:87], a[160:163], v[152:155]
    buffer_load_dwordx4 v70, s[4:7], s33 offen offset:2048  lds
    v_mfma_f32_16x16x32_bf16 v[148:151], a[84:87], a[156:159], v[148:151]
    s_waitcnt lgkmcnt(12)
    ds_read_b64_tr_b16 a[116:117], v77 offset:26696
    ds_read_b64_tr_b16 a[118:119], v77 offset:27208
    v_mfma_f32_16x16x32_bf16 v[160:163], a[88:91], a[156:159], v[160:163]
    v_mfma_f32_16x16x32_bf16 v[164:167], a[88:91], a[160:163], v[164:167]
    s_add_u32 m0, s58, 64672
    v_mfma_f32_16x16x32_bf16 v[168:171], a[88:91], a[164:167], v[168:171]
    s_waitcnt lgkmcnt(12)
    buffer_load_dwordx4 v71, s[4:7], s33 offen offset:0  lds
    v_mfma_f32_16x16x32_bf16 v[180:183], a[92:95], a[164:167], v[180:183]
    v_mfma_f32_16x16x32_bf16 v[176:179], a[92:95], a[160:163], v[176:179]
    v_mfma_f32_16x16x32_bf16 v[172:175], a[92:95], a[156:159], v[172:175]
    s_waitcnt lgkmcnt(10)
    buffer_load_dwordx4 v72, s[4:7], s33 offen offset:1024  lds
    v_mfma_f32_16x16x32_bf16 v[184:187], a[96:99], a[156:159], v[184:187]
    v_mfma_f32_16x16x32_bf16 v[188:191], a[96:99], a[160:163], v[188:191]
    v_mfma_f32_16x16x32_bf16 v[192:195], a[96:99], a[164:167], v[192:195]
    s_waitcnt lgkmcnt(8)
    buffer_load_dwordx4 v73, s[4:7], s33 offen offset:2048  lds
    v_mfma_f32_16x16x32_bf16 v[204:207], a[100:103], a[164:167], v[204:207]
    s_add_u32 s33, s33, 128
    v_mfma_f32_16x16x32_bf16 v[200:203], a[100:103], a[160:163], v[200:203]
    s_cmp_eq_u32 s33, 1280
    s_cselect_b32 s33, 128, s33
    v_mfma_f32_16x16x32_bf16 v[196:199], a[100:103], a[156:159], v[196:199]
    s_waitcnt lgkmcnt(6)
    v_mfma_f32_16x16x32_bf16 v[208:211], a[104:107], a[156:159], v[208:211]
    s_waitcnt vmcnt(20) lgkmcnt(0)
    s_barrier
    v_mfma_f32_16x16x32_bf16 v[212:215], a[104:107], a[160:163], v[212:215]
    s_add_u32 m0, s99, 110880
    ds_read_b128 a[120:123], v80 offset:0
    ds_read_b128 a[124:127], v80 offset:2048
    v_mfma_f32_16x16x32_bf16 v[216:219], a[104:107], a[164:167], v[216:219]
    buffer_load_dwordx4 v64, s[8:11], s32 offen  lds
    v_mfma_f32_16x16x32_bf16 v[228:231], a[108:111], a[164:167], v[228:231]
    s_add_u32 m0, s99, 111904
    ds_read_b128 a[128:131], v80 offset:4096
    v_mfma_f32_16x16x32_bf16 v[224:227], a[108:111], a[160:163], v[224:227]
    buffer_load_dwordx4 v65, s[8:11], s32 offen  lds
    v_mfma_f32_16x16x32_bf16 v[220:223], a[108:111], a[156:159], v[220:223]
    ds_read_b64_tr_b16 a[72:73], v76 offset:61600
    ds_read_b64_tr_b16 a[74:75], v76 offset:62112
    v_mfma_f32_16x16x32_bf16 v[232:235], a[112:115], a[156:159], v[232:235]
    v_mfma_f32_16x16x32_bf16 v[236:239], a[112:115], a[160:163], v[236:239]
    s_add_u32 m0, s99, 112928
    ds_read_b64_tr_b16 a[76:77], v76 offset:61608
    ds_read_b64_tr_b16 a[78:79], v76 offset:62120
    v_mfma_f32_16x16x32_bf16 v[240:243], a[112:115], a[164:167], v[240:243]
    buffer_load_dwordx4 v66, s[8:11], s32 offen  lds
    v_mfma_f32_16x16x32_bf16 v[252:255], a[116:119], a[164:167], v[252:255]
    s_add_u32 s32, s32, 393216
    ds_read_b64_tr_b16 a[80:81], v77 offset:61600
    ds_read_b64_tr_b16 a[82:83], v77 offset:62112
    v_mfma_f32_16x16x32_bf16 v[248:251], a[116:119], a[160:163], v[248:251]
    s_cmp_eq_u32 s32, 7864320
    s_cselect_b32 s32, 786432, s32
    v_mfma_f32_16x16x32_bf16 v[244:247], a[116:119], a[156:159], v[244:247]
    s_waitcnt lgkmcnt(4)
    ds_read_b64_tr_b16 a[84:85], v77 offset:61608
    ds_read_b64_tr_b16 a[86:87], v77 offset:62120
    v_mfma_f32_16x16x32_bf16 v[112:115], a[72:75], a[120:123], v[112:115]
    v_mfma_f32_16x16x32_bf16 v[116:119], a[72:75], a[124:127], v[116:119]
    ds_read_b64_tr_b16 a[88:89], v76 offset:62624
    ds_read_b64_tr_b16 a[90:91], v76 offset:63136
    v_mfma_f32_16x16x32_bf16 v[120:123], a[72:75], a[128:131], v[120:123]
    s_waitcnt lgkmcnt(6)
    v_mfma_f32_16x16x32_bf16 v[132:135], a[76:79], a[128:131], v[132:135]
    ds_read_b64_tr_b16 a[92:93], v76 offset:62632
    ds_read_b64_tr_b16 a[94:95], v76 offset:63144
    v_mfma_f32_16x16x32_bf16 v[128:131], a[76:79], a[124:127], v[128:131]
    v_mfma_f32_16x16x32_bf16 v[124:127], a[76:79], a[120:123], v[124:127]
    s_waitcnt lgkmcnt(6)
    ds_read_b64_tr_b16 a[96:97], v77 offset:62624
    ds_read_b64_tr_b16 a[98:99], v77 offset:63136
    v_mfma_f32_16x16x32_bf16 v[136:139], a[80:83], a[120:123], v[136:139]
    v_mfma_f32_16x16x32_bf16 v[140:143], a[80:83], a[124:127], v[140:143]
    ds_read_b64_tr_b16 a[100:101], v77 offset:62632
    ds_read_b64_tr_b16 a[102:103], v77 offset:63144
    v_mfma_f32_16x16x32_bf16 v[144:147], a[80:83], a[128:131], v[144:147]
    s_waitcnt lgkmcnt(8)
    v_mfma_f32_16x16x32_bf16 v[156:159], a[84:87], a[128:131], v[156:159]
    ds_read_b64_tr_b16 a[104:105], v76 offset:63648
    ds_read_b64_tr_b16 a[106:107], v76 offset:64160
    v_mfma_f32_16x16x32_bf16 v[152:155], a[84:87], a[124:127], v[152:155]
    v_mfma_f32_16x16x32_bf16 v[148:151], a[84:87], a[120:123], v[148:151]
    s_waitcnt lgkmcnt(8)
    ds_read_b64_tr_b16 a[108:109], v76 offset:63656
    ds_read_b64_tr_b16 a[110:111], v76 offset:64168
    v_mfma_f32_16x16x32_bf16 v[160:163], a[88:91], a[120:123], v[160:163]
    v_mfma_f32_16x16x32_bf16 v[164:167], a[88:91], a[124:127], v[164:167]
    ds_read_b64_tr_b16 a[112:113], v77 offset:63648
    ds_read_b64_tr_b16 a[114:115], v77 offset:64160
    v_mfma_f32_16x16x32_bf16 v[168:171], a[88:91], a[128:131], v[168:171]
    s_waitcnt lgkmcnt(10)
    v_mfma_f32_16x16x32_bf16 v[180:183], a[92:95], a[128:131], v[180:183]
    ds_read_b64_tr_b16 a[116:117], v77 offset:63656
    ds_read_b64_tr_b16 a[118:119], v77 offset:64168
    v_mfma_f32_16x16x32_bf16 v[176:179], a[92:95], a[124:127], v[176:179]
    v_mfma_f32_16x16x32_bf16 v[172:175], a[92:95], a[120:123], v[172:175]
    s_waitcnt lgkmcnt(10)
    ds_read_b128 a[132:135], v81 offset:0
    ds_read_b128 a[136:139], v81 offset:2048
    v_mfma_f32_16x16x32_bf16 v[184:187], a[96:99], a[120:123], v[184:187]
    v_mfma_f32_16x16x32_bf16 v[188:191], a[96:99], a[124:127], v[188:191]
    ds_read_b128 a[140:143], v81 offset:4096
    v_mfma_f32_16x16x32_bf16 v[192:195], a[96:99], a[128:131], v[192:195]
    s_waitcnt lgkmcnt(11)
    v_mfma_f32_16x16x32_bf16 v[204:207], a[100:103], a[128:131], v[204:207]
    v_mfma_f32_16x16x32_bf16 v[200:203], a[100:103], a[124:127], v[200:203]
    v_mfma_f32_16x16x32_bf16 v[196:199], a[100:103], a[120:123], v[196:199]
    s_waitcnt lgkmcnt(9)
    v_mfma_f32_16x16x32_bf16 v[208:211], a[104:107], a[120:123], v[208:211]
    s_waitcnt vmcnt(19) lgkmcnt(0)
    s_barrier
    v_mfma_f32_16x16x32_bf16 v[212:215], a[104:107], a[124:127], v[212:215]
    ds_read_b64_tr_b16 a[72:73], v76 offset:0
    ds_read_b64_tr_b16 a[74:75], v76 offset:512
    v_mfma_f32_16x16x32_bf16 v[216:219], a[104:107], a[128:131], v[216:219]
    s_add_u32 s30, s34, 36960
    v_lshl_add_u32 v29, v1, 4, s30
    v_mfma_f32_16x16x32_bf16 v[228:231], a[108:111], a[128:131], v[228:231]
    ds_read_b64_tr_b16 a[76:77], v76 offset:8
    ds_read_b64_tr_b16 a[78:79], v76 offset:520
    v_mfma_f32_16x16x32_bf16 v[224:227], a[108:111], a[124:127], v[224:227]
    ds_write_b128 v29, a[168:171] offset:0
    ds_write_b128 v29, a[172:175] offset:1024
    ds_write_b128 v29, a[176:179] offset:2048
    v_mfma_f32_16x16x32_bf16 v[220:223], a[108:111], a[120:123], v[220:223]
    s_add_u32 s38, s34, 61440
    ds_read_b64_tr_b16 a[80:81], v77 offset:0
    ds_read_b64_tr_b16 a[82:83], v77 offset:512
    v_mfma_f32_16x16x32_bf16 v[232:235], a[112:115], a[120:123], v[232:235]
    buffer_load_dwordx4 a[220:223], v21, s[12:15], s38 offen offset:1024 nt
    v_mfma_f32_16x16x32_bf16 v[236:239], a[112:115], a[124:127], v[236:239]
    s_add_u32 s38, s34, 61440
    ds_read_b64_tr_b16 a[84:85], v77 offset:8
    ds_read_b64_tr_b16 a[86:87], v77 offset:520
    v_mfma_f32_16x16x32_bf16 v[240:243], a[112:115], a[128:131], v[240:243]
    buffer_load_dwordx4 a[224:227], v22, s[12:15], s38 offen offset:2048 nt
    v_mfma_f32_16x16x32_bf16 v[252:255], a[116:119], a[128:131], v[252:255]
    s_add_u32 s38, s34, 49152
    ds_read_b64_tr_b16 a[88:89], v76 offset:1024
    ds_read_b64_tr_b16 a[90:91], v76 offset:1536
    v_mfma_f32_16x16x32_bf16 v[248:251], a[116:119], a[124:127], v[248:251]
    buffer_load_dwordx4 a[228:231], v23, s[16:19], s38 offen offset:0 nt
    v_mfma_f32_16x16x32_bf16 v[244:247], a[116:119], a[120:123], v[244:247]
    s_waitcnt lgkmcnt(11)
    ds_read_b64_tr_b16 a[92:93], v76 offset:1032
    ds_read_b64_tr_b16 a[94:95], v76 offset:1544
    v_mfma_f32_16x16x32_bf16 v[112:115], a[72:75], a[132:135], v[112:115]
    s_add_u32 s38, s34, 49152
    buffer_load_dwordx4 a[232:235], v24, s[16:19], s38 offen offset:1024 nt
    v_mfma_f32_16x16x32_bf16 v[116:119], a[72:75], a[136:139], v[116:119]
    ds_read_b64_tr_b16 a[96:97], v77 offset:1024
    ds_read_b64_tr_b16 a[98:99], v77 offset:1536
    v_mfma_f32_16x16x32_bf16 v[120:123], a[72:75], a[140:143], v[120:123]
    s_waitcnt lgkmcnt(13)
    v_mfma_f32_16x16x32_bf16 v[132:135], a[76:79], a[140:143], v[132:135]
    ds_read_b64_tr_b16 a[100:101], v77 offset:1032
    ds_read_b64_tr_b16 a[102:103], v77 offset:1544
    v_mfma_f32_16x16x32_bf16 v[128:131], a[76:79], a[136:139], v[128:131]
    v_mfma_f32_16x16x32_bf16 v[124:127], a[76:79], a[132:135], v[124:127]
    s_waitcnt lgkmcnt(10)
    ds_read_b64_tr_b16 a[104:105], v76 offset:2048
    ds_read_b64_tr_b16 a[106:107], v76 offset:2560
    v_mfma_f32_16x16x32_bf16 v[136:139], a[80:83], a[132:135], v[136:139]
    v_mfma_f32_16x16x32_bf16 v[140:143], a[80:83], a[136:139], v[140:143]
    s_add_u32 s38, s34, 49152
    ds_read_b64_tr_b16 a[108:109], v76 offset:2056
    ds_read_b64_tr_b16 a[110:111], v76 offset:2568
    v_mfma_f32_16x16x32_bf16 v[144:147], a[80:83], a[140:143], v[144:147]
    s_waitcnt lgkmcnt(12)
    buffer_load_dwordx4 a[236:239], v25, s[16:19], s38 offen offset:2048 nt
    v_mfma_f32_16x16x32_bf16 v[156:159], a[84:87], a[140:143], v[156:159]
    ds_read_b64_tr_b16 a[112:113], v77 offset:2048
    ds_read_b64_tr_b16 a[114:115], v77 offset:2560
    v_mfma_f32_16x16x32_bf16 v[152:155], a[84:87], a[136:139], v[152:155]
    v_mfma_f32_16x16x32_bf16 v[148:151], a[84:87], a[132:135], v[148:151]
    s_waitcnt lgkmcnt(12)
    ds_read_b64_tr_b16 a[116:117], v77 offset:2056
    ds_read_b64_tr_b16 a[118:119], v77 offset:2568
    v_mfma_f32_16x16x32_bf16 v[160:163], a[88:91], a[132:135], v[160:163]
    v_mfma_f32_16x16x32_bf16 v[164:167], a[88:91], a[136:139], v[164:167]
    s_add_u32 s38, s34, 73728
    v_mfma_f32_16x16x32_bf16 v[168:171], a[88:91], a[140:143], v[168:171]
    s_waitcnt lgkmcnt(12)
    buffer_load_dwordx4 a[240:243], v20, s[12:15], s38 offen offset:0 nt
    v_mfma_f32_16x16x32_bf16 v[180:183], a[92:95], a[140:143], v[180:183]
    v_mfma_f32_16x16x32_bf16 v[176:179], a[92:95], a[136:139], v[176:179]
    v_mfma_f32_16x16x32_bf16 v[172:175], a[92:95], a[132:135], v[172:175]
    s_waitcnt lgkmcnt(10)
    s_add_u32 s38, s34, 73728
    v_mfma_f32_16x16x32_bf16 v[184:187], a[96:99], a[132:135], v[184:187]
    buffer_load_dwordx4 a[244:247], v21, s[12:15], s38 offen offset:1024 nt
    v_mfma_f32_16x16x32_bf16 v[188:191], a[96:99], a[136:139], v[188:191]
    v_mfma_f32_16x16x32_bf16 v[192:195], a[96:99], a[140:143], v[192:195]
    s_waitcnt lgkmcnt(8)
    v_mfma_f32_16x16x32_bf16 v[204:207], a[100:103], a[140:143], v[204:207]
    v_mfma_f32_16x16x32_bf16 v[200:203], a[100:103], a[136:139], v[200:203]
    v_mfma_f32_16x16x32_bf16 v[196:199], a[100:103], a[132:135], v[196:199]
    s_waitcnt lgkmcnt(6)
    v_mfma_f32_16x16x32_bf16 v[208:211], a[104:107], a[132:135], v[208:211]
    s_waitcnt vmcnt(10) lgkmcnt(0)
    s_barrier
    v_mfma_f32_16x16x32_bf16 v[212:215], a[104:107], a[136:139], v[212:215]
    ds_read_b128 a[144:147], v80 offset:24640
    ds_read_b128 a[148:151], v80 offset:26688
    v_mfma_f32_16x16x32_bf16 v[216:219], a[104:107], a[140:143], v[216:219]
    s_add_u32 s30, s34, 147840
    v_lshl_add_u32 v29, v1, 4, s30
    v_mfma_f32_16x16x32_bf16 v[228:231], a[108:111], a[140:143], v[228:231]
    ds_read_b128 a[152:155], v80 offset:28736
    v_mfma_f32_16x16x32_bf16 v[224:227], a[108:111], a[136:139], v[224:227]
    ds_write_b128 v29, a[180:183] offset:0
    ds_write_b128 v29, a[184:187] offset:1024
    ds_write_b128 v29, a[188:191] offset:2048
    v_mfma_f32_16x16x32_bf16 v[220:223], a[108:111], a[132:135], v[220:223]
    ds_read_b64_tr_b16 a[72:73], v76 offset:12320
    ds_read_b64_tr_b16 a[74:75], v76 offset:12832
    v_mfma_f32_16x16x32_bf16 v[232:235], a[112:115], a[132:135], v[232:235]
    v_mfma_f32_16x16x32_bf16 v[236:239], a[112:115], a[136:139], v[236:239]
    ds_read_b64_tr_b16 a[76:77], v76 offset:12328
    ds_read_b64_tr_b16 a[78:79], v76 offset:12840
    v_mfma_f32_16x16x32_bf16 v[240:243], a[112:115], a[140:143], v[240:243]
    v_mfma_f32_16x16x32_bf16 v[252:255], a[116:119], a[140:143], v[252:255]
    ds_read_b64_tr_b16 a[80:81], v77 offset:12320
    ds_read_b64_tr_b16 a[82:83], v77 offset:12832
    v_mfma_f32_16x16x32_bf16 v[248:251], a[116:119], a[136:139], v[248:251]
    v_mfma_f32_16x16x32_bf16 v[244:247], a[116:119], a[132:135], v[244:247]
    s_waitcnt lgkmcnt(4)
    ds_read_b64_tr_b16 a[84:85], v77 offset:12328
    ds_read_b64_tr_b16 a[86:87], v77 offset:12840
    v_mfma_f32_16x16x32_bf16 v[112:115], a[72:75], a[144:147], v[112:115]
    v_mfma_f32_16x16x32_bf16 v[116:119], a[72:75], a[148:151], v[116:119]
    ds_read_b64_tr_b16 a[88:89], v76 offset:13344
    ds_read_b64_tr_b16 a[90:91], v76 offset:13856
    v_mfma_f32_16x16x32_bf16 v[120:123], a[72:75], a[152:155], v[120:123]
    s_waitcnt lgkmcnt(6)
    v_mfma_f32_16x16x32_bf16 v[132:135], a[76:79], a[152:155], v[132:135]
    ds_read_b64_tr_b16 a[92:93], v76 offset:13352
    ds_read_b64_tr_b16 a[94:95], v76 offset:13864
    v_mfma_f32_16x16x32_bf16 v[128:131], a[76:79], a[148:151], v[128:131]
    v_mfma_f32_16x16x32_bf16 v[124:127], a[76:79], a[144:147], v[124:127]
    s_waitcnt lgkmcnt(6)
    ds_read_b64_tr_b16 a[96:97], v77 offset:13344
    ds_read_b64_tr_b16 a[98:99], v77 offset:13856
    v_mfma_f32_16x16x32_bf16 v[136:139], a[80:83], a[144:147], v[136:139]
    v_mfma_f32_16x16x32_bf16 v[140:143], a[80:83], a[148:151], v[140:143]
    ds_read_b64_tr_b16 a[100:101], v77 offset:13352
    ds_read_b64_tr_b16 a[102:103], v77 offset:13864
    v_mfma_f32_16x16x32_bf16 v[144:147], a[80:83], a[152:155], v[144:147]
    s_waitcnt lgkmcnt(8)
    v_mfma_f32_16x16x32_bf16 v[156:159], a[84:87], a[152:155], v[156:159]
    ds_read_b64_tr_b16 a[104:105], v76 offset:14368
    ds_read_b64_tr_b16 a[106:107], v76 offset:14880
    v_mfma_f32_16x16x32_bf16 v[152:155], a[84:87], a[148:151], v[152:155]
    v_mfma_f32_16x16x32_bf16 v[148:151], a[84:87], a[144:147], v[148:151]
    s_waitcnt lgkmcnt(8)
    ds_read_b64_tr_b16 a[108:109], v76 offset:14376
    ds_read_b64_tr_b16 a[110:111], v76 offset:14888
    v_mfma_f32_16x16x32_bf16 v[160:163], a[88:91], a[144:147], v[160:163]
    v_mfma_f32_16x16x32_bf16 v[164:167], a[88:91], a[148:151], v[164:167]
    ds_read_b64_tr_b16 a[112:113], v77 offset:14368
    ds_read_b64_tr_b16 a[114:115], v77 offset:14880
    v_mfma_f32_16x16x32_bf16 v[168:171], a[88:91], a[152:155], v[168:171]
    s_waitcnt lgkmcnt(10)
    v_mfma_f32_16x16x32_bf16 v[180:183], a[92:95], a[152:155], v[180:183]
    ds_read_b64_tr_b16 a[116:117], v77 offset:14376
    ds_read_b64_tr_b16 a[118:119], v77 offset:14888
    v_mfma_f32_16x16x32_bf16 v[176:179], a[92:95], a[148:151], v[176:179]
    v_mfma_f32_16x16x32_bf16 v[172:175], a[92:95], a[144:147], v[172:175]
    s_waitcnt lgkmcnt(10)
    ds_read_b128 a[156:159], v81 offset:24640
    ds_read_b128 a[160:163], v81 offset:26688
    v_mfma_f32_16x16x32_bf16 v[184:187], a[96:99], a[144:147], v[184:187]
    v_mfma_f32_16x16x32_bf16 v[188:191], a[96:99], a[148:151], v[188:191]
    ds_read_b128 a[164:167], v81 offset:28736
    v_mfma_f32_16x16x32_bf16 v[192:195], a[96:99], a[152:155], v[192:195]
    s_waitcnt lgkmcnt(11)
    v_mfma_f32_16x16x32_bf16 v[204:207], a[100:103], a[152:155], v[204:207]
    v_mfma_f32_16x16x32_bf16 v[200:203], a[100:103], a[148:151], v[200:203]
    v_mfma_f32_16x16x32_bf16 v[196:199], a[100:103], a[144:147], v[196:199]
    s_waitcnt lgkmcnt(9)
    v_mfma_f32_16x16x32_bf16 v[208:211], a[104:107], a[144:147], v[208:211]
    s_waitcnt vmcnt(7) lgkmcnt(0)
    s_barrier
    v_mfma_f32_16x16x32_bf16 v[212:215], a[104:107], a[148:151], v[212:215]
    ds_read_b64_tr_b16 a[72:73], v76 offset:24640
    ds_read_b64_tr_b16 a[74:75], v76 offset:25152
    v_mfma_f32_16x16x32_bf16 v[216:219], a[104:107], a[152:155], v[216:219]
    s_add_u32 s30, s34, 49280
    v_lshl_add_u32 v29, v1, 4, s30
    v_mfma_f32_16x16x32_bf16 v[228:231], a[108:111], a[152:155], v[228:231]
    ds_read_b64_tr_b16 a[76:77], v76 offset:24648
    ds_read_b64_tr_b16 a[78:79], v76 offset:25160
    v_mfma_f32_16x16x32_bf16 v[224:227], a[108:111], a[148:151], v[224:227]
    ds_write_b128 v29, a[192:195] offset:0
    ds_write_b128 v29, a[196:199] offset:1024
    ds_write_b128 v29, a[200:203] offset:2048
    v_mfma_f32_16x16x32_bf16 v[220:223], a[108:111], a[144:147], v[220:223]
    ds_read_b64_tr_b16 a[80:81], v77 offset:24640
    ds_read_b64_tr_b16 a[82:83], v77 offset:25152
    v_mfma_f32_16x16x32_bf16 v[232:235], a[112:115], a[144:147], v[232:235]
    v_mfma_f32_16x16x32_bf16 v[236:239], a[112:115], a[148:151], v[236:239]
    ds_read_b64_tr_b16 a[84:85], v77 offset:24648
    ds_read_b64_tr_b16 a[86:87], v77 offset:25160
    v_mfma_f32_16x16x32_bf16 v[240:243], a[112:115], a[152:155], v[240:243]
    v_mfma_f32_16x16x32_bf16 v[252:255], a[116:119], a[152:155], v[252:255]
    ds_read_b64_tr_b16 a[88:89], v76 offset:25664
    ds_read_b64_tr_b16 a[90:91], v76 offset:26176
    v_mfma_f32_16x16x32_bf16 v[248:251], a[116:119], a[148:151], v[248:251]
    v_mfma_f32_16x16x32_bf16 v[244:247], a[116:119], a[144:147], v[244:247]
    s_waitcnt lgkmcnt(11)
    ds_read_b64_tr_b16 a[92:93], v76 offset:25672
    ds_read_b64_tr_b16 a[94:95], v76 offset:26184
    v_mfma_f32_16x16x32_bf16 v[112:115], a[72:75], a[156:159], v[112:115]
    v_mfma_f32_16x16x32_bf16 v[116:119], a[72:75], a[160:163], v[116:119]
    ds_read_b64_tr_b16 a[96:97], v77 offset:25664
    ds_read_b64_tr_b16 a[98:99], v77 offset:26176
    v_mfma_f32_16x16x32_bf16 v[120:123], a[72:75], a[164:167], v[120:123]
    s_waitcnt lgkmcnt(13)
    v_mfma_f32_16x16x32_bf16 v[132:135], a[76:79], a[164:167], v[132:135]
    ds_read_b64_tr_b16 a[100:101], v77 offset:25672
    ds_read_b64_tr_b16 a[102:103], v77 offset:26184
    v_mfma_f32_16x16x32_bf16 v[128:131], a[76:79], a[160:163], v[128:131]
    v_mfma_f32_16x16x32_bf16 v[124:127], a[76:79], a[156:159], v[124:127]
    s_waitcnt lgkmcnt(10)
    ds_read_b64_tr_b16 a[104:105], v76 offset:26688
    ds_read_b64_tr_b16 a[106:107], v76 offset:27200
    v_mfma_f32_16x16x32_bf16 v[136:139], a[80:83], a[156:159], v[136:139]
    v_mfma_f32_16x16x32_bf16 v[140:143], a[80:83], a[160:163], v[140:143]
    ds_read_b64_tr_b16 a[108:109], v76 offset:26696
    ds_read_b64_tr_b16 a[110:111], v76 offset:27208
    v_mfma_f32_16x16x32_bf16 v[144:147], a[80:83], a[164:167], v[144:147]
    s_waitcnt lgkmcnt(12)
    v_mfma_f32_16x16x32_bf16 v[156:159], a[84:87], a[164:167], v[156:159]
    ds_read_b64_tr_b16 a[112:113], v77 offset:26688
    ds_read_b64_tr_b16 a[114:115], v77 offset:27200
    v_mfma_f32_16x16x32_bf16 v[152:155], a[84:87], a[160:163], v[152:155]
    v_mfma_f32_16x16x32_bf16 v[148:151], a[84:87], a[156:159], v[148:151]
    s_waitcnt lgkmcnt(12)
    ds_read_b64_tr_b16 a[116:117], v77 offset:26696
    ds_read_b64_tr_b16 a[118:119], v77 offset:27208
    v_mfma_f32_16x16x32_bf16 v[160:163], a[88:91], a[156:159], v[160:163]
    v_mfma_f32_16x16x32_bf16 v[164:167], a[88:91], a[160:163], v[164:167]
    v_mfma_f32_16x16x32_bf16 v[168:171], a[88:91], a[164:167], v[168:171]
    s_waitcnt lgkmcnt(12)
    v_mfma_f32_16x16x32_bf16 v[180:183], a[92:95], a[164:167], v[180:183]
    v_mfma_f32_16x16x32_bf16 v[176:179], a[92:95], a[160:163], v[176:179]
    v_mfma_f32_16x16x32_bf16 v[172:175], a[92:95], a[156:159], v[172:175]
    s_waitcnt lgkmcnt(10)
    v_mfma_f32_16x16x32_bf16 v[184:187], a[96:99], a[156:159], v[184:187]
    v_mfma_f32_16x16x32_bf16 v[188:191], a[96:99], a[160:163], v[188:191]
    v_mfma_f32_16x16x32_bf16 v[192:195], a[96:99], a[164:167], v[192:195]
    s_waitcnt lgkmcnt(8)
    v_mfma_f32_16x16x32_bf16 v[204:207], a[100:103], a[164:167], v[204:207]
    v_mfma_f32_16x16x32_bf16 v[200:203], a[100:103], a[160:163], v[200:203]
    v_mfma_f32_16x16x32_bf16 v[196:199], a[100:103], a[156:159], v[196:199]
    s_waitcnt lgkmcnt(6)
    v_mfma_f32_16x16x32_bf16 v[208:211], a[104:107], a[156:159], v[208:211]
    s_waitcnt lgkmcnt(0)
    s_barrier
    v_mfma_f32_16x16x32_bf16 v[212:215], a[104:107], a[160:163], v[212:215]
    v_mfma_f32_16x16x32_bf16 v[216:219], a[104:107], a[164:167], v[216:219]
    s_add_u32 s30, s34, 86240
    v_lshl_add_u32 v29, v1, 4, s30
    v_mfma_f32_16x16x32_bf16 v[228:231], a[108:111], a[164:167], v[228:231]
    s_add_u32 s38, s34, 73728
    ds_write_b128 v29, a[204:207] offset:0
    ds_write_b128 v29, a[208:211] offset:1024
    ds_write_b128 v29, a[212:215] offset:2048
    v_mfma_f32_16x16x32_bf16 v[224:227], a[108:111], a[160:163], v[224:227]
    buffer_load_dwordx4 a[248:251], v22, s[12:15], s38 offen offset:2048 nt
    v_mfma_f32_16x16x32_bf16 v[220:223], a[108:111], a[156:159], v[220:223]
    s_add_u32 s39, s34, 61440
    s_add_u32 m0, s34, 110880
    v_mfma_f32_16x16x32_bf16 v[232:235], a[112:115], a[156:159], v[232:235]
    buffer_load_dwordx4 v23, s[16:19], s39 offen offset:0 nt lds
    v_mfma_f32_16x16x32_bf16 v[236:239], a[112:115], a[160:163], v[236:239]
    v_mfma_f32_16x16x32_bf16 v[240:243], a[112:115], a[164:167], v[240:243]
    v_mfma_f32_16x16x32_bf16 v[252:255], a[116:119], a[164:167], v[252:255]
    buffer_load_dwordx4 v24, s[16:19], s39 offen offset:1024 nt lds
    v_mfma_f32_16x16x32_bf16 v[248:251], a[116:119], a[160:163], v[248:251]
    v_mfma_f32_16x16x32_bf16 v[244:247], a[116:119], a[156:159], v[244:247]
    s_add_u32 s30, s34, 61600
    v_lshl_add_u32 v29, v1, 4, s30
    ds_write_b128 v29, a[216:219] offset:0
    s_waitcnt vmcnt(9)
    ds_write_b128 v29, a[220:223] offset:1024
    s_waitcnt vmcnt(8)
    ds_write_b128 v29, a[224:227] offset:2048
    s_add_u32 s30, s34, 98560
    s_nop 0
    v_lshl_add_u32 v29, v1, 4, s30
    s_waitcnt vmcnt(7)
    ds_write_b128 v29, a[228:231] offset:0
    s_waitcnt vmcnt(6)
    ds_write_b128 v29, a[232:235] offset:1024
    s_waitcnt vmcnt(5)
    ds_write_b128 v29, a[236:239] offset:2048
    v_pk_mul_f32 v[112:113], v[112:113], s[36:37]
    v_pk_mul_f32 v[114:115], v[114:115], s[36:37]
    v_pk_mul_f32 v[124:125], v[124:125], s[36:37]
    v_pk_mul_f32 v[126:127], v[126:127], s[36:37]
    v_pk_mul_f32 v[116:117], v[116:117], s[36:37]
    v_pk_mul_f32 v[118:119], v[118:119], s[36:37]
    v_pk_mul_f32 v[128:129], v[128:129], s[36:37]
    v_pk_mul_f32 v[130:131], v[130:131], s[36:37]
    v_pk_mul_f32 v[120:121], v[120:121], s[36:37]
    v_pk_mul_f32 v[122:123], v[122:123], s[36:37]
    v_pk_mul_f32 v[132:133], v[132:133], s[36:37]
    v_pk_mul_f32 v[134:135], v[134:135], s[36:37]
    buffer_load_dwordx4 v25, s[16:19], s39 offen offset:2048 nt lds
    s_add_u32 s38, s34, 86016
    buffer_load_dwordx4 a[168:171], v20, s[12:15], s38 offen offset:0 nt
    v_cvt_pk_bf16_f32 v88, v112, v113
    v_cvt_pk_bf16_f32 v89, v114, v115
    v_cvt_pk_bf16_f32 v90, v124, v125
    v_cvt_pk_bf16_f32 v91, v126, v127
    v_cvt_pk_bf16_f32 v92, v116, v117
    v_cvt_pk_bf16_f32 v93, v118, v119
    v_cvt_pk_bf16_f32 v94, v128, v129
    v_cvt_pk_bf16_f32 v95, v130, v131
    v_cvt_pk_bf16_f32 v96, v120, v121
    v_cvt_pk_bf16_f32 v97, v122, v123
    v_cvt_pk_bf16_f32 v98, v132, v133
    v_cvt_pk_bf16_f32 v99, v134, v135
    v_accvgpr_write_b32 a0, v88
    v_accvgpr_write_b32 a1, v89
    v_accvgpr_write_b32 a2, v90
    v_accvgpr_write_b32 a3, v91
    v_accvgpr_write_b32 a4, v92
    v_accvgpr_write_b32 a5, v93
    v_accvgpr_write_b32 a6, v94
    v_accvgpr_write_b32 a7, v95
    v_accvgpr_write_b32 a8, v96
    v_accvgpr_write_b32 a9, v97
    v_accvgpr_write_b32 a10, v98
    v_accvgpr_write_b32 a11, v99
    v_pk_mul_f32 v[136:137], v[136:137], s[36:37]
    v_pk_mul_f32 v[138:139], v[138:139], s[36:37]
    v_pk_mul_f32 v[148:149], v[148:149], s[36:37]
    v_pk_mul_f32 v[150:151], v[150:151], s[36:37]
    v_pk_mul_f32 v[140:141], v[140:141], s[36:37]
    v_pk_mul_f32 v[142:143], v[142:143], s[36:37]
    v_pk_mul_f32 v[152:153], v[152:153], s[36:37]
    v_pk_mul_f32 v[154:155], v[154:155], s[36:37]
    v_pk_mul_f32 v[144:145], v[144:145], s[36:37]
    v_pk_mul_f32 v[146:147], v[146:147], s[36:37]
    v_pk_mul_f32 v[156:157], v[156:157], s[36:37]
    v_pk_mul_f32 v[158:159], v[158:159], s[36:37]
    s_add_u32 s38, s34, 86016
    buffer_load_dwordx4 a[172:175], v21, s[12:15], s38 offen offset:1024 nt
    s_add_u32 s38, s34, 86016
    buffer_load_dwordx4 a[176:179], v22, s[12:15], s38 offen offset:2048 nt
    v_cvt_pk_bf16_f32 v100, v136, v137
    v_cvt_pk_bf16_f32 v101, v138, v139
    v_cvt_pk_bf16_f32 v102, v148, v149
    v_cvt_pk_bf16_f32 v103, v150, v151
    v_cvt_pk_bf16_f32 v104, v140, v141
    v_cvt_pk_bf16_f32 v105, v142, v143
    v_cvt_pk_bf16_f32 v106, v152, v153
    v_cvt_pk_bf16_f32 v107, v154, v155
    v_cvt_pk_bf16_f32 v108, v144, v145
    v_cvt_pk_bf16_f32 v109, v146, v147
    v_cvt_pk_bf16_f32 v110, v156, v157
    v_cvt_pk_bf16_f32 v111, v158, v159
    v_accvgpr_write_b32 a12, v100
    v_accvgpr_write_b32 a13, v101
    v_accvgpr_write_b32 a14, v102
    v_accvgpr_write_b32 a15, v103
    v_accvgpr_write_b32 a16, v104
    v_accvgpr_write_b32 a17, v105
    v_accvgpr_write_b32 a18, v106
    v_accvgpr_write_b32 a19, v107
    v_accvgpr_write_b32 a20, v108
    v_accvgpr_write_b32 a21, v109
    v_accvgpr_write_b32 a22, v110
    v_accvgpr_write_b32 a23, v111
    v_pk_mul_f32 v[160:161], v[160:161], s[36:37]
    v_pk_mul_f32 v[162:163], v[162:163], s[36:37]
    v_pk_mul_f32 v[172:173], v[172:173], s[36:37]
    v_pk_mul_f32 v[174:175], v[174:175], s[36:37]
    v_pk_mul_f32 v[164:165], v[164:165], s[36:37]
    v_pk_mul_f32 v[166:167], v[166:167], s[36:37]
    v_pk_mul_f32 v[176:177], v[176:177], s[36:37]
    v_pk_mul_f32 v[178:179], v[178:179], s[36:37]
    v_pk_mul_f32 v[168:169], v[168:169], s[36:37]
    v_pk_mul_f32 v[170:171], v[170:171], s[36:37]
    v_pk_mul_f32 v[180:181], v[180:181], s[36:37]
    v_pk_mul_f32 v[182:183], v[182:183], s[36:37]
    s_add_u32 s38, s34, 73728
    buffer_load_dwordx4 a[180:183], v23, s[16:19], s38 offen offset:0 nt
    v_cvt_pk_bf16_f32 v88, v160, v161
    v_cvt_pk_bf16_f32 v89, v162, v163
    v_cvt_pk_bf16_f32 v90, v172, v173
    v_cvt_pk_bf16_f32 v91, v174, v175
    v_cvt_pk_bf16_f32 v92, v164, v165
    v_cvt_pk_bf16_f32 v93, v166, v167
    v_cvt_pk_bf16_f32 v94, v176, v177
    v_cvt_pk_bf16_f32 v95, v178, v179
    v_cvt_pk_bf16_f32 v96, v168, v169
    v_cvt_pk_bf16_f32 v97, v170, v171
    v_cvt_pk_bf16_f32 v98, v180, v181
    v_cvt_pk_bf16_f32 v99, v182, v183
    v_accvgpr_write_b32 a24, v88
    v_accvgpr_write_b32 a25, v89
    v_accvgpr_write_b32 a26, v90
    v_accvgpr_write_b32 a27, v91
    v_accvgpr_write_b32 a28, v92
    v_accvgpr_write_b32 a29, v93
    v_accvgpr_write_b32 a30, v94
    v_accvgpr_write_b32 a31, v95
    v_accvgpr_write_b32 a32, v96
    v_accvgpr_write_b32 a33, v97
    v_accvgpr_write_b32 a34, v98
    v_accvgpr_write_b32 a35, v99
    v_pk_mul_f32 v[184:185], v[184:185], s[36:37]
    v_pk_mul_f32 v[186:187], v[186:187], s[36:37]
    v_pk_mul_f32 v[196:197], v[196:197], s[36:37]
    v_pk_mul_f32 v[198:199], v[198:199], s[36:37]
    v_pk_mul_f32 v[188:189], v[188:189], s[36:37]
    v_pk_mul_f32 v[190:191], v[190:191], s[36:37]
    v_pk_mul_f32 v[200:201], v[200:201], s[36:37]
    v_pk_mul_f32 v[202:203], v[202:203], s[36:37]
    v_pk_mul_f32 v[192:193], v[192:193], s[36:37]
    v_pk_mul_f32 v[194:195], v[194:195], s[36:37]
    v_pk_mul_f32 v[204:205], v[204:205], s[36:37]
    v_pk_mul_f32 v[206:207], v[206:207], s[36:37]
    s_add_u32 s38, s34, 73728
    buffer_load_dwordx4 a[184:187], v24, s[16:19], s38 offen offset:1024 nt
    v_cvt_pk_bf16_f32 v100, v184, v185
    v_cvt_pk_bf16_f32 v101, v186, v187
    v_cvt_pk_bf16_f32 v102, v196, v197
    v_cvt_pk_bf16_f32 v103, v198, v199
    v_cvt_pk_bf16_f32 v104, v188, v189
    v_cvt_pk_bf16_f32 v105, v190, v191
    v_cvt_pk_bf16_f32 v106, v200, v201
    v_cvt_pk_bf16_f32 v107, v202, v203
    v_cvt_pk_bf16_f32 v108, v192, v193
    v_cvt_pk_bf16_f32 v109, v194, v195
    v_cvt_pk_bf16_f32 v110, v204, v205
    v_cvt_pk_bf16_f32 v111, v206, v207
    v_accvgpr_write_b32 a36, v100
    v_accvgpr_write_b32 a37, v101
    v_accvgpr_write_b32 a38, v102
    v_accvgpr_write_b32 a39, v103
    v_accvgpr_write_b32 a40, v104
    v_accvgpr_write_b32 a41, v105
    v_accvgpr_write_b32 a42, v106
    v_accvgpr_write_b32 a43, v107
    v_accvgpr_write_b32 a44, v108
    v_accvgpr_write_b32 a45, v109
    v_accvgpr_write_b32 a46, v110
    v_accvgpr_write_b32 a47, v111
    v_pk_mul_f32 v[208:209], v[208:209], s[36:37]
    v_pk_mul_f32 v[210:211], v[210:211], s[36:37]
    v_pk_mul_f32 v[220:221], v[220:221], s[36:37]
    v_pk_mul_f32 v[222:223], v[222:223], s[36:37]
    v_pk_mul_f32 v[212:213], v[212:213], s[36:37]
    v_pk_mul_f32 v[214:215], v[214:215], s[36:37]
    v_pk_mul_f32 v[224:225], v[224:225], s[36:37]
    v_pk_mul_f32 v[226:227], v[226:227], s[36:37]
    v_pk_mul_f32 v[216:217], v[216:217], s[36:37]
    v_pk_mul_f32 v[218:219], v[218:219], s[36:37]
    v_pk_mul_f32 v[228:229], v[228:229], s[36:37]
    v_pk_mul_f32 v[230:231], v[230:231], s[36:37]
    s_add_u32 s38, s34, 73728
    buffer_load_dwordx4 a[188:191], v25, s[16:19], s38 offen offset:2048 nt
    v_cvt_pk_bf16_f32 v88, v208, v209
    v_cvt_pk_bf16_f32 v89, v210, v211
    v_cvt_pk_bf16_f32 v90, v220, v221
    v_cvt_pk_bf16_f32 v91, v222, v223
    v_cvt_pk_bf16_f32 v92, v212, v213
    v_cvt_pk_bf16_f32 v93, v214, v215
    v_cvt_pk_bf16_f32 v94, v224, v225
    v_cvt_pk_bf16_f32 v95, v226, v227
    v_cvt_pk_bf16_f32 v96, v216, v217
    v_cvt_pk_bf16_f32 v97, v218, v219
    v_cvt_pk_bf16_f32 v98, v228, v229
    v_cvt_pk_bf16_f32 v99, v230, v231
    v_accvgpr_write_b32 a48, v88
    v_accvgpr_write_b32 a49, v89
    v_accvgpr_write_b32 a50, v90
    v_accvgpr_write_b32 a51, v91
    v_accvgpr_write_b32 a52, v92
    v_accvgpr_write_b32 a53, v93
    v_accvgpr_write_b32 a54, v94
    v_accvgpr_write_b32 a55, v95
    v_accvgpr_write_b32 a56, v96
    v_accvgpr_write_b32 a57, v97
    v_accvgpr_write_b32 a58, v98
    v_accvgpr_write_b32 a59, v99
    v_pk_mul_f32 v[232:233], v[232:233], s[36:37]
    v_pk_mul_f32 v[234:235], v[234:235], s[36:37]
    v_pk_mul_f32 v[244:245], v[244:245], s[36:37]
    v_pk_mul_f32 v[246:247], v[246:247], s[36:37]
    v_pk_mul_f32 v[236:237], v[236:237], s[36:37]
    v_pk_mul_f32 v[238:239], v[238:239], s[36:37]
    v_pk_mul_f32 v[248:249], v[248:249], s[36:37]
    v_pk_mul_f32 v[250:251], v[250:251], s[36:37]
    v_pk_mul_f32 v[240:241], v[240:241], s[36:37]
    v_pk_mul_f32 v[242:243], v[242:243], s[36:37]
    v_pk_mul_f32 v[252:253], v[252:253], s[36:37]
    v_pk_mul_f32 v[254:255], v[254:255], s[36:37]
    s_add_u32 s38, s34, 98304
    buffer_load_dwordx4 a[192:195], v20, s[12:15], s38 offen offset:0 nt
    v_cvt_pk_bf16_f32 v100, v232, v233
    v_cvt_pk_bf16_f32 v101, v234, v235
    v_cvt_pk_bf16_f32 v102, v244, v245
    v_cvt_pk_bf16_f32 v103, v246, v247
    v_cvt_pk_bf16_f32 v104, v236, v237
    v_cvt_pk_bf16_f32 v105, v238, v239
    v_cvt_pk_bf16_f32 v106, v248, v249
    v_cvt_pk_bf16_f32 v107, v250, v251
    v_cvt_pk_bf16_f32 v108, v240, v241
    v_cvt_pk_bf16_f32 v109, v242, v243
    v_cvt_pk_bf16_f32 v110, v252, v253
    v_cvt_pk_bf16_f32 v111, v254, v255
    v_accvgpr_write_b32 a60, v100
    v_accvgpr_write_b32 a61, v101
    v_accvgpr_write_b32 a62, v102
    v_accvgpr_write_b32 a63, v103
    v_accvgpr_write_b32 a64, v104
    v_accvgpr_write_b32 a65, v105
    v_accvgpr_write_b32 a66, v106
    v_accvgpr_write_b32 a67, v107
    v_accvgpr_write_b32 a68, v108
    v_accvgpr_write_b32 a69, v109
    v_accvgpr_write_b32 a70, v110
    v_accvgpr_write_b32 a71, v111
L_P2:
    s_waitcnt lgkmcnt(0)
    s_barrier
    ds_read_b128 a[72:75], v8 offset:0
    ds_read_b128 a[76:79], v9 offset:0
    ds_read_b128 a[80:83], v8 offset:128
    ds_read_b128 a[84:87], v9 offset:128
    ds_read_b128 a[88:91], v8 offset:256
    ds_read_b128 a[92:95], v9 offset:256
    ds_read_b128 a[96:99], v8 offset:6144
    ds_read_b128 a[100:103], v9 offset:6144
    ds_read_b128 a[104:107], v8 offset:6272
    ds_read_b128 a[108:111], v9 offset:6272
    ds_read_b128 a[112:115], v8 offset:6400
    ds_read_b128 a[116:119], v9 offset:6400
    s_waitcnt lgkmcnt(11)
    v_mfma_f32_16x16x32_bf16 v[64:67], a[72:75], a[0:3], 0
    v_mfma_f32_16x16x32_bf16 v[68:71], a[72:75], a[4:7], 0
    v_mfma_f32_16x16x32_bf16 v[72:75], a[72:75], a[8:11], 0
    s_waitcnt lgkmcnt(10)
    ds_read_b128 a[72:75], v8 offset:12320
    v_mfma_f32_16x16x32_bf16 v[64:67], a[76:79], a[12:15], v[64:67]
    v_mfma_f32_16x16x32_bf16 v[68:71], a[76:79], a[16:19], v[68:71]
    v_mfma_f32_16x16x32_bf16 v[72:75], a[76:79], a[20:23], v[72:75]
    s_waitcnt lgkmcnt(10)
    ds_read_b128 a[76:79], v9 offset:12320
    v_mfma_f32_16x16x32_bf16 v[64:67], a[80:83], a[24:27], v[64:67]
    v_mfma_f32_16x16x32_bf16 v[68:71], a[80:83], a[28:31], v[68:71]
    v_mfma_f32_16x16x32_bf16 v[72:75], a[80:83], a[32:35], v[72:75]
    s_waitcnt lgkmcnt(10)
    ds_read_b128 a[80:83], v8 offset:12448
    v_mfma_f32_16x16x32_bf16 v[64:67], a[84:87], a[36:39], v[64:67]
    v_mfma_f32_16x16x32_bf16 v[68:71], a[84:87], a[40:43], v[68:71]
    v_mfma_f32_16x16x32_bf16 v[72:75], a[84:87], a[44:47], v[72:75]
    s_waitcnt lgkmcnt(10)
    ds_read_b128 a[84:87], v9 offset:12448
    v_mfma_f32_16x16x32_bf16 v[64:67], a[88:91], a[48:51], v[64:67]
    v_mfma_f32_16x16x32_bf16 v[68:71], a[88:91], a[52:55], v[68:71]
    v_mfma_f32_16x16x32_bf16 v[72:75], a[88:91], a[56:59], v[72:75]
    s_waitcnt lgkmcnt(10)
    ds_read_b128 a[88:91], v8 offset:12576
    v_mfma_f32_16x16x32_bf16 v[64:67], a[92:95], a[60:63], v[64:67]
    v_mfma_f32_16x16x32_bf16 v[68:71], a[92:95], a[64:67], v[68:71]
    v_mfma_f32_16x16x32_bf16 v[72:75], a[92:95], a[68:71], v[72:75]
    s_waitcnt lgkmcnt(10)
    ds_read_b128 a[92:95], v9 offset:12576
    v_mfma_f32_16x16x32_bf16 v[76:79], a[96:99], a[0:3], 0
    v_mfma_f32_16x16x32_bf16 v[80:83], a[96:99], a[4:7], 0
    v_mfma_f32_16x16x32_bf16 v[84:87], a[96:99], a[8:11], 0
    s_waitcnt lgkmcnt(10)
    ds_read_b128 a[96:99], v8 offset:18464
    v_mfma_f32_16x16x32_bf16 v[76:79], a[100:103], a[12:15], v[76:79]
    v_mfma_f32_16x16x32_bf16 v[80:83], a[100:103], a[16:19], v[80:83]
    v_mfma_f32_16x16x32_bf16 v[84:87], a[100:103], a[20:23], v[84:87]
    s_waitcnt lgkmcnt(10)
    ds_read_b128 a[100:103], v9 offset:18464
    v_mfma_f32_16x16x32_bf16 v[76:79], a[104:107], a[24:27], v[76:79]
    v_mfma_f32_16x16x32_bf16 v[80:83], a[104:107], a[28:31], v[80:83]
    v_mfma_f32_16x16x32_bf16 v[84:87], a[104:107], a[32:35], v[84:87]
    s_waitcnt lgkmcnt(10)
    ds_read_b128 a[104:107], v8 offset:18592
    v_mfma_f32_16x16x32_bf16 v[76:79], a[108:111], a[36:39], v[76:79]
    v_mfma_f32_16x16x32_bf16 v[80:83], a[108:111], a[40:43], v[80:83]
    v_mfma_f32_16x16x32_bf16 v[84:87], a[108:111], a[44:47], v[84:87]
    s_waitcnt lgkmcnt(10)
    ds_read_b128 a[108:111], v9 offset:18592
    v_mfma_f32_16x16x32_bf16 v[76:79], a[112:115], a[48:51], v[76:79]
    v_mfma_f32_16x16x32_bf16 v[80:83], a[112:115], a[52:55], v[80:83]
    v_mfma_f32_16x16x32_bf16 v[84:87], a[112:115], a[56:59], v[84:87]
    s_waitcnt lgkmcnt(10)
    ds_read_b128 a[112:115], v8 offset:18720
    v_mfma_f32_16x16x32_bf16 v[76:79], a[116:119], a[60:63], v[76:79]
    v_mfma_f32_16x16x32_bf16 v[80:83], a[116:119], a[64:67], v[80:83]
    v_mfma_f32_16x16x32_bf16 v[84:87], a[116:119], a[68:71], v[84:87]
    ds_read_b128 a[116:119], v9 offset:18720
    v_mov_b32 v52, v26
    v_mov_b32 v53, v27
    v_mov_b32 v54, v28
    v_max3_f32 v52, v64, v65, v52
    v_max3_f32 v52, v66, v67, v52
    v_max3_f32 v52, v76, v77, v52
    v_max3_f32 v52, v78, v79, v52
    v_max3_f32 v53, v68, v69, v53
    v_max3_f32 v53, v70, v71, v53
    v_max3_f32 v53, v80, v81, v53
    v_max3_f32 v53, v82, v83, v53
    v_max3_f32 v54, v72, v73, v54
    v_max3_f32 v54, v74, v75, v54
    v_max3_f32 v54, v84, v85, v54
    v_max3_f32 v54, v86, v87, v54
    v_mov_b32 v55, v52
    v_mov_b32 v56, v53
    v_mov_b32 v57, v54
    v_permlane32_swap_b32 v55, v52
    v_permlane32_swap_b32 v56, v53
    v_permlane32_swap_b32 v57, v54
    v_max_f32 v52, v52, v55
    v_max_f32 v53, v53, v56
    v_max_f32 v54, v54, v57
    v_mov_b32 v55, v52
    v_mov_b32 v56, v53
    v_mov_b32 v57, v54
    v_permlane16_swap_b32 v55, v52
    v_permlane16_swap_b32 v56, v53
    v_permlane16_swap_b32 v57, v54
    v_max_f32 v52, v52, v55
    v_max_f32 v53, v53, v56
    v_max_f32 v54, v54, v57
    v_sub_f32 v40, 0, v52
    v_sub_f32 v41, 0, v52
    v_sub_f32 v42, 0, v52
    v_sub_f32 v43, 0, v52
    v_mov_b32 v37, 0
    v_sub_f32 v44, 0, v53
    v_sub_f32 v45, 0, v53
    v_sub_f32 v46, 0, v53
    v_sub_f32 v47, 0, v53
    v_mov_b32 v38, 0
    v_sub_f32 v48, 0, v54
    v_sub_f32 v49, 0, v54
    v_sub_f32 v50, 0, v54
    v_sub_f32 v51, 0, v54
    v_mov_b32 v39, 0
    s_waitcnt lgkmcnt(0)
    s_barrier
    v_mov_b32 v36, s98
    v_mov_b32 v30, 0
    s_add_u32 s38, s34, 98304
    buffer_load_dwordx4 a[196:199], v21, s[12:15], s38 offen offset:1024 nt
    s_add_u32 s38, s34, 98304
    buffer_load_dwordx4 a[200:203], v22, s[12:15], s38 offen offset:2048 nt
    s_add_u32 s38, s34, 86016
    buffer_load_dwordx4 a[204:207], v23, s[16:19], s38 offen offset:0 nt
    s_cmp_lg_u32 s35, 0
    s_cbranch_scc1 L_RELOAD
L_RELOADED:
    s_add_u32 s30, s34, 0
    v_lshl_add_u32 v29, v1, 4, s30
    s_waitcnt vmcnt(15)
    ds_write_b128 v29, a[240:243] offset:0
    s_waitcnt vmcnt(14)
    ds_write_b128 v29, a[244:247] offset:1024
    s_waitcnt vmcnt(13)
    ds_write_b128 v29, a[248:251] offset:2048
    v_sub_f32 v64, v64, v52
    v_sub_f32 v65, v65, v52
    v_sub_f32 v66, v66, v52
    v_sub_f32 v67, v67, v52
    v_sub_f32 v68, v68, v53
    v_sub_f32 v69, v69, v53
    v_sub_f32 v70, v70, v53
    v_sub_f32 v71, v71, v53
    v_sub_f32 v72, v72, v54
    v_sub_f32 v73, v73, v54
    v_sub_f32 v74, v74, v54
    v_sub_f32 v75, v75, v54
    v_sub_f32 v76, v76, v52
    v_sub_f32 v77, v77, v52
    v_sub_f32 v78, v78, v52
    v_sub_f32 v79, v79, v52
    v_sub_f32 v80, v80, v53
    v_sub_f32 v81, v81, v53
    v_sub_f32 v82, v82, v53
    v_sub_f32 v83, v83, v53
    v_sub_f32 v84, v84, v54
    v_sub_f32 v85, v85, v54
    v_sub_f32 v86, v86, v54
    v_sub_f32 v87, v87, v54
    v_mfma_f32_16x16x32_bf16 v[88:91], a[72:75], a[0:3], v[40:43]
    v_exp_f32 v64, v64
    v_mfma_f32_16x16x32_bf16 v[92:95], a[72:75], a[4:7], v[44:47]
    v_exp_f32 v65, v65
    v_mfma_f32_16x16x32_bf16 v[96:99], a[72:75], a[8:11], v[48:51]
    v_exp_f32 v66, v66
    v_mfma_f32_16x16x32_bf16 v[88:91], a[76:79], a[12:15], v[88:91]
    v_exp_f32 v67, v67
    v_mfma_f32_16x16x32_bf16 v[92:95], a[76:79], a[16:19], v[92:95]
    v_cvt_pk_bf16_f32 v52, v64, v65
    v_cvt_pk_bf16_f32 v53, v66, v67
    v_mfma_f32_16x16x32_bf16 v[96:99], a[76:79], a[20:23], v[96:99]
    v_exp_f32 v76, v76
    v_mfma_f32_16x16x32_bf16 v[88:91], a[80:83], a[24:27], v[88:91]
    v_exp_f32 v77, v77
    v_mfma_f32_16x16x32_bf16 v[92:95], a[80:83], a[28:31], v[92:95]
    v_exp_f32 v78, v78
    v_mfma_f32_16x16x32_bf16 v[96:99], a[80:83], a[32:35], v[96:99]
    v_exp_f32 v79, v79
    v_mfma_f32_16x16x32_bf16 v[88:91], a[84:87], a[36:39], v[88:91]
    v_cvt_pk_bf16_f32 v54, v76, v77
    v_cvt_pk_bf16_f32 v55, v78, v79
    v_mfma_f32_16x16x32_bf16 v[92:95], a[84:87], a[40:43], v[92:95]
    v_exp_f32 v68, v68
    v_mfma_f32_16x16x32_bf16 v[96:99], a[84:87], a[44:47], v[96:99]
    v_exp_f32 v69, v69
    v_mfma_f32_16x16x32_bf16 v[88:91], a[88:91], a[48:51], v[88:91]
    v_exp_f32 v70, v70
    v_mfma_f32_16x16x32_bf16 v[92:95], a[88:91], a[52:55], v[92:95]
    v_exp_f32 v71, v71
    v_mfma_f32_16x16x32_bf16 v[96:99], a[88:91], a[56:59], v[96:99]
    v_cvt_pk_bf16_f32 v56, v68, v69
    v_cvt_pk_bf16_f32 v57, v70, v71
    v_mfma_f32_16x16x32_bf16 v[88:91], a[92:95], a[60:63], v[88:91]
    v_exp_f32 v80, v80
    v_mfma_f32_16x16x32_bf16 v[92:95], a[92:95], a[64:67], v[92:95]
    v_exp_f32 v81, v81
    v_mfma_f32_16x16x32_bf16 v[96:99], a[92:95], a[68:71], v[96:99]
    v_exp_f32 v82, v82
    v_mfma_f32_16x16x32_bf16 v[100:103], a[96:99], a[0:3], v[40:43]
    v_exp_f32 v83, v83
    v_mfma_f32_16x16x32_bf16 v[104:107], a[96:99], a[4:7], v[44:47]
    v_cvt_pk_bf16_f32 v58, v80, v81
    v_cvt_pk_bf16_f32 v59, v82, v83
    v_mfma_f32_16x16x32_bf16 v[108:111], a[96:99], a[8:11], v[48:51]
    v_exp_f32 v72, v72
    v_mfma_f32_16x16x32_bf16 v[100:103], a[100:103], a[12:15], v[100:103]
    v_exp_f32 v73, v73
    v_mfma_f32_16x16x32_bf16 v[104:107], a[100:103], a[16:19], v[104:107]
    v_exp_f32 v74, v74
    v_mfma_f32_16x16x32_bf16 v[108:111], a[100:103], a[20:23], v[108:111]
    s_waitcnt lgkmcnt(0)
    s_barrier
    v_exp_f32 v75, v75
    v_mfma_f32_16x16x32_bf16 v[100:103], a[104:107], a[24:27], v[100:103]
    ds_read_b64_tr_b16 a[120:121], v12 offset:0
    v_add_f32 v37, v37, v64
    v_mfma_f32_16x16x32_bf16 v[104:107], a[104:107], a[28:31], v[104:107]
    v_cvt_pk_bf16_f32 v60, v72, v73
    v_cvt_pk_bf16_f32 v61, v74, v75
    v_mfma_f32_16x16x32_bf16 v[108:111], a[104:107], a[32:35], v[108:111]
    ds_read_b64_tr_b16 a[122:123], v12 offset:6144
    v_add_f32 v37, v37, v65
    v_mfma_f32_16x16x32_bf16 v[100:103], a[108:111], a[36:39], v[100:103]
    v_exp_f32 v84, v84
    v_mfma_f32_16x16x32_bf16 v[104:107], a[108:111], a[40:43], v[104:107]
    ds_read_b64_tr_b16 a[124:125], v13 offset:0
    v_add_f32 v37, v37, v66
    v_mfma_f32_16x16x32_bf16 v[108:111], a[108:111], a[44:47], v[108:111]
    v_exp_f32 v85, v85
    v_mfma_f32_16x16x32_bf16 v[100:103], a[112:115], a[48:51], v[100:103]
    ds_read_b64_tr_b16 a[126:127], v13 offset:6144
    v_add_f32 v37, v37, v67
    v_mfma_f32_16x16x32_bf16 v[104:107], a[112:115], a[52:55], v[104:107]
    v_exp_f32 v86, v86
    v_mfma_f32_16x16x32_bf16 v[108:111], a[112:115], a[56:59], v[108:111]
    ds_read_b64_tr_b16 a[128:129], v14 offset:0
    v_add_f32 v37, v37, v76
    v_mfma_f32_16x16x32_bf16 v[100:103], a[116:119], a[60:63], v[100:103]
    v_exp_f32 v87, v87
    v_mfma_f32_16x16x32_bf16 v[104:107], a[116:119], a[64:67], v[104:107]
    ds_read_b64_tr_b16 a[130:131], v14 offset:6144
    v_add_f32 v37, v37, v77
    v_mfma_f32_16x16x32_bf16 v[108:111], a[116:119], a[68:71], v[108:111]
    s_waitcnt lgkmcnt(4)
    v_cvt_pk_bf16_f32 v62, v84, v85
    v_cvt_pk_bf16_f32 v63, v86, v87
    v_mfma_f32_16x16x32_bf16 v[112:115], a[120:123], v[52:55], 0
    ds_read_b64_tr_b16 a[132:133], v15 offset:0
    v_add_f32 v38, v38, v68
    v_mfma_f32_16x16x32_bf16 v[116:119], a[120:123], v[56:59], 0
    ds_read_b64_tr_b16 a[134:135], v15 offset:6144
    v_add_f32 v39, v39, v72
    v_mfma_f32_16x16x32_bf16 v[120:123], a[120:123], v[60:63], 0
    s_waitcnt lgkmcnt(4)
    s_add_u32 s38, s34, 86016
    ds_read_b64_tr_b16 a[136:137], v12 offset:128
    v_add_f32 v38, v38, v69
    v_mfma_f32_16x16x32_bf16 v[132:135], a[124:127], v[60:63], 0
    buffer_load_dwordx4 a[208:211], v24, s[16:19], s38 offen offset:1024 nt
    v_mfma_f32_16x16x32_bf16 v[128:131], a[124:127], v[56:59], 0
    ds_read_b64_tr_b16 a[138:139], v12 offset:6272
    v_add_f32 v39, v39, v73
    v_mfma_f32_16x16x32_bf16 v[124:127], a[124:127], v[52:55], 0
    s_waitcnt lgkmcnt(4)
    ds_read_b64_tr_b16 a[140:141], v13 offset:128
    v_add_f32 v38, v38, v70
    v_mfma_f32_16x16x32_bf16 v[136:139], a[128:131], v[52:55], 0
    ds_read_b64_tr_b16 a[142:143], v13 offset:6272
    v_add_f32 v39, v39, v74
    v_mfma_f32_16x16x32_bf16 v[140:143], a[128:131], v[56:59], 0
    ds_read_b64_tr_b16 a[144:145], v14 offset:128
    v_add_f32 v38, v38, v71
    v_mfma_f32_16x16x32_bf16 v[144:147], a[128:131], v[60:63], 0
    s_waitcnt lgkmcnt(5)
    ds_read_b64_tr_b16 a[146:147], v14 offset:6272
    v_add_f32 v39, v39, v75
    v_mfma_f32_16x16x32_bf16 v[156:159], a[132:135], v[60:63], 0
    ds_read_b64_tr_b16 a[148:149], v15 offset:128
    v_add_f32 v38, v38, v80
    v_mfma_f32_16x16x32_bf16 v[152:155], a[132:135], v[56:59], 0
    s_add_u32 s38, s34, 86016
    ds_read_b64_tr_b16 a[150:151], v15 offset:6272
    v_add_f32 v39, v39, v84
    v_mfma_f32_16x16x32_bf16 v[148:151], a[132:135], v[52:55], 0
    s_waitcnt lgkmcnt(6)
    buffer_load_dwordx4 a[212:215], v25, s[16:19], s38 offen offset:2048 nt
    v_mfma_f32_16x16x32_bf16 v[160:163], a[136:139], v[52:55], 0
    ds_read_b64_tr_b16 a[152:153], v12 offset:256
    v_add_f32 v38, v38, v81
    v_mfma_f32_16x16x32_bf16 v[164:167], a[136:139], v[56:59], 0
    ds_read_b64_tr_b16 a[154:155], v12 offset:6400
    v_add_f32 v39, v39, v85
    v_mfma_f32_16x16x32_bf16 v[168:171], a[136:139], v[60:63], 0
    s_waitcnt lgkmcnt(6)
    ds_read_b64_tr_b16 a[156:157], v13 offset:256
    v_add_f32 v37, v37, v78
    v_mfma_f32_16x16x32_bf16 v[180:183], a[140:143], v[60:63], 0
    ds_read_b64_tr_b16 a[158:159], v13 offset:6400
    v_add_f32 v38, v38, v82
    v_mfma_f32_16x16x32_bf16 v[176:179], a[140:143], v[56:59], 0
    ds_read_b64_tr_b16 a[160:161], v14 offset:256
    v_add_f32 v39, v39, v86
    v_mfma_f32_16x16x32_bf16 v[172:175], a[140:143], v[52:55], 0
    s_waitcnt lgkmcnt(7)
    ds_read_b64_tr_b16 a[162:163], v14 offset:6400
    v_add_f32 v37, v37, v79
    v_mfma_f32_16x16x32_bf16 v[184:187], a[144:147], v[52:55], 0
    s_add_u32 s38, s34, 110592
    ds_read_b64_tr_b16 a[164:165], v15 offset:256
    v_add_f32 v38, v38, v83
    v_mfma_f32_16x16x32_bf16 v[188:191], a[144:147], v[56:59], 0
    buffer_load_dwordx4 a[216:219], v20, s[12:15], s38 offen offset:0 nt
    v_mfma_f32_16x16x32_bf16 v[192:195], a[144:147], v[60:63], 0
    s_waitcnt lgkmcnt(7)
    ds_read_b64_tr_b16 a[166:167], v15 offset:6400
    v_add_f32 v39, v39, v87
    v_mfma_f32_16x16x32_bf16 v[204:207], a[148:151], v[60:63], 0
    s_add_u32 s30, s34, 12320
    v_lshl_add_u32 v29, v1, 4, s30
    v_mfma_f32_16x16x32_bf16 v[200:203], a[148:151], v[56:59], 0
    s_waitcnt vmcnt(12)
    ds_write_b128 v29, a[168:171] offset:0
    v_mfma_f32_16x16x32_bf16 v[196:199], a[148:151], v[52:55], 0
    s_waitcnt lgkmcnt(7)
    s_waitcnt vmcnt(11)
    ds_write_b128 v29, a[172:175] offset:1024
    v_mfma_f32_16x16x32_bf16 v[208:211], a[152:155], v[52:55], 0
    s_waitcnt vmcnt(10)
    ds_write_b128 v29, a[176:179] offset:2048
    v_mfma_f32_16x16x32_bf16 v[212:215], a[152:155], v[56:59], 0
    ds_read_b128 a[72:75], v8 offset:24640
    v_mfma_f32_16x16x32_bf16 v[216:219], a[152:155], v[60:63], 0
    s_waitcnt lgkmcnt(8)
    s_mov_b32 s31, 0
    ds_read_b128 a[76:79], v9 offset:24640
    v_mfma_f32_16x16x32_bf16 v[228:231], a[156:159], v[60:63], 0
    buffer_load_dword a252, v31, s[60:63], s31 offen
    v_mfma_f32_16x16x32_bf16 v[224:227], a[156:159], v[56:59], 0
    ds_read_b128 a[80:83], v8 offset:24768
    v_mfma_f32_16x16x32_bf16 v[220:223], a[156:159], v[52:55], 0
    s_waitcnt lgkmcnt(8)
    ds_read_b128 a[84:87], v9 offset:24768
    v_mfma_f32_16x16x32_bf16 v[232:235], a[160:163], v[52:55], 0
    ds_read_b128 a[88:91], v8 offset:24896
    v_mfma_f32_16x16x32_bf16 v[236:239], a[160:163], v[56:59], 0
    ds_read_b128 a[92:95], v9 offset:24896
    v_mfma_f32_16x16x32_bf16 v[240:243], a[160:163], v[60:63], 0
    s_waitcnt lgkmcnt(9)
    ds_read_b128 a[96:99], v8 offset:30784
    v_mfma_f32_16x16x32_bf16 v[252:255], a[164:167], v[60:63], 0
    ds_read_b128 a[100:103], v9 offset:30784
    v_mfma_f32_16x16x32_bf16 v[248:251], a[164:167], v[56:59], 0
    ds_read_b128 a[104:107], v8 offset:30912
    v_mfma_f32_16x16x32_bf16 v[244:247], a[164:167], v[52:55], 0
    s_waitcnt lgkmcnt(8)
    ds_read_b128 a[108:111], v9 offset:30912
    ds_read_b128 a[112:115], v8 offset:31040
    ds_read_b128 a[116:119], v9 offset:31040
    v_mfma_f32_16x16x32_bf16 v[64:67], a[72:75], a[0:3], v[40:43]
    v_exp_f32 v88, v88
    v_mfma_f32_16x16x32_bf16 v[68:71], a[72:75], a[4:7], v[44:47]
    v_exp_f32 v89, v89
    v_mfma_f32_16x16x32_bf16 v[72:75], a[72:75], a[8:11], v[48:51]
    s_waitcnt lgkmcnt(10)
    v_exp_f32 v90, v90
    v_mfma_f32_16x16x32_bf16 v[64:67], a[76:79], a[12:15], v[64:67]
    v_exp_f32 v91, v91
    v_mfma_f32_16x16x32_bf16 v[68:71], a[76:79], a[16:19], v[68:71]
    v_cvt_pk_bf16_f32 v52, v88, v89
    v_cvt_pk_bf16_f32 v53, v90, v91
    v_mfma_f32_16x16x32_bf16 v[72:75], a[76:79], a[20:23], v[72:75]
    s_waitcnt lgkmcnt(9)
    v_exp_f32 v100, v100
    v_mfma_f32_16x16x32_bf16 v[64:67], a[80:83], a[24:27], v[64:67]
    v_exp_f32 v101, v101
    v_mfma_f32_16x16x32_bf16 v[68:71], a[80:83], a[28:31], v[68:71]
    v_exp_f32 v102, v102
    v_mfma_f32_16x16x32_bf16 v[72:75], a[80:83], a[32:35], v[72:75]
    s_waitcnt lgkmcnt(8)
    v_exp_f32 v103, v103
    v_mfma_f32_16x16x32_bf16 v[64:67], a[84:87], a[36:39], v[64:67]
    v_cvt_pk_bf16_f32 v54, v100, v101
    v_cvt_pk_bf16_f32 v55, v102, v103
    v_mfma_f32_16x16x32_bf16 v[68:71], a[84:87], a[40:43], v[68:71]
    v_exp_f32 v92, v92
    v_mfma_f32_16x16x32_bf16 v[72:75], a[84:87], a[44:47], v[72:75]
    s_waitcnt lgkmcnt(7)
    v_exp_f32 v93, v93
    v_mfma_f32_16x16x32_bf16 v[64:67], a[88:91], a[48:51], v[64:67]
    v_exp_f32 v94, v94
    v_mfma_f32_16x16x32_bf16 v[68:71], a[88:91], a[52:55], v[68:71]
    v_exp_f32 v95, v95
    v_mfma_f32_16x16x32_bf16 v[72:75], a[88:91], a[56:59], v[72:75]
    s_waitcnt lgkmcnt(6)
    v_cvt_pk_bf16_f32 v56, v92, v93
    v_cvt_pk_bf16_f32 v57, v94, v95
    v_mfma_f32_16x16x32_bf16 v[64:67], a[92:95], a[60:63], v[64:67]
    v_exp_f32 v104, v104
    v_mfma_f32_16x16x32_bf16 v[68:71], a[92:95], a[64:67], v[68:71]
    v_exp_f32 v105, v105
    v_mfma_f32_16x16x32_bf16 v[72:75], a[92:95], a[68:71], v[72:75]
    s_waitcnt lgkmcnt(5)
    v_exp_f32 v106, v106
    v_mfma_f32_16x16x32_bf16 v[76:79], a[96:99], a[0:3], v[40:43]
    v_exp_f32 v107, v107
    v_mfma_f32_16x16x32_bf16 v[80:83], a[96:99], a[4:7], v[44:47]
    v_cvt_pk_bf16_f32 v58, v104, v105
    v_cvt_pk_bf16_f32 v59, v106, v107
    v_mfma_f32_16x16x32_bf16 v[84:87], a[96:99], a[8:11], v[48:51]
    s_waitcnt lgkmcnt(4)
    v_exp_f32 v96, v96
    v_mfma_f32_16x16x32_bf16 v[76:79], a[100:103], a[12:15], v[76:79]
    v_exp_f32 v97, v97
    v_mfma_f32_16x16x32_bf16 v[80:83], a[100:103], a[16:19], v[80:83]
    v_exp_f32 v98, v98
    v_mfma_f32_16x16x32_bf16 v[84:87], a[100:103], a[20:23], v[84:87]
    s_waitcnt lgkmcnt(3)
    s_waitcnt lgkmcnt(0)
    s_barrier
    v_exp_f32 v99, v99
    v_mfma_f32_16x16x32_bf16 v[76:79], a[104:107], a[24:27], v[76:79]
    ds_read_b64_tr_b16 a[120:121], v12 offset:12320
    v_add_f32 v37, v37, v88
    v_mfma_f32_16x16x32_bf16 v[80:83], a[104:107], a[28:31], v[80:83]
    v_cvt_pk_bf16_f32 v60, v96, v97
    v_cvt_pk_bf16_f32 v61, v98, v99
    v_mfma_f32_16x16x32_bf16 v[84:87], a[104:107], a[32:35], v[84:87]
    ds_read_b64_tr_b16 a[122:123], v12 offset:18464
    v_add_f32 v37, v37, v89
    v_mfma_f32_16x16x32_bf16 v[76:79], a[108:111], a[36:39], v[76:79]
    v_exp_f32 v108, v108
    v_mfma_f32_16x16x32_bf16 v[80:83], a[108:111], a[40:43], v[80:83]
    ds_read_b64_tr_b16 a[124:125], v13 offset:12320
    v_add_f32 v37, v37, v90
    v_mfma_f32_16x16x32_bf16 v[84:87], a[108:111], a[44:47], v[84:87]
    v_exp_f32 v109, v109
    v_mfma_f32_16x16x32_bf16 v[76:79], a[112:115], a[48:51], v[76:79]
    ds_read_b64_tr_b16 a[126:127], v13 offset:18464
    v_add_f32 v37, v37, v91
    v_mfma_f32_16x16x32_bf16 v[80:83], a[112:115], a[52:55], v[80:83]
    v_exp_f32 v110, v110
    v_mfma_f32_16x16x32_bf16 v[84:87], a[112:115], a[56:59], v[84:87]
    ds_read_b64_tr_b16 a[128:129], v14 offset:12320
    v_add_f32 v37, v37, v100
    v_mfma_f32_16x16x32_bf16 v[76:79], a[116:119], a[60:63], v[76:79]
    v_exp_f32 v111, v111
    v_mfma_f32_16x16x32_bf16 v[80:83], a[116:119], a[64:67], v[80:83]
    ds_read_b64_tr_b16 a[130:131], v14 offset:18464
    v_add_f32 v37, v37, v101
    v_mfma_f32_16x16x32_bf16 v[84:87], a[116:119], a[68:71], v[84:87]
    s_waitcnt lgkmcnt(4)
    v_cvt_pk_bf16_f32 v62, v108, v109
    v_cvt_pk_bf16_f32 v63, v110, v111
    v_mfma_f32_16x16x32_bf16 v[112:115], a[120:123], v[52:55], v[112:115]
    ds_read_b64_tr_b16 a[132:133], v15 offset:12320
    v_add_f32 v38, v38, v92
    v_mfma_f32_16x16x32_bf16 v[116:119], a[120:123], v[56:59], v[116:119]
    ds_read_b64_tr_b16 a[134:135], v15 offset:18464
    v_add_f32 v39, v39, v96
    v_mfma_f32_16x16x32_bf16 v[120:123], a[120:123], v[60:63], v[120:123]
    s_waitcnt lgkmcnt(4)
    s_add_u32 s38, s34, 110592
    ds_read_b64_tr_b16 a[136:137], v12 offset:12448
    v_add_f32 v38, v38, v93
    v_mfma_f32_16x16x32_bf16 v[132:135], a[124:127], v[60:63], v[132:135]
    buffer_load_dwordx4 a[220:223], v21, s[12:15], s38 offen offset:1024 nt
    v_mfma_f32_16x16x32_bf16 v[128:131], a[124:127], v[56:59], v[128:131]
    ds_read_b64_tr_b16 a[138:139], v12 offset:18592
    v_add_f32 v39, v39, v97
    v_mfma_f32_16x16x32_bf16 v[124:127], a[124:127], v[52:55], v[124:127]
    s_waitcnt lgkmcnt(4)
    ds_read_b64_tr_b16 a[140:141], v13 offset:12448
    v_add_f32 v38, v38, v94
    v_mfma_f32_16x16x32_bf16 v[136:139], a[128:131], v[52:55], v[136:139]
    ds_read_b64_tr_b16 a[142:143], v13 offset:18592
    v_add_f32 v39, v39, v98
    v_mfma_f32_16x16x32_bf16 v[140:143], a[128:131], v[56:59], v[140:143]
    ds_read_b64_tr_b16 a[144:145], v14 offset:12448
    v_add_f32 v38, v38, v95
    v_mfma_f32_16x16x32_bf16 v[144:147], a[128:131], v[60:63], v[144:147]
    s_waitcnt lgkmcnt(5)
    ds_read_b64_tr_b16 a[146:147], v14 offset:18592
    v_add_f32 v39, v39, v99
    v_mfma_f32_16x16x32_bf16 v[156:159], a[132:135], v[60:63], v[156:159]
    ds_read_b64_tr_b16 a[148:149], v15 offset:12448
    v_add_f32 v38, v38, v104
    v_mfma_f32_16x16x32_bf16 v[152:155], a[132:135], v[56:59], v[152:155]
    s_add_u32 s38, s34, 110592
    ds_read_b64_tr_b16 a[150:151], v15 offset:18592
    v_add_f32 v39, v39, v108
    v_mfma_f32_16x16x32_bf16 v[148:151], a[132:135], v[52:55], v[148:151]
    s_waitcnt lgkmcnt(6)
    buffer_load_dwordx4 a[224:227], v22, s[12:15], s38 offen offset:2048 nt
    v_mfma_f32_16x16x32_bf16 v[160:163], a[136:139], v[52:55], v[160:163]
    ds_read_b64_tr_b16 a[152:153], v12 offset:12576
    v_add_f32 v38, v38, v105
    v_mfma_f32_16x16x32_bf16 v[164:167], a[136:139], v[56:59], v[164:167]
    ds_read_b64_tr_b16 a[154:155], v12 offset:18720
    v_add_f32 v39, v39, v109
    v_mfma_f32_16x16x32_bf16 v[168:171], a[136:139], v[60:63], v[168:171]
    s_waitcnt lgkmcnt(6)
    ds_read_b64_tr_b16 a[156:157], v13 offset:12576
    v_add_f32 v37, v37, v102
    v_mfma_f32_16x16x32_bf16 v[180:183], a[140:143], v[60:63], v[180:183]
    ds_read_b64_tr_b16 a[158:159], v13 offset:18720
    v_add_f32 v38, v38, v106
    v_mfma_f32_16x16x32_bf16 v[176:179], a[140:143], v[56:59], v[176:179]
    ds_read_b64_tr_b16 a[160:161], v14 offset:12576
    v_add_f32 v39, v39, v110
    v_mfma_f32_16x16x32_bf16 v[172:175], a[140:143], v[52:55], v[172:175]
    s_waitcnt lgkmcnt(7)
    ds_read_b64_tr_b16 a[162:163], v14 offset:18720
    v_add_f32 v37, v37, v103
    v_mfma_f32_16x16x32_bf16 v[184:187], a[144:147], v[52:55], v[184:187]
    s_add_u32 s38, s34, 98304
    ds_read_b64_tr_b16 a[164:165], v15 offset:12576
    v_add_f32 v38, v38, v107
    v_mfma_f32_16x16x32_bf16 v[188:191], a[144:147], v[56:59], v[188:191]
    buffer_load_dwordx4 a[168:171], v23, s[16:19], s38 offen offset:0 nt
    v_mfma_f32_16x16x32_bf16 v[192:195], a[144:147], v[60:63], v[192:195]
    s_waitcnt lgkmcnt(7)
    ds_read_b64_tr_b16 a[166:167], v15 offset:18720
    v_add_f32 v39, v39, v111
    v_mfma_f32_16x16x32_bf16 v[204:207], a[148:151], v[60:63], v[204:207]
    s_add_u32 s30, s34, 123200
    v_lshl_add_u32 v29, v1, 4, s30
    v_mfma_f32_16x16x32_bf16 v[200:203], a[148:151], v[56:59], v[200:203]
    s_waitcnt vmcnt(13)
    ds_write_b128 v29, a[180:183] offset:0
    v_mfma_f32_16x16x32_bf16 v[196:199], a[148:151], v[52:55], v[196:199]
    s_waitcnt lgkmcnt(7)
    s_waitcnt vmcnt(12)
    ds_write_b128 v29, a[184:187] offset:1024
    v_mfma_f32_16x16x32_bf16 v[208:211], a[152:155], v[52:55], v[208:211]
    s_waitcnt vmcnt(11)
    ds_write_b128 v29, a[188:191] offset:2048
    v_mfma_f32_16x16x32_bf16 v[212:215], a[152:155], v[56:59], v[212:215]
    ds_read_b128 a[72:75], v10 offset:0
    v_mfma_f32_16x16x32_bf16 v[216:219], a[152:155], v[60:63], v[216:219]
    s_waitcnt lgkmcnt(8)
    s_mov_b32 s31, 3840
    ds_read_b128 a[76:79], v11 offset:0
    v_mfma_f32_16x16x32_bf16 v[228:231], a[156:159], v[60:63], v[228:231]
    buffer_load_dword a253, v31, s[60:63], s31 offen
    v_mfma_f32_16x16x32_bf16 v[224:227], a[156:159], v[56:59], v[224:227]
    ds_read_b128 a[80:83], v10 offset:128
    v_mfma_f32_16x16x32_bf16 v[220:223], a[156:159], v[52:55], v[220:223]
    s_waitcnt lgkmcnt(8)
    ds_read_b128 a[84:87], v11 offset:128
    v_mfma_f32_16x16x32_bf16 v[232:235], a[160:163], v[52:55], v[232:235]
    ds_read_b128 a[88:91], v10 offset:256
    v_mfma_f32_16x16x32_bf16 v[236:239], a[160:163], v[56:59], v[236:239]
    ds_read_b128 a[92:95], v11 offset:256
    v_mfma_f32_16x16x32_bf16 v[240:243], a[160:163], v[60:63], v[240:243]
    s_waitcnt lgkmcnt(9)
    ds_read_b128 a[96:99], v10 offset:6144
    v_mfma_f32_16x16x32_bf16 v[252:255], a[164:167], v[60:63], v[252:255]
    ds_read_b128 a[100:103], v11 offset:6144
    v_mfma_f32_16x16x32_bf16 v[248:251], a[164:167], v[56:59], v[248:251]
    ds_read_b128 a[104:107], v10 offset:6272
    v_mfma_f32_16x16x32_bf16 v[244:247], a[164:167], v[52:55], v[244:247]
    s_waitcnt lgkmcnt(8)
    ds_read_b128 a[108:111], v11 offset:6272
    ds_read_b128 a[112:115], v10 offset:6400
    ds_read_b128 a[116:119], v11 offset:6400
    v_mfma_f32_16x16x32_bf16 v[88:91], a[72:75], a[0:3], v[40:43]
    v_exp_f32 v64, v64
    v_mfma_f32_16x16x32_bf16 v[92:95], a[72:75], a[4:7], v[44:47]
    v_exp_f32 v65, v65
    v_mfma_f32_16x16x32_bf16 v[96:99], a[72:75], a[8:11], v[48:51]
    s_waitcnt lgkmcnt(10)
    v_exp_f32 v66, v66
    v_mfma_f32_16x16x32_bf16 v[88:91], a[76:79], a[12:15], v[88:91]
    v_exp_f32 v67, v67
    v_mfma_f32_16x16x32_bf16 v[92:95], a[76:79], a[16:19], v[92:95]
    v_cvt_pk_bf16_f32 v52, v64, v65
    v_cvt_pk_bf16_f32 v53, v66, v67
    v_mfma_f32_16x16x32_bf16 v[96:99], a[76:79], a[20:23], v[96:99]
    s_waitcnt lgkmcnt(9)
    v_exp_f32 v76, v76
    v_mfma_f32_16x16x32_bf16 v[88:91], a[80:83], a[24:27], v[88:91]
    v_exp_f32 v77, v77
    v_mfma_f32_16x16x32_bf16 v[92:95], a[80:83], a[28:31], v[92:95]
    v_exp_f32 v78, v78
    v_mfma_f32_16x16x32_bf16 v[96:99], a[80:83], a[32:35], v[96:99]
    s_waitcnt lgkmcnt(8)
    v_exp_f32 v79, v79
    v_mfma_f32_16x16x32_bf16 v[88:91], a[84:87], a[36:39], v[88:91]
    v_cvt_pk_bf16_f32 v54, v76, v77
    v_cvt_pk_bf16_f32 v55, v78, v79
    v_mfma_f32_16x16x32_bf16 v[92:95], a[84:87], a[40:43], v[92:95]
    v_exp_f32 v68, v68
    v_mfma_f32_16x16x32_bf16 v[96:99], a[84:87], a[44:47], v[96:99]
    s_waitcnt lgkmcnt(7)
    v_exp_f32 v69, v69
    v_mfma_f32_16x16x32_bf16 v[88:91], a[88:91], a[48:51], v[88:91]
    v_exp_f32 v70, v70
    v_mfma_f32_16x16x32_bf16 v[92:95], a[88:91], a[52:55], v[92:95]
    v_exp_f32 v71, v71
    v_mfma_f32_16x16x32_bf16 v[96:99], a[88:91], a[56:59], v[96:99]
    s_waitcnt lgkmcnt(6)
    v_cvt_pk_bf16_f32 v56, v68, v69
    v_cvt_pk_bf16_f32 v57, v70, v71
    v_mfma_f32_16x16x32_bf16 v[88:91], a[92:95], a[60:63], v[88:91]
    v_exp_f32 v80, v80
    v_mfma_f32_16x16x32_bf16 v[92:95], a[92:95], a[64:67], v[92:95]
    v_exp_f32 v81, v81
    v_mfma_f32_16x16x32_bf16 v[96:99], a[92:95], a[68:71], v[96:99]
    s_waitcnt lgkmcnt(5)
    v_exp_f32 v82, v82
    v_mfma_f32_16x16x32_bf16 v[100:103], a[96:99], a[0:3], v[40:43]
    v_exp_f32 v83, v83
    v_mfma_f32_16x16x32_bf16 v[104:107], a[96:99], a[4:7], v[44:47]
    v_cvt_pk_bf16_f32 v58, v80, v81
    v_cvt_pk_bf16_f32 v59, v82, v83
    v_mfma_f32_16x16x32_bf16 v[108:111], a[96:99], a[8:11], v[48:51]
    s_waitcnt lgkmcnt(4)
    v_exp_f32 v72, v72
    v_mfma_f32_16x16x32_bf16 v[100:103], a[100:103], a[12:15], v[100:103]
    v_exp_f32 v73, v73
    v_mfma_f32_16x16x32_bf16 v[104:107], a[100:103], a[16:19], v[104:107]
    v_exp_f32 v74, v74
    v_mfma_f32_16x16x32_bf16 v[108:111], a[100:103], a[20:23], v[108:111]
    s_waitcnt lgkmcnt(3)
    s_waitcnt lgkmcnt(0)
    s_barrier
    v_exp_f32 v75, v75
    v_mfma_f32_16x16x32_bf16 v[100:103], a[104:107], a[24:27], v[100:103]
    ds_read_b64_tr_b16 a[120:121], v12 offset:24640
    v_add_f32 v37, v37, v64
    v_mfma_f32_16x16x32_bf16 v[104:107], a[104:107], a[28:31], v[104:107]
    v_cvt_pk_bf16_f32 v60, v72, v73
    v_cvt_pk_bf16_f32 v61, v74, v75
    v_mfma_f32_16x16x32_bf16 v[108:111], a[104:107], a[32:35], v[108:111]
    ds_read_b64_tr_b16 a[122:123], v12 offset:30784
    v_add_f32 v37, v37, v65
    v_mfma_f32_16x16x32_bf16 v[100:103], a[108:111], a[36:39], v[100:103]
    v_exp_f32 v84, v84
    v_mfma_f32_16x16x32_bf16 v[104:107], a[108:111], a[40:43], v[104:107]
    ds_read_b64_tr_b16 a[124:125], v13 offset:24640
    v_add_f32 v37, v37, v66
    v_mfma_f32_16x16x32_bf16 v[108:111], a[108:111], a[44:47], v[108:111]
    v_exp_f32 v85, v85
    v_mfma_f32_16x16x32_bf16 v[100:103], a[112:115], a[48:51], v[100:103]
    ds_read_b64_tr_b16 a[126:127], v13 offset:30784
    v_add_f32 v37, v37, v67
    v_mfma_f32_16x16x32_bf16 v[104:107], a[112:115], a[52:55], v[104:107]
    v_exp_f32 v86, v86
    v_mfma_f32_16x16x32_bf16 v[108:111], a[112:115], a[56:59], v[108:111]
    ds_read_b64_tr_b16 a[128:129], v14 offset:24640
    v_add_f32 v37, v37, v76
    v_mfma_f32_16x16x32_bf16 v[100:103], a[116:119], a[60:63], v[100:103]
    v_exp_f32 v87, v87
    v_mfma_f32_16x16x32_bf16 v[104:107], a[116:119], a[64:67], v[104:107]
    ds_read_b64_tr_b16 a[130:131], v14 offset:30784
    v_add_f32 v37, v37, v77
    v_mfma_f32_16x16x32_bf16 v[108:111], a[116:119], a[68:71], v[108:111]
    s_waitcnt lgkmcnt(4)
    v_cvt_pk_bf16_f32 v62, v84, v85
    v_cvt_pk_bf16_f32 v63, v86, v87
    v_mfma_f32_16x16x32_bf16 v[112:115], a[120:123], v[52:55], v[112:115]
    ds_read_b64_tr_b16 a[132:133], v15 offset:24640
    v_add_f32 v38, v38, v68
    v_mfma_f32_16x16x32_bf16 v[116:119], a[120:123], v[56:59], v[116:119]
    ds_read_b64_tr_b16 a[134:135], v15 offset:30784
    v_add_f32 v39, v39, v72
    v_mfma_f32_16x16x32_bf16 v[120:123], a[120:123], v[60:63], v[120:123]
    s_waitcnt lgkmcnt(4)
    s_add_u32 s38, s34, 98304
    ds_read_b64_tr_b16 a[136:137], v12 offset:24768
    v_add_f32 v38, v38, v69
    v_mfma_f32_16x16x32_bf16 v[132:135], a[124:127], v[60:63], v[132:135]
    buffer_load_dwordx4 a[172:175], v24, s[16:19], s38 offen offset:1024 nt
    v_mfma_f32_16x16x32_bf16 v[128:131], a[124:127], v[56:59], v[128:131]
    ds_read_b64_tr_b16 a[138:139], v12 offset:30912
    v_add_f32 v39, v39, v73
    v_mfma_f32_16x16x32_bf16 v[124:127], a[124:127], v[52:55], v[124:127]
    s_waitcnt lgkmcnt(4)
    ds_read_b64_tr_b16 a[140:141], v13 offset:24768
    v_add_f32 v38, v38, v70
    v_mfma_f32_16x16x32_bf16 v[136:139], a[128:131], v[52:55], v[136:139]
    ds_read_b64_tr_b16 a[142:143], v13 offset:30912
    v_add_f32 v39, v39, v74
    v_mfma_f32_16x16x32_bf16 v[140:143], a[128:131], v[56:59], v[140:143]
    ds_read_b64_tr_b16 a[144:145], v14 offset:24768
    v_add_f32 v38, v38, v71
    v_mfma_f32_16x16x32_bf16 v[144:147], a[128:131], v[60:63], v[144:147]
    s_waitcnt lgkmcnt(5)
    ds_read_b64_tr_b16 a[146:147], v14 offset:30912
    v_add_f32 v39, v39, v75
    v_mfma_f32_16x16x32_bf16 v[156:159], a[132:135], v[60:63], v[156:159]
    ds_read_b64_tr_b16 a[148:149], v15 offset:24768
    v_add_f32 v38, v38, v80
    v_mfma_f32_16x16x32_bf16 v[152:155], a[132:135], v[56:59], v[152:155]
    s_add_u32 s38, s34, 98304
    ds_read_b64_tr_b16 a[150:151], v15 offset:30912
    v_add_f32 v39, v39, v84
    v_mfma_f32_16x16x32_bf16 v[148:151], a[132:135], v[52:55], v[148:151]
    s_waitcnt lgkmcnt(6)
    buffer_load_dwordx4 a[176:179], v25, s[16:19], s38 offen offset:2048 nt
    v_mfma_f32_16x16x32_bf16 v[160:163], a[136:139], v[52:55], v[160:163]
    ds_read_b64_tr_b16 a[152:153], v12 offset:24896
    v_add_f32 v38, v38, v81
    v_mfma_f32_16x16x32_bf16 v[164:167], a[136:139], v[56:59], v[164:167]
    ds_read_b64_tr_b16 a[154:155], v12 offset:31040
    v_add_f32 v39, v39, v85
    v_mfma_f32_16x16x32_bf16 v[168:171], a[136:139], v[60:63], v[168:171]
    s_waitcnt lgkmcnt(6)
    ds_read_b64_tr_b16 a[156:157], v13 offset:24896
    v_add_f32 v37, v37, v78
    v_mfma_f32_16x16x32_bf16 v[180:183], a[140:143], v[60:63], v[180:183]
    ds_read_b64_tr_b16 a[158:159], v13 offset:31040
    v_add_f32 v38, v38, v82
    v_mfma_f32_16x16x32_bf16 v[176:179], a[140:143], v[56:59], v[176:179]
    ds_read_b64_tr_b16 a[160:161], v14 offset:24896
    v_add_f32 v39, v39, v86
    v_mfma_f32_16x16x32_bf16 v[172:175], a[140:143], v[52:55], v[172:175]
    s_waitcnt lgkmcnt(7)
    ds_read_b64_tr_b16 a[162:163], v14 offset:31040
    v_add_f32 v37, v37, v79
    v_mfma_f32_16x16x32_bf16 v[184:187], a[144:147], v[52:55], v[184:187]
    s_add_u32 s38, s34, 122880
    ds_read_b64_tr_b16 a[164:165], v15 offset:24896
    v_add_f32 v38, v38, v83
    v_mfma_f32_16x16x32_bf16 v[188:191], a[144:147], v[56:59], v[188:191]
    buffer_load_dwordx4 a[180:183], v20, s[12:15], s38 offen offset:0 nt
    v_mfma_f32_16x16x32_bf16 v[192:195], a[144:147], v[60:63], v[192:195]
    s_waitcnt lgkmcnt(7)
    ds_read_b64_tr_b16 a[166:167], v15 offset:31040
    v_add_f32 v39, v39, v87
    v_mfma_f32_16x16x32_bf16 v[204:207], a[148:151], v[60:63], v[204:207]
    s_add_u32 s30, s34, 24640
    v_lshl_add_u32 v29, v1, 4, s30
    v_mfma_f32_16x16x32_bf16 v[200:203], a[148:151], v[56:59], v[200:203]
    s_waitcnt vmcnt(14)
    ds_write_b128 v29, a[192:195] offset:0
    v_mfma_f32_16x16x32_bf16 v[196:199], a[148:151], v[52:55], v[196:199]
    s_waitcnt lgkmcnt(7)
    s_waitcnt vmcnt(13)
    ds_write_b128 v29, a[196:199] offset:1024
    v_mfma_f32_16x16x32_bf16 v[208:211], a[152:155], v[52:55], v[208:211]
    s_waitcnt vmcnt(12)
    ds_write_b128 v29, a[200:203] offset:2048
    v_mfma_f32_16x16x32_bf16 v[212:215], a[152:155], v[56:59], v[212:215]
    ds_read_b128 a[72:75], v10 offset:12320
    v_mfma_f32_16x16x32_bf16 v[216:219], a[152:155], v[60:63], v[216:219]
    s_waitcnt lgkmcnt(8)
    s_mov_b32 s31, 7680
    ds_read_b128 a[76:79], v11 offset:12320
    v_mfma_f32_16x16x32_bf16 v[228:231], a[156:159], v[60:63], v[228:231]
    buffer_load_dword a254, v31, s[60:63], s31 offen
    v_mfma_f32_16x16x32_bf16 v[224:227], a[156:159], v[56:59], v[224:227]
    ds_read_b128 a[80:83], v10 offset:12448
    v_mfma_f32_16x16x32_bf16 v[220:223], a[156:159], v[52:55], v[220:223]
    s_waitcnt lgkmcnt(8)
    ds_read_b128 a[84:87], v11 offset:12448
    v_mfma_f32_16x16x32_bf16 v[232:235], a[160:163], v[52:55], v[232:235]
    ds_read_b128 a[88:91], v10 offset:12576
    v_mfma_f32_16x16x32_bf16 v[236:239], a[160:163], v[56:59], v[236:239]
    ds_read_b128 a[92:95], v11 offset:12576
    v_mfma_f32_16x16x32_bf16 v[240:243], a[160:163], v[60:63], v[240:243]
    s_waitcnt lgkmcnt(9)
    ds_read_b128 a[96:99], v10 offset:18464
    v_mfma_f32_16x16x32_bf16 v[252:255], a[164:167], v[60:63], v[252:255]
    ds_read_b128 a[100:103], v11 offset:18464
    v_mfma_f32_16x16x32_bf16 v[248:251], a[164:167], v[56:59], v[248:251]
    ds_read_b128 a[104:107], v10 offset:18592
    v_mfma_f32_16x16x32_bf16 v[244:247], a[164:167], v[52:55], v[244:247]
    s_waitcnt lgkmcnt(8)
    ds_read_b128 a[108:111], v11 offset:18592
    ds_read_b128 a[112:115], v10 offset:18720
    ds_read_b128 a[116:119], v11 offset:18720
    v_mfma_f32_16x16x32_bf16 v[64:67], a[72:75], a[0:3], v[40:43]
    v_exp_f32 v88, v88
    v_mfma_f32_16x16x32_bf16 v[68:71], a[72:75], a[4:7], v[44:47]
    v_exp_f32 v89, v89
    v_mfma_f32_16x16x32_bf16 v[72:75], a[72:75], a[8:11], v[48:51]
    s_waitcnt lgkmcnt(10)
    v_exp_f32 v90, v90
    v_mfma_f32_16x16x32_bf16 v[64:67], a[76:79], a[12:15], v[64:67]
    v_exp_f32 v91, v91
    v_mfma_f32_16x16x32_bf16 v[68:71], a[76:79], a[16:19], v[68:71]
    v_cvt_pk_bf16_f32 v52, v88, v89
    v_cvt_pk_bf16_f32 v53, v90, v91
    v_mfma_f32_16x16x32_bf16 v[72:75], a[76:79], a[20:23], v[72:75]
    s_waitcnt lgkmcnt(9)
    v_exp_f32 v100, v100
    v_mfma_f32_16x16x32_bf16 v[64:67], a[80:83], a[24:27], v[64:67]
    v_exp_f32 v101, v101
    v_mfma_f32_16x16x32_bf16 v[68:71], a[80:83], a[28:31], v[68:71]
    v_exp_f32 v102, v102
    v_mfma_f32_16x16x32_bf16 v[72:75], a[80:83], a[32:35], v[72:75]
    s_waitcnt lgkmcnt(8)
    v_exp_f32 v103, v103
    v_mfma_f32_16x16x32_bf16 v[64:67], a[84:87], a[36:39], v[64:67]
    v_cvt_pk_bf16_f32 v54, v100, v101
    v_cvt_pk_bf16_f32 v55, v102, v103
    v_mfma_f32_16x16x32_bf16 v[68:71], a[84:87], a[40:43], v[68:71]
    v_exp_f32 v92, v92
    v_mfma_f32_16x16x32_bf16 v[72:75], a[84:87], a[44:47], v[72:75]
    s_waitcnt lgkmcnt(7)
    v_exp_f32 v93, v93
    v_mfma_f32_16x16x32_bf16 v[64:67], a[88:91], a[48:51], v[64:67]
    v_exp_f32 v94, v94
    v_mfma_f32_16x16x32_bf16 v[68:71], a[88:91], a[52:55], v[68:71]
    v_exp_f32 v95, v95
    v_mfma_f32_16x16x32_bf16 v[72:75], a[88:91], a[56:59], v[72:75]
    s_waitcnt lgkmcnt(6)
    v_cvt_pk_bf16_f32 v56, v92, v93
    v_cvt_pk_bf16_f32 v57, v94, v95
    v_mfma_f32_16x16x32_bf16 v[64:67], a[92:95], a[60:63], v[64:67]
    v_exp_f32 v104, v104
    v_mfma_f32_16x16x32_bf16 v[68:71], a[92:95], a[64:67], v[68:71]
    v_exp_f32 v105, v105
    v_mfma_f32_16x16x32_bf16 v[72:75], a[92:95], a[68:71], v[72:75]
    s_waitcnt lgkmcnt(5)
    v_exp_f32 v106, v106
    v_mfma_f32_16x16x32_bf16 v[76:79], a[96:99], a[0:3], v[40:43]
    v_exp_f32 v107, v107
    v_mfma_f32_16x16x32_bf16 v[80:83], a[96:99], a[4:7], v[44:47]
    v_cvt_pk_bf16_f32 v58, v104, v105
    v_cvt_pk_bf16_f32 v59, v106, v107
    v_mfma_f32_16x16x32_bf16 v[84:87], a[96:99], a[8:11], v[48:51]
    s_waitcnt lgkmcnt(4)
    v_exp_f32 v96, v96
    v_mfma_f32_16x16x32_bf16 v[76:79], a[100:103], a[12:15], v[76:79]
    v_exp_f32 v97, v97
    v_mfma_f32_16x16x32_bf16 v[80:83], a[100:103], a[16:19], v[80:83]
    v_exp_f32 v98, v98
    v_mfma_f32_16x16x32_bf16 v[84:87], a[100:103], a[20:23], v[84:87]
    s_waitcnt lgkmcnt(3)
    s_waitcnt lgkmcnt(0)
    s_barrier
    v_exp_f32 v99, v99
    v_mfma_f32_16x16x32_bf16 v[76:79], a[104:107], a[24:27], v[76:79]
    ds_read_b64_tr_b16 a[120:121], v16 offset:0
    v_add_f32 v37, v37, v88
    v_mfma_f32_16x16x32_bf16 v[80:83], a[104:107], a[28:31], v[80:83]
    v_cvt_pk_bf16_f32 v60, v96, v97
    v_cvt_pk_bf16_f32 v61, v98, v99
    v_mfma_f32_16x16x32_bf16 v[84:87], a[104:107], a[32:35], v[84:87]
    ds_read_b64_tr_b16 a[122:123], v16 offset:6144
    v_add_f32 v37, v37, v89
    v_mfma_f32_16x16x32_bf16 v[76:79], a[108:111], a[36:39], v[76:79]
    v_exp_f32 v108, v108
    v_mfma_f32_16x16x32_bf16 v[80:83], a[108:111], a[40:43], v[80:83]
    ds_read_b64_tr_b16 a[124:125], v17 offset:0
    v_add_f32 v37, v37, v90
    v_mfma_f32_16x16x32_bf16 v[84:87], a[108:111], a[44:47], v[84:87]
    v_exp_f32 v109, v109
    v_mfma_f32_16x16x32_bf16 v[76:79], a[112:115], a[48:51], v[76:79]
    ds_read_b64_tr_b16 a[126:127], v17 offset:6144
    v_add_f32 v37, v37, v91
    v_mfma_f32_16x16x32_bf16 v[80:83], a[112:115], a[52:55], v[80:83]
    v_exp_f32 v110, v110
    v_mfma_f32_16x16x32_bf16 v[84:87], a[112:115], a[56:59], v[84:87]
    ds_read_b64_tr_b16 a[128:129], v18 offset:0
    v_add_f32 v37, v37, v100
    v_mfma_f32_16x16x32_bf16 v[76:79], a[116:119], a[60:63], v[76:79]
    v_exp_f32 v111, v111
    v_mfma_f32_16x16x32_bf16 v[80:83], a[116:119], a[64:67], v[80:83]
    ds_read_b64_tr_b16 a[130:131], v18 offset:6144
    v_add_f32 v37, v37, v101
    v_mfma_f32_16x16x32_bf16 v[84:87], a[116:119], a[68:71], v[84:87]
    s_waitcnt lgkmcnt(4)
    v_cvt_pk_bf16_f32 v62, v108, v109
    v_cvt_pk_bf16_f32 v63, v110, v111
    v_mfma_f32_16x16x32_bf16 v[112:115], a[120:123], v[52:55], v[112:115]
    ds_read_b64_tr_b16 a[132:133], v19 offset:0
    v_add_f32 v38, v38, v92
    v_mfma_f32_16x16x32_bf16 v[116:119], a[120:123], v[56:59], v[116:119]
    ds_read_b64_tr_b16 a[134:135], v19 offset:6144
    v_add_f32 v39, v39, v96
    v_mfma_f32_16x16x32_bf16 v[120:123], a[120:123], v[60:63], v[120:123]
    s_waitcnt lgkmcnt(4)
    s_add_u32 s38, s34, 122880
    ds_read_b64_tr_b16 a[136:137], v16 offset:128
    v_add_f32 v38, v38, v93
    v_mfma_f32_16x16x32_bf16 v[132:135], a[124:127], v[60:63], v[132:135]
    buffer_load_dwordx4 a[184:187], v21, s[12:15], s38 offen offset:1024 nt
    v_mfma_f32_16x16x32_bf16 v[128:131], a[124:127], v[56:59], v[128:131]
    ds_read_b64_tr_b16 a[138:139], v16 offset:6272
    v_add_f32 v39, v39, v97
    v_mfma_f32_16x16x32_bf16 v[124:127], a[124:127], v[52:55], v[124:127]
    s_waitcnt lgkmcnt(4)
    ds_read_b64_tr_b16 a[140:141], v17 offset:128
    v_add_f32 v38, v38, v94
    v_mfma_f32_16x16x32_bf16 v[136:139], a[128:131], v[52:55], v[136:139]
    ds_read_b64_tr_b16 a[142:143], v17 offset:6272
    v_add_f32 v39, v39, v98
    v_mfma_f32_16x16x32_bf16 v[140:143], a[128:131], v[56:59], v[140:143]
    ds_read_b64_tr_b16 a[144:145], v18 offset:128
    v_add_f32 v38, v38, v95
    v_mfma_f32_16x16x32_bf16 v[144:147], a[128:131], v[60:63], v[144:147]
    s_waitcnt lgkmcnt(5)
    ds_read_b64_tr_b16 a[146:147], v18 offset:6272
    v_add_f32 v39, v39, v99
    v_mfma_f32_16x16x32_bf16 v[156:159], a[132:135], v[60:63], v[156:159]
    ds_read_b64_tr_b16 a[148:149], v19 offset:128
    v_add_f32 v38, v38, v104
    v_mfma_f32_16x16x32_bf16 v[152:155], a[132:135], v[56:59], v[152:155]
    s_add_u32 s38, s34, 122880
    ds_read_b64_tr_b16 a[150:151], v19 offset:6272
    v_add_f32 v39, v39, v108
    v_mfma_f32_16x16x32_bf16 v[148:151], a[132:135], v[52:55], v[148:151]
    s_waitcnt lgkmcnt(6)
    buffer_load_dwordx4 a[188:191], v22, s[12:15], s38 offen offset:2048 nt
    v_mfma_f32_16x16x32_bf16 v[160:163], a[136:139], v[52:55], v[160:163]
    ds_read_b64_tr_b16 a[152:153], v16 offset:256
    v_add_f32 v38, v38, v105
    v_mfma_f32_16x16x32_bf16 v[164:167], a[136:139], v[56:59], v[164:167]
    ds_read_b64_tr_b16 a[154:155], v16 offset:6400
    v_add_f32 v39, v39, v109
    v_mfma_f32_16x16x32_bf16 v[168:171], a[136:139], v[60:63], v[168:171]
    s_waitcnt lgkmcnt(6)
    ds_read_b64_tr_b16 a[156:157], v17 offset:256
    v_add_f32 v37, v37, v102
    v_mfma_f32_16x16x32_bf16 v[180:183], a[140:143], v[60:63], v[180:183]
    ds_read_b64_tr_b16 a[158:159], v17 offset:6400
    v_add_f32 v38, v38, v106
    v_mfma_f32_16x16x32_bf16 v[176:179], a[140:143], v[56:59], v[176:179]
    ds_read_b64_tr_b16 a[160:161], v18 offset:256
    v_add_f32 v39, v39, v110
    v_mfma_f32_16x16x32_bf16 v[172:175], a[140:143], v[52:55], v[172:175]
    s_waitcnt lgkmcnt(7)
    ds_read_b64_tr_b16 a[162:163], v18 offset:6400
    v_add_f32 v37, v37, v103
    v_mfma_f32_16x16x32_bf16 v[184:187], a[144:147], v[52:55], v[184:187]
    s_add_u32 s38, s34, 110592
    ds_read_b64_tr_b16 a[164:165], v19 offset:256
    v_add_f32 v38, v38, v107
    v_mfma_f32_16x16x32_bf16 v[188:191], a[144:147], v[56:59], v[188:191]
    buffer_load_dwordx4 a[192:195], v23, s[16:19], s38 offen offset:0 nt
    v_mfma_f32_16x16x32_bf16 v[192:195], a[144:147], v[60:63], v[192:195]
    s_waitcnt lgkmcnt(7)
    ds_read_b64_tr_b16 a[166:167], v19 offset:6400
    v_add_f32 v39, v39, v111
    v_mfma_f32_16x16x32_bf16 v[204:207], a[148:151], v[60:63], v[204:207]
    s_add_u32 s30, s34, 135520
    v_lshl_add_u32 v29, v1, 4, s30
    v_mfma_f32_16x16x32_bf16 v[200:203], a[148:151], v[56:59], v[200:203]
    s_waitcnt vmcnt(15)
    ds_write_b128 v29, a[204:207] offset:0
    v_mfma_f32_16x16x32_bf16 v[196:199], a[148:151], v[52:55], v[196:199]
    s_waitcnt lgkmcnt(7)
    s_waitcnt vmcnt(14)
    ds_write_b128 v29, a[208:211] offset:1024
    v_mfma_f32_16x16x32_bf16 v[208:211], a[152:155], v[52:55], v[208:211]
    s_waitcnt vmcnt(13)
    ds_write_b128 v29, a[212:215] offset:2048
    v_mfma_f32_16x16x32_bf16 v[212:215], a[152:155], v[56:59], v[212:215]
    ds_read_b128 a[72:75], v10 offset:24640
    v_mfma_f32_16x16x32_bf16 v[216:219], a[152:155], v[60:63], v[216:219]
    s_waitcnt lgkmcnt(8)
    s_mov_b32 s31, 11520
    ds_read_b128 a[76:79], v11 offset:24640
    v_mfma_f32_16x16x32_bf16 v[228:231], a[156:159], v[60:63], v[228:231]
    buffer_load_dword a255, v31, s[60:63], s31 offen
    v_mfma_f32_16x16x32_bf16 v[224:227], a[156:159], v[56:59], v[224:227]
    ds_read_b128 a[80:83], v10 offset:24768
    v_mfma_f32_16x16x32_bf16 v[220:223], a[156:159], v[52:55], v[220:223]
    s_waitcnt lgkmcnt(8)
    ds_read_b128 a[84:87], v11 offset:24768
    v_mfma_f32_16x16x32_bf16 v[232:235], a[160:163], v[52:55], v[232:235]
    ds_read_b128 a[88:91], v10 offset:24896
    v_mfma_f32_16x16x32_bf16 v[236:239], a[160:163], v[56:59], v[236:239]
    ds_read_b128 a[92:95], v11 offset:24896
    v_mfma_f32_16x16x32_bf16 v[240:243], a[160:163], v[60:63], v[240:243]
    s_waitcnt lgkmcnt(9)
    ds_read_b128 a[96:99], v10 offset:30784
    v_mfma_f32_16x16x32_bf16 v[252:255], a[164:167], v[60:63], v[252:255]
    ds_read_b128 a[100:103], v11 offset:30784
    v_mfma_f32_16x16x32_bf16 v[248:251], a[164:167], v[56:59], v[248:251]
    ds_read_b128 a[104:107], v10 offset:30912
    v_mfma_f32_16x16x32_bf16 v[244:247], a[164:167], v[52:55], v[244:247]
    s_waitcnt lgkmcnt(8)
    ds_read_b128 a[108:111], v11 offset:30912
    ds_read_b128 a[112:115], v10 offset:31040
    ds_read_b128 a[116:119], v11 offset:31040
    v_mfma_f32_16x16x32_bf16 v[88:91], a[72:75], a[0:3], v[40:43]
    v_exp_f32 v64, v64
    v_mfma_f32_16x16x32_bf16 v[92:95], a[72:75], a[4:7], v[44:47]
    v_exp_f32 v65, v65
    v_mfma_f32_16x16x32_bf16 v[96:99], a[72:75], a[8:11], v[48:51]
    s_waitcnt lgkmcnt(10)
    v_exp_f32 v66, v66
    v_mfma_f32_16x16x32_bf16 v[88:91], a[76:79], a[12:15], v[88:91]
    v_exp_f32 v67, v67
    v_mfma_f32_16x16x32_bf16 v[92:95], a[76:79], a[16:19], v[92:95]
    v_cvt_pk_bf16_f32 v52, v64, v65
    v_cvt_pk_bf16_f32 v53, v66, v67
    v_mfma_f32_16x16x32_bf16 v[96:99], a[76:79], a[20:23], v[96:99]
    s_waitcnt lgkmcnt(9)
    v_exp_f32 v76, v76
    v_mfma_f32_16x16x32_bf16 v[88:91], a[80:83], a[24:27], v[88:91]
    v_exp_f32 v77, v77
    v_mfma_f32_16x16x32_bf16 v[92:95], a[80:83], a[28:31], v[92:95]
    v_exp_f32 v78, v78
    v_mfma_f32_16x16x32_bf16 v[96:99], a[80:83], a[32:35], v[96:99]
    s_waitcnt lgkmcnt(8)
    v_exp_f32 v79, v79
    v_mfma_f32_16x16x32_bf16 v[88:91], a[84:87], a[36:39], v[88:91]
    v_cvt_pk_bf16_f32 v54, v76, v77
    v_cvt_pk_bf16_f32 v55, v78, v79
    v_mfma_f32_16x16x32_bf16 v[92:95], a[84:87], a[40:43], v[92:95]
    v_exp_f32 v68, v68
    v_mfma_f32_16x16x32_bf16 v[96:99], a[84:87], a[44:47], v[96:99]
    s_waitcnt lgkmcnt(7)
    v_exp_f32 v69, v69
    v_mfma_f32_16x16x32_bf16 v[88:91], a[88:91], a[48:51], v[88:91]
    v_exp_f32 v70, v70
    v_mfma_f32_16x16x32_bf16 v[92:95], a[88:91], a[52:55], v[92:95]
    v_exp_f32 v71, v71
    v_mfma_f32_16x16x32_bf16 v[96:99], a[88:91], a[56:59], v[96:99]
    s_waitcnt lgkmcnt(6)
    v_cvt_pk_bf16_f32 v56, v68, v69
    v_cvt_pk_bf16_f32 v57, v70, v71
    v_mfma_f32_16x16x32_bf16 v[88:91], a[92:95], a[60:63], v[88:91]
    v_exp_f32 v80, v80
    v_mfma_f32_16x16x32_bf16 v[92:95], a[92:95], a[64:67], v[92:95]
    v_exp_f32 v81, v81
    v_mfma_f32_16x16x32_bf16 v[96:99], a[92:95], a[68:71], v[96:99]
    s_waitcnt lgkmcnt(5)
    v_exp_f32 v82, v82
    v_mfma_f32_16x16x32_bf16 v[100:103], a[96:99], a[0:3], v[40:43]
    v_exp_f32 v83, v83
    v_mfma_f32_16x16x32_bf16 v[104:107], a[96:99], a[4:7], v[44:47]
    v_cvt_pk_bf16_f32 v58, v80, v81
    v_cvt_pk_bf16_f32 v59, v82, v83
    v_mfma_f32_16x16x32_bf16 v[108:111], a[96:99], a[8:11], v[48:51]
    s_waitcnt lgkmcnt(4)
    v_exp_f32 v72, v72
    v_mfma_f32_16x16x32_bf16 v[100:103], a[100:103], a[12:15], v[100:103]
    v_exp_f32 v73, v73
    v_mfma_f32_16x16x32_bf16 v[104:107], a[100:103], a[16:19], v[104:107]
    v_exp_f32 v74, v74
    v_mfma_f32_16x16x32_bf16 v[108:111], a[100:103], a[20:23], v[108:111]
    s_waitcnt lgkmcnt(3)
    s_waitcnt lgkmcnt(0)
    s_barrier
    v_exp_f32 v75, v75
    v_mfma_f32_16x16x32_bf16 v[100:103], a[104:107], a[24:27], v[100:103]
    ds_read_b64_tr_b16 a[120:121], v16 offset:12320
    v_add_f32 v37, v37, v64
    v_mfma_f32_16x16x32_bf16 v[104:107], a[104:107], a[28:31], v[104:107]
    v_cvt_pk_bf16_f32 v60, v72, v73
    v_cvt_pk_bf16_f32 v61, v74, v75
    v_mfma_f32_16x16x32_bf16 v[108:111], a[104:107], a[32:35], v[108:111]
    ds_read_b64_tr_b16 a[122:123], v16 offset:18464
    v_add_f32 v37, v37, v65
    v_mfma_f32_16x16x32_bf16 v[100:103], a[108:111], a[36:39], v[100:103]
    v_exp_f32 v84, v84
    v_mfma_f32_16x16x32_bf16 v[104:107], a[108:111], a[40:43], v[104:107]
    ds_read_b64_tr_b16 a[124:125], v17 offset:12320
    v_add_f32 v37, v37, v66
    v_mfma_f32_16x16x32_bf16 v[108:111], a[108:111], a[44:47], v[108:111]
    v_exp_f32 v85, v85
    v_mfma_f32_16x16x32_bf16 v[100:103], a[112:115], a[48:51], v[100:103]
    ds_read_b64_tr_b16 a[126:127], v17 offset:18464
    v_add_f32 v37, v37, v67
    v_mfma_f32_16x16x32_bf16 v[104:107], a[112:115], a[52:55], v[104:107]
    v_exp_f32 v86, v86
    v_mfma_f32_16x16x32_bf16 v[108:111], a[112:115], a[56:59], v[108:111]
    ds_read_b64_tr_b16 a[128:129], v18 offset:12320
    v_add_f32 v37, v37, v76
    v_mfma_f32_16x16x32_bf16 v[100:103], a[116:119], a[60:63], v[100:103]
    v_exp_f32 v87, v87
    v_mfma_f32_16x16x32_bf16 v[104:107], a[116:119], a[64:67], v[104:107]
    ds_read_b64_tr_b16 a[130:131], v18 offset:18464
    v_add_f32 v37, v37, v77
    v_mfma_f32_16x16x32_bf16 v[108:111], a[116:119], a[68:71], v[108:111]
    s_waitcnt lgkmcnt(4)
    v_cvt_pk_bf16_f32 v62, v84, v85
    v_cvt_pk_bf16_f32 v63, v86, v87
    v_mfma_f32_16x16x32_bf16 v[112:115], a[120:123], v[52:55], v[112:115]
    ds_read_b64_tr_b16 a[132:133], v19 offset:12320
    v_add_f32 v38, v38, v68
    v_mfma_f32_16x16x32_bf16 v[116:119], a[120:123], v[56:59], v[116:119]
    ds_read_b64_tr_b16 a[134:135], v19 offset:18464
    v_add_f32 v39, v39, v72
    v_mfma_f32_16x16x32_bf16 v[120:123], a[120:123], v[60:63], v[120:123]
    s_waitcnt lgkmcnt(4)
    s_add_u32 s38, s34, 110592
    ds_read_b64_tr_b16 a[136:137], v16 offset:12448
    v_add_f32 v38, v38, v69
    v_mfma_f32_16x16x32_bf16 v[132:135], a[124:127], v[60:63], v[132:135]
    buffer_load_dwordx4 a[196:199], v24, s[16:19], s38 offen offset:1024 nt
    v_mfma_f32_16x16x32_bf16 v[128:131], a[124:127], v[56:59], v[128:131]
    ds_read_b64_tr_b16 a[138:139], v16 offset:18592
    v_add_f32 v39, v39, v73
    v_mfma_f32_16x16x32_bf16 v[124:127], a[124:127], v[52:55], v[124:127]
    s_waitcnt lgkmcnt(4)
    ds_read_b64_tr_b16 a[140:141], v17 offset:12448
    v_add_f32 v38, v38, v70
    v_mfma_f32_16x16x32_bf16 v[136:139], a[128:131], v[52:55], v[136:139]
    ds_read_b64_tr_b16 a[142:143], v17 offset:18592
    v_add_f32 v39, v39, v74
    v_mfma_f32_16x16x32_bf16 v[140:143], a[128:131], v[56:59], v[140:143]
    ds_read_b64_tr_b16 a[144:145], v18 offset:12448
    v_add_f32 v38, v38, v71
    v_mfma_f32_16x16x32_bf16 v[144:147], a[128:131], v[60:63], v[144:147]
    s_waitcnt lgkmcnt(5)
    ds_read_b64_tr_b16 a[146:147], v18 offset:18592
    v_add_f32 v39, v39, v75
    v_mfma_f32_16x16x32_bf16 v[156:159], a[132:135], v[60:63], v[156:159]
    ds_read_b64_tr_b16 a[148:149], v19 offset:12448
    v_add_f32 v38, v38, v80
    v_mfma_f32_16x16x32_bf16 v[152:155], a[132:135], v[56:59], v[152:155]
    s_add_u32 s38, s34, 110592
    ds_read_b64_tr_b16 a[150:151], v19 offset:18592
    v_add_f32 v39, v39, v84
    v_mfma_f32_16x16x32_bf16 v[148:151], a[132:135], v[52:55], v[148:151]
    s_waitcnt lgkmcnt(6)
    buffer_load_dwordx4 a[200:203], v25, s[16:19], s38 offen offset:2048 nt
    v_mfma_f32_16x16x32_bf16 v[160:163], a[136:139], v[52:55], v[160:163]
    ds_read_b64_tr_b16 a[152:153], v16 offset:12576
    v_add_f32 v38, v38, v81
    v_mfma_f32_16x16x32_bf16 v[164:167], a[136:139], v[56:59], v[164:167]
    ds_read_b64_tr_b16 a[154:155], v16 offset:18720
    v_add_f32 v39, v39, v85
    v_mfma_f32_16x16x32_bf16 v[168:171], a[136:139], v[60:63], v[168:171]
    s_waitcnt lgkmcnt(6)
    ds_read_b64_tr_b16 a[156:157], v17 offset:12576
    v_add_f32 v37, v37, v78
    v_mfma_f32_16x16x32_bf16 v[180:183], a[140:143], v[60:63], v[180:183]
    ds_read_b64_tr_b16 a[158:159], v17 offset:18720
    v_add_f32 v38, v38, v82
    v_mfma_f32_16x16x32_bf16 v[176:179], a[140:143], v[56:59], v[176:179]
    ds_read_b64_tr_b16 a[160:161], v18 offset:12576
    v_add_f32 v39, v39, v86
    v_mfma_f32_16x16x32_bf16 v[172:175], a[140:143], v[52:55], v[172:175]
    s_waitcnt lgkmcnt(7)
    s_add_u32 s39, s34, 135168
    ds_read_b64_tr_b16 a[162:163], v18 offset:18720
    v_add_f32 v37, v37, v79
    v_mfma_f32_16x16x32_bf16 v[184:187], a[144:147], v[52:55], v[184:187]
    s_add_u32 m0, s34, 61600
    ds_read_b64_tr_b16 a[164:165], v19 offset:12576
    v_add_f32 v38, v38, v83
    v_mfma_f32_16x16x32_bf16 v[188:191], a[144:147], v[56:59], v[188:191]
    buffer_load_dwordx4 v20, s[12:15], s39 offen offset:0 nt lds
    v_mfma_f32_16x16x32_bf16 v[192:195], a[144:147], v[60:63], v[192:195]
    s_waitcnt lgkmcnt(7)
    ds_read_b64_tr_b16 a[166:167], v19 offset:18720
    v_add_f32 v39, v39, v87
    v_mfma_f32_16x16x32_bf16 v[204:207], a[148:151], v[60:63], v[204:207]
    s_add_u32 s30, s34, 36960
    v_lshl_add_u32 v29, v1, 4, s30
    v_mfma_f32_16x16x32_bf16 v[200:203], a[148:151], v[56:59], v[200:203]
    s_waitcnt vmcnt(16)
    ds_write_b128 v29, a[216:219] offset:0
    v_mfma_f32_16x16x32_bf16 v[196:199], a[148:151], v[52:55], v[196:199]
    s_waitcnt lgkmcnt(7)
    s_waitcnt vmcnt(14)
    ds_write_b128 v29, a[220:223] offset:1024
    v_mfma_f32_16x16x32_bf16 v[208:211], a[152:155], v[52:55], v[208:211]
    s_waitcnt vmcnt(13)
    ds_write_b128 v29, a[224:227] offset:2048
    v_mfma_f32_16x16x32_bf16 v[212:215], a[152:155], v[56:59], v[212:215]
    ds_read_b128 a[72:75], v8 offset:0
    v_mfma_f32_16x16x32_bf16 v[216:219], a[152:155], v[60:63], v[216:219]
    s_waitcnt lgkmcnt(8)
    s_mov_b32 s31, 15360
    ds_read_b128 a[76:79], v9 offset:0
    v_mfma_f32_16x16x32_bf16 v[228:231], a[156:159], v[60:63], v[228:231]
    buffer_load_dword a252, v31, s[60:63], s31 offen
    v_mfma_f32_16x16x32_bf16 v[224:227], a[156:159], v[56:59], v[224:227]
    ds_read_b128 a[80:83], v8 offset:128
    v_mfma_f32_16x16x32_bf16 v[220:223], a[156:159], v[52:55], v[220:223]
    s_waitcnt lgkmcnt(8)
    ds_read_b128 a[84:87], v9 offset:128
    v_mfma_f32_16x16x32_bf16 v[232:235], a[160:163], v[52:55], v[232:235]
    ds_read_b128 a[88:91], v8 offset:256
    v_mfma_f32_16x16x32_bf16 v[236:239], a[160:163], v[56:59], v[236:239]
    ds_read_b128 a[92:95], v9 offset:256
    v_mfma_f32_16x16x32_bf16 v[240:243], a[160:163], v[60:63], v[240:243]
    s_waitcnt lgkmcnt(9)
    ds_read_b128 a[96:99], v8 offset:6144
    v_mfma_f32_16x16x32_bf16 v[252:255], a[164:167], v[60:63], v[252:255]
    ds_read_b128 a[100:103], v9 offset:6144
    v_mfma_f32_16x16x32_bf16 v[248:251], a[164:167], v[56:59], v[248:251]
    ds_read_b128 a[104:107], v8 offset:6272
    v_mfma_f32_16x16x32_bf16 v[244:247], a[164:167], v[52:55], v[244:247]
    s_waitcnt lgkmcnt(8)
    ds_read_b128 a[108:111], v9 offset:6272
    ds_read_b128 a[112:115], v8 offset:6400
    ds_read_b128 a[116:119], v9 offset:6400
    v_mfma_f32_16x16x32_bf16 v[64:67], a[72:75], a[0:3], v[40:43]
    v_exp_f32 v88, v88
    v_mfma_f32_16x16x32_bf16 v[68:71], a[72:75], a[4:7], v[44:47]
    v_exp_f32 v89, v89
    v_mfma_f32_16x16x32_bf16 v[72:75], a[72:75], a[8:11], v[48:51]
    s_waitcnt lgkmcnt(10)
    v_exp_f32 v90, v90
    v_mfma_f32_16x16x32_bf16 v[64:67], a[76:79], a[12:15], v[64:67]
    v_exp_f32 v91, v91
    v_mfma_f32_16x16x32_bf16 v[68:71], a[76:79], a[16:19], v[68:71]
    v_cvt_pk_bf16_f32 v52, v88, v89
    v_cvt_pk_bf16_f32 v53, v90, v91
    v_mfma_f32_16x16x32_bf16 v[72:75], a[76:79], a[20:23], v[72:75]
    s_waitcnt lgkmcnt(9)
    v_exp_f32 v100, v100
    v_mfma_f32_16x16x32_bf16 v[64:67], a[80:83], a[24:27], v[64:67]
    v_exp_f32 v101, v101
    v_mfma_f32_16x16x32_bf16 v[68:71], a[80:83], a[28:31], v[68:71]
    v_exp_f32 v102, v102
    v_mfma_f32_16x16x32_bf16 v[72:75], a[80:83], a[32:35], v[72:75]
    s_waitcnt lgkmcnt(8)
    v_exp_f32 v103, v103
    v_mfma_f32_16x16x32_bf16 v[64:67], a[84:87], a[36:39], v[64:67]
    v_cvt_pk_bf16_f32 v54, v100, v101
    v_cvt_pk_bf16_f32 v55, v102, v103
    v_mfma_f32_16x16x32_bf16 v[68:71], a[84:87], a[40:43], v[68:71]
    v_exp_f32 v92, v92
    v_mfma_f32_16x16x32_bf16 v[72:75], a[84:87], a[44:47], v[72:75]
    s_waitcnt lgkmcnt(7)
    v_exp_f32 v93, v93
    v_mfma_f32_16x16x32_bf16 v[64:67], a[88:91], a[48:51], v[64:67]
    v_exp_f32 v94, v94
    v_mfma_f32_16x16x32_bf16 v[68:71], a[88:91], a[52:55], v[68:71]
    v_exp_f32 v95, v95
    v_mfma_f32_16x16x32_bf16 v[72:75], a[88:91], a[56:59], v[72:75]
    s_waitcnt lgkmcnt(6)
    v_cvt_pk_bf16_f32 v56, v92, v93
    v_cvt_pk_bf16_f32 v57, v94, v95
    v_mfma_f32_16x16x32_bf16 v[64:67], a[92:95], a[60:63], v[64:67]
    v_exp_f32 v104, v104
    v_mfma_f32_16x16x32_bf16 v[68:71], a[92:95], a[64:67], v[68:71]
    v_exp_f32 v105, v105
    v_mfma_f32_16x16x32_bf16 v[72:75], a[92:95], a[68:71], v[72:75]
    s_waitcnt lgkmcnt(5)
    v_exp_f32 v106, v106
    v_mfma_f32_16x16x32_bf16 v[76:79], a[96:99], a[0:3], v[40:43]
    v_exp_f32 v107, v107
    v_mfma_f32_16x16x32_bf16 v[80:83], a[96:99], a[4:7], v[44:47]
    v_cvt_pk_bf16_f32 v58, v104, v105
    v_cvt_pk_bf16_f32 v59, v106, v107
    v_mfma_f32_16x16x32_bf16 v[84:87], a[96:99], a[8:11], v[48:51]
    s_waitcnt lgkmcnt(4)
    v_exp_f32 v96, v96
    v_mfma_f32_16x16x32_bf16 v[76:79], a[100:103], a[12:15], v[76:79]
    v_exp_f32 v97, v97
    v_mfma_f32_16x16x32_bf16 v[80:83], a[100:103], a[16:19], v[80:83]
    v_exp_f32 v98, v98
    v_mfma_f32_16x16x32_bf16 v[84:87], a[100:103], a[20:23], v[84:87]
    s_waitcnt lgkmcnt(3)
    s_waitcnt lgkmcnt(0)
    s_barrier
    v_exp_f32 v99, v99
    v_mfma_f32_16x16x32_bf16 v[76:79], a[104:107], a[24:27], v[76:79]
    ds_read_b64_tr_b16 a[120:121], v16 offset:24640
    v_add_f32 v37, v37, v88
    v_mfma_f32_16x16x32_bf16 v[80:83], a[104:107], a[28:31], v[80:83]
    v_cvt_pk_bf16_f32 v60, v96, v97
    v_cvt_pk_bf16_f32 v61, v98, v99
    v_mfma_f32_16x16x32_bf16 v[84:87], a[104:107], a[32:35], v[84:87]
    ds_read_b64_tr_b16 a[122:123], v16 offset:30784
    v_add_f32 v37, v37, v89
    v_mfma_f32_16x16x32_bf16 v[76:79], a[108:111], a[36:39], v[76:79]
    v_exp_f32 v108, v108
    v_mfma_f32_16x16x32_bf16 v[80:83], a[108:111], a[40:43], v[80:83]
    ds_read_b64_tr_b16 a[124:125], v17 offset:24640
    v_add_f32 v37, v37, v90
    v_mfma_f32_16x16x32_bf16 v[84:87], a[108:111], a[44:47], v[84:87]
    v_exp_f32 v109, v109
    v_mfma_f32_16x16x32_bf16 v[76:79], a[112:115], a[48:51], v[76:79]
    ds_read_b64_tr_b16 a[126:127], v17 offset:30784
    v_add_f32 v37, v37, v91
    v_mfma_f32_16x16x32_bf16 v[80:83], a[112:115], a[52:55], v[80:83]
    v_exp_f32 v110, v110
    v_mfma_f32_16x16x32_bf16 v[84:87], a[112:115], a[56:59], v[84:87]
    ds_read_b64_tr_b16 a[128:129], v18 offset:24640
    v_add_f32 v37, v37, v100
    v_mfma_f32_16x16x32_bf16 v[76:79], a[116:119], a[60:63], v[76:79]
    v_exp_f32 v111, v111
    v_mfma_f32_16x16x32_bf16 v[80:83], a[116:119], a[64:67], v[80:83]
    ds_read_b64_tr_b16 a[130:131], v18 offset:30784
    v_add_f32 v37, v37, v101
    v_mfma_f32_16x16x32_bf16 v[84:87], a[116:119], a[68:71], v[84:87]
    s_waitcnt lgkmcnt(4)
    v_cvt_pk_bf16_f32 v62, v108, v109
    v_cvt_pk_bf16_f32 v63, v110, v111
    v_mfma_f32_16x16x32_bf16 v[112:115], a[120:123], v[52:55], v[112:115]
    ds_read_b64_tr_b16 a[132:133], v19 offset:24640
    v_add_f32 v38, v38, v92
    v_mfma_f32_16x16x32_bf16 v[116:119], a[120:123], v[56:59], v[116:119]
    ds_read_b64_tr_b16 a[134:135], v19 offset:30784
    v_add_f32 v39, v39, v96
    v_mfma_f32_16x16x32_bf16 v[120:123], a[120:123], v[60:63], v[120:123]
    s_waitcnt lgkmcnt(4)
    ds_read_b64_tr_b16 a[136:137], v16 offset:24768
    v_add_f32 v38, v38, v93
    v_mfma_f32_16x16x32_bf16 v[132:135], a[124:127], v[60:63], v[132:135]
    buffer_load_dwordx4 v21, s[12:15], s39 offen offset:1024 nt lds
    v_mfma_f32_16x16x32_bf16 v[128:131], a[124:127], v[56:59], v[128:131]
    ds_read_b64_tr_b16 a[138:139], v16 offset:30912
    v_add_f32 v39, v39, v97
    v_mfma_f32_16x16x32_bf16 v[124:127], a[124:127], v[52:55], v[124:127]
    s_waitcnt lgkmcnt(4)
    ds_read_b64_tr_b16 a[140:141], v17 offset:24768
    v_add_f32 v38, v38, v94
    v_mfma_f32_16x16x32_bf16 v[136:139], a[128:131], v[52:55], v[136:139]
    ds_read_b64_tr_b16 a[142:143], v17 offset:30912
    v_add_f32 v39, v39, v98
    v_mfma_f32_16x16x32_bf16 v[140:143], a[128:131], v[56:59], v[140:143]
    ds_read_b64_tr_b16 a[144:145], v18 offset:24768
    v_add_f32 v38, v38, v95
    v_mfma_f32_16x16x32_bf16 v[144:147], a[128:131], v[60:63], v[144:147]
    s_waitcnt lgkmcnt(5)
    ds_read_b64_tr_b16 a[146:147], v18 offset:30912
    v_add_f32 v39, v39, v99
    v_mfma_f32_16x16x32_bf16 v[156:159], a[132:135], v[60:63], v[156:159]
    buffer_load_dwordx4 v22, s[12:15], s39 offen offset:2048 nt lds
    v_mfma_f32_16x16x32_bf16 v[152:155], a[132:135], v[56:59], v[152:155]
    ds_read_b64_tr_b16 a[148:149], v19 offset:24768
    v_add_f32 v38, v38, v104
    v_mfma_f32_16x16x32_bf16 v[148:151], a[132:135], v[52:55], v[148:151]
    s_waitcnt lgkmcnt(5)
    ds_read_b64_tr_b16 a[150:151], v19 offset:30912
    v_add_f32 v39, v39, v108
    v_mfma_f32_16x16x32_bf16 v[160:163], a[136:139], v[52:55], v[160:163]
    ds_read_b64_tr_b16 a[152:153], v16 offset:24896
    v_add_f32 v38, v38, v105
    v_mfma_f32_16x16x32_bf16 v[164:167], a[136:139], v[56:59], v[164:167]
    ds_read_b64_tr_b16 a[154:155], v16 offset:31040
    v_add_f32 v39, v39, v109
    v_mfma_f32_16x16x32_bf16 v[168:171], a[136:139], v[60:63], v[168:171]
    s_waitcnt lgkmcnt(6)
    s_add_u32 s39, s34, 122880
    ds_read_b64_tr_b16 a[156:157], v17 offset:24896
    v_add_f32 v37, v37, v102
    v_mfma_f32_16x16x32_bf16 v[180:183], a[140:143], v[60:63], v[180:183]
    s_add_u32 m0, s34, 98560
    ds_read_b64_tr_b16 a[158:159], v17 offset:31040
    v_add_f32 v38, v38, v106
    v_mfma_f32_16x16x32_bf16 v[176:179], a[140:143], v[56:59], v[176:179]
    buffer_load_dwordx4 v23, s[16:19], s39 offen offset:0 nt lds
    v_mfma_f32_16x16x32_bf16 v[172:175], a[140:143], v[52:55], v[172:175]
    s_waitcnt lgkmcnt(6)
    ds_read_b64_tr_b16 a[160:161], v18 offset:24896
    v_add_f32 v39, v39, v110
    v_mfma_f32_16x16x32_bf16 v[184:187], a[144:147], v[52:55], v[184:187]
    ds_read_b64_tr_b16 a[162:163], v18 offset:31040
    v_add_f32 v37, v37, v103
    v_mfma_f32_16x16x32_bf16 v[188:191], a[144:147], v[56:59], v[188:191]
    ds_read_b64_tr_b16 a[164:165], v19 offset:24896
    v_add_f32 v38, v38, v107
    v_mfma_f32_16x16x32_bf16 v[192:195], a[144:147], v[60:63], v[192:195]
    s_waitcnt lgkmcnt(7)
    ds_read_b64_tr_b16 a[166:167], v19 offset:31040
    v_add_f32 v39, v39, v111
    v_mfma_f32_16x16x32_bf16 v[204:207], a[148:151], v[60:63], v[204:207]
    s_add_u32 s0, s56, 32768
    s_addc_u32 s1, s57, 0
    s_add_u32 s30, s34, 147840
    v_lshl_add_u32 v29, v1, 4, s30
    v_mfma_f32_16x16x32_bf16 v[200:203], a[148:151], v[56:59], v[200:203]
    s_waitcnt vmcnt(11)
    global_load_dword a254, v0, s[0:1]
    v_mfma_f32_16x16x32_bf16 v[196:199], a[148:151], v[52:55], v[196:199]
    s_waitcnt lgkmcnt(6)
    ds_write_b128 v29, a[168:171] offset:0
    v_mfma_f32_16x16x32_bf16 v[208:211], a[152:155], v[52:55], v[208:211]
    ds_write_b128 v29, a[172:175] offset:1024
    v_mfma_f32_16x16x32_bf16 v[212:215], a[152:155], v[56:59], v[212:215]
    ds_write_b128 v29, a[176:179] offset:2048
    v_mfma_f32_16x16x32_bf16 v[216:219], a[152:155], v[60:63], v[216:219]
    s_waitcnt lgkmcnt(7)
    ds_read_b128 a[72:75], v8 offset:12320
    v_mfma_f32_16x16x32_bf16 v[228:231], a[156:159], v[60:63], v[228:231]
    ds_read_b128 a[76:79], v9 offset:12320
    v_mfma_f32_16x16x32_bf16 v[224:227], a[156:159], v[56:59], v[224:227]
    s_mov_b32 s31, 19200
    ds_read_b128 a[80:83], v8 offset:12448
    v_mfma_f32_16x16x32_bf16 v[220:223], a[156:159], v[52:55], v[220:223]
    s_waitcnt lgkmcnt(8)
    buffer_load_dword a253, v31, s[60:63], s31 offen
    v_mfma_f32_16x16x32_bf16 v[232:235], a[160:163], v[52:55], v[232:235]
    ds_read_b128 a[84:87], v9 offset:12448
    v_mfma_f32_16x16x32_bf16 v[236:239], a[160:163], v[56:59], v[236:239]
    ds_read_b128 a[88:91], v8 offset:12576
    v_mfma_f32_16x16x32_bf16 v[240:243], a[160:163], v[60:63], v[240:243]
    s_waitcnt lgkmcnt(8)
    ds_read_b128 a[92:95], v9 offset:12576
    v_mfma_f32_16x16x32_bf16 v[252:255], a[164:167], v[60:63], v[252:255]
    ds_read_b128 a[96:99], v8 offset:18464
    v_mfma_f32_16x16x32_bf16 v[248:251], a[164:167], v[56:59], v[248:251]
    ds_read_b128 a[100:103], v9 offset:18464
    v_mfma_f32_16x16x32_bf16 v[244:247], a[164:167], v[52:55], v[244:247]
    s_waitcnt lgkmcnt(7)
    ds_read_b128 a[104:107], v8 offset:18592
    ds_read_b128 a[108:111], v9 offset:18592
    ds_read_b128 a[112:115], v8 offset:18720
    ds_read_b128 a[116:119], v9 offset:18720
    v_mfma_f32_16x16x32_bf16 v[88:91], a[72:75], a[0:3], v[40:43]
    v_exp_f32 v64, v64
    v_mfma_f32_16x16x32_bf16 v[92:95], a[72:75], a[4:7], v[44:47]
    v_exp_f32 v65, v65
    v_mfma_f32_16x16x32_bf16 v[96:99], a[72:75], a[8:11], v[48:51]
    s_waitcnt lgkmcnt(10)
    v_exp_f32 v66, v66
    v_mfma_f32_16x16x32_bf16 v[88:91], a[76:79], a[12:15], v[88:91]
    v_exp_f32 v67, v67
    v_mfma_f32_16x16x32_bf16 v[92:95], a[76:79], a[16:19], v[92:95]
    v_cvt_pk_bf16_f32 v52, v64, v65
    v_cvt_pk_bf16_f32 v53, v66, v67
    v_mfma_f32_16x16x32_bf16 v[96:99], a[76:79], a[20:23], v[96:99]
    s_waitcnt lgkmcnt(9)
    v_exp_f32 v76, v76
    v_mfma_f32_16x16x32_bf16 v[88:91], a[80:83], a[24:27], v[88:91]
    v_exp_f32 v77, v77
    v_mfma_f32_16x16x32_bf16 v[92:95], a[80:83], a[28:31], v[92:95]
    v_exp_f32 v78, v78
    v_mfma_f32_16x16x32_bf16 v[96:99], a[80:83], a[32:35], v[96:99]
    s_waitcnt lgkmcnt(8)
    v_exp_f32 v79, v79
    v_mfma_f32_16x16x32_bf16 v[88:91], a[84:87], a[36:39], v[88:91]
    v_cvt_pk_bf16_f32 v54, v76, v77
    v_cvt_pk_bf16_f32 v55, v78, v79
    v_mfma_f32_16x16x32_bf16 v[92:95], a[84:87], a[40:43], v[92:95]
    v_exp_f32 v68, v68
    v_mfma_f32_16x16x32_bf16 v[96:99], a[84:87], a[44:47], v[96:99]
    s_waitcnt lgkmcnt(7)
    v_exp_f32 v69, v69
    v_mfma_f32_16x16x32_bf16 v[88:91], a[88:91], a[48:51], v[88:91]
    v_exp_f32 v70, v70
    v_mfma_f32_16x16x32_bf16 v[92:95], a[88:91], a[52:55], v[92:95]
    v_exp_f32 v71, v71
    v_mfma_f32_16x16x32_bf16 v[96:99], a[88:91], a[56:59], v[96:99]
    s_waitcnt lgkmcnt(6)
    v_cvt_pk_bf16_f32 v56, v68, v69
    v_cvt_pk_bf16_f32 v57, v70, v71
    v_mfma_f32_16x16x32_bf16 v[88:91], a[92:95], a[60:63], v[88:91]
    v_exp_f32 v80, v80
    v_mfma_f32_16x16x32_bf16 v[92:95], a[92:95], a[64:67], v[92:95]
    v_exp_f32 v81, v81
    v_mfma_f32_16x16x32_bf16 v[96:99], a[92:95], a[68:71], v[96:99]
    s_waitcnt lgkmcnt(5)
    v_exp_f32 v82, v82
    v_mfma_f32_16x16x32_bf16 v[100:103], a[96:99], a[0:3], v[40:43]
    v_exp_f32 v83, v83
    v_mfma_f32_16x16x32_bf16 v[104:107], a[96:99], a[4:7], v[44:47]
    v_cvt_pk_bf16_f32 v58, v80, v81
    v_cvt_pk_bf16_f32 v59, v82, v83
    v_mfma_f32_16x16x32_bf16 v[108:111], a[96:99], a[8:11], v[48:51]
    s_waitcnt lgkmcnt(4)
    v_exp_f32 v72, v72
    v_mfma_f32_16x16x32_bf16 v[100:103], a[100:103], a[12:15], v[100:103]
    v_exp_f32 v73, v73
    v_mfma_f32_16x16x32_bf16 v[104:107], a[100:103], a[16:19], v[104:107]
    v_exp_f32 v74, v74
    v_mfma_f32_16x16x32_bf16 v[108:111], a[100:103], a[20:23], v[108:111]
    s_waitcnt lgkmcnt(3)
    s_waitcnt lgkmcnt(0)
    s_barrier
    v_exp_f32 v75, v75
    v_mfma_f32_16x16x32_bf16 v[100:103], a[104:107], a[24:27], v[100:103]
    ds_read_b64_tr_b16 a[120:121], v12 offset:0
    v_add_f32 v37, v37, v64
    v_mfma_f32_16x16x32_bf16 v[104:107], a[104:107], a[28:31], v[104:107]
    v_cvt_pk_bf16_f32 v60, v72, v73
    v_cvt_pk_bf16_f32 v61, v74, v75
    v_mfma_f32_16x16x32_bf16 v[108:111], a[104:107], a[32:35], v[108:111]
    ds_read_b64_tr_b16 a[122:123], v12 offset:6144
    v_add_f32 v37, v37, v65
    v_mfma_f32_16x16x32_bf16 v[100:103], a[108:111], a[36:39], v[100:103]
    v_exp_f32 v84, v84
    v_mfma_f32_16x16x32_bf16 v[104:107], a[108:111], a[40:43], v[104:107]
    ds_read_b64_tr_b16 a[124:125], v13 offset:0
    v_add_f32 v37, v37, v66
    v_mfma_f32_16x16x32_bf16 v[108:111], a[108:111], a[44:47], v[108:111]
    v_exp_f32 v85, v85
    v_mfma_f32_16x16x32_bf16 v[100:103], a[112:115], a[48:51], v[100:103]
    ds_read_b64_tr_b16 a[126:127], v13 offset:6144
    v_add_f32 v37, v37, v67
    v_mfma_f32_16x16x32_bf16 v[104:107], a[112:115], a[52:55], v[104:107]
    v_exp_f32 v86, v86
    v_mfma_f32_16x16x32_bf16 v[108:111], a[112:115], a[56:59], v[108:111]
    ds_read_b64_tr_b16 a[128:129], v14 offset:0
    v_add_f32 v37, v37, v76
    v_mfma_f32_16x16x32_bf16 v[100:103], a[116:119], a[60:63], v[100:103]
    v_exp_f32 v87, v87
    v_mfma_f32_16x16x32_bf16 v[104:107], a[116:119], a[64:67], v[104:107]
    ds_read_b64_tr_b16 a[130:131], v14 offset:6144
    v_add_f32 v37, v37, v77
    v_mfma_f32_16x16x32_bf16 v[108:111], a[116:119], a[68:71], v[108:111]
    s_waitcnt lgkmcnt(4)
    v_cvt_pk_bf16_f32 v62, v84, v85
    v_cvt_pk_bf16_f32 v63, v86, v87
    v_mfma_f32_16x16x32_bf16 v[112:115], a[120:123], v[52:55], v[112:115]
    ds_read_b64_tr_b16 a[132:133], v15 offset:0
    v_add_f32 v38, v38, v68
    v_mfma_f32_16x16x32_bf16 v[116:119], a[120:123], v[56:59], v[116:119]
    ds_read_b64_tr_b16 a[134:135], v15 offset:6144
    v_add_f32 v39, v39, v72
    v_mfma_f32_16x16x32_bf16 v[120:123], a[120:123], v[60:63], v[120:123]
    s_waitcnt lgkmcnt(4)
    ds_read_b64_tr_b16 a[136:137], v12 offset:128
    v_add_f32 v38, v38, v69
    v_mfma_f32_16x16x32_bf16 v[132:135], a[124:127], v[60:63], v[132:135]
    buffer_load_dwordx4 v24, s[16:19], s39 offen offset:1024 nt lds
    v_mfma_f32_16x16x32_bf16 v[128:131], a[124:127], v[56:59], v[128:131]
    ds_read_b64_tr_b16 a[138:139], v12 offset:6272
    v_add_f32 v39, v39, v73
    v_mfma_f32_16x16x32_bf16 v[124:127], a[124:127], v[52:55], v[124:127]
    s_waitcnt lgkmcnt(4)
    ds_read_b64_tr_b16 a[140:141], v13 offset:128
    v_add_f32 v38, v38, v70
    v_mfma_f32_16x16x32_bf16 v[136:139], a[128:131], v[52:55], v[136:139]
    ds_read_b64_tr_b16 a[142:143], v13 offset:6272
    v_add_f32 v39, v39, v74
    v_mfma_f32_16x16x32_bf16 v[140:143], a[128:131], v[56:59], v[140:143]
    ds_read_b64_tr_b16 a[144:145], v14 offset:128
    v_add_f32 v38, v38, v71
    v_mfma_f32_16x16x32_bf16 v[144:147], a[128:131], v[60:63], v[144:147]
    s_waitcnt lgkmcnt(5)
    ds_read_b64_tr_b16 a[146:147], v14 offset:6272
    v_add_f32 v39, v39, v75
    v_mfma_f32_16x16x32_bf16 v[156:159], a[132:135], v[60:63], v[156:159]
    ds_read_b64_tr_b16 a[148:149], v15 offset:128
    v_add_f32 v38, v38, v80
    v_mfma_f32_16x16x32_bf16 v[152:155], a[132:135], v[56:59], v[152:155]
    ds_read_b64_tr_b16 a[150:151], v15 offset:6272
    v_add_f32 v39, v39, v84
    v_mfma_f32_16x16x32_bf16 v[148:151], a[132:135], v[52:55], v[148:151]
    s_waitcnt lgkmcnt(6)
    buffer_load_dwordx4 v25, s[16:19], s39 offen offset:2048 nt lds
    v_mfma_f32_16x16x32_bf16 v[160:163], a[136:139], v[52:55], v[160:163]
    ds_read_b64_tr_b16 a[152:153], v12 offset:256
    v_add_f32 v38, v38, v81
    v_mfma_f32_16x16x32_bf16 v[164:167], a[136:139], v[56:59], v[164:167]
    ds_read_b64_tr_b16 a[154:155], v12 offset:6400
    v_add_f32 v39, v39, v85
    v_mfma_f32_16x16x32_bf16 v[168:171], a[136:139], v[60:63], v[168:171]
    s_waitcnt lgkmcnt(6)
    ds_read_b64_tr_b16 a[156:157], v13 offset:256
    v_add_f32 v37, v37, v78
    v_mfma_f32_16x16x32_bf16 v[180:183], a[140:143], v[60:63], v[180:183]
    ds_read_b64_tr_b16 a[158:159], v13 offset:6400
    v_add_f32 v38, v38, v82
    v_mfma_f32_16x16x32_bf16 v[176:179], a[140:143], v[56:59], v[176:179]
    ds_read_b64_tr_b16 a[160:161], v14 offset:256
    v_add_f32 v39, v39, v86
    v_mfma_f32_16x16x32_bf16 v[172:175], a[140:143], v[52:55], v[172:175]
    s_waitcnt lgkmcnt(7)
    s_add_u32 s39, s34, 147456
    ds_read_b64_tr_b16 a[162:163], v14 offset:6400
    v_add_f32 v37, v37, v79
    v_mfma_f32_16x16x32_bf16 v[184:187], a[144:147], v[52:55], v[184:187]
    s_add_u32 m0, s34, 0
    ds_read_b64_tr_b16 a[164:165], v15 offset:256
    v_add_f32 v38, v38, v83
    v_mfma_f32_16x16x32_bf16 v[188:191], a[144:147], v[56:59], v[188:191]
    buffer_load_dwordx4 v20, s[12:15], s39 offen offset:0 nt lds
    v_mfma_f32_16x16x32_bf16 v[192:195], a[144:147], v[60:63], v[192:195]
    s_waitcnt lgkmcnt(7)
    ds_read_b64_tr_b16 a[166:167], v15 offset:6400
    v_add_f32 v39, v39, v87
    v_mfma_f32_16x16x32_bf16 v[204:207], a[148:151], v[60:63], v[204:207]
    s_add_u32 s30, s34, 49280
    v_lshl_add_u32 v29, v1, 4, s30
    v_mfma_f32_16x16x32_bf16 v[200:203], a[148:151], v[56:59], v[200:203]
    ds_write_b128 v29, a[180:183] offset:0
    v_mfma_f32_16x16x32_bf16 v[196:199], a[148:151], v[52:55], v[196:199]
    s_waitcnt lgkmcnt(7)
    s_waitcnt vmcnt(15)
    ds_write_b128 v29, a[184:187] offset:1024
    v_mfma_f32_16x16x32_bf16 v[208:211], a[152:155], v[52:55], v[208:211]
    s_waitcnt vmcnt(14)
    ds_write_b128 v29, a[188:191] offset:2048
    v_mfma_f32_16x16x32_bf16 v[212:215], a[152:155], v[56:59], v[212:215]
    ds_read_b128 a[72:75], v8 offset:24640
    v_mfma_f32_16x16x32_bf16 v[216:219], a[152:155], v[60:63], v[216:219]
    s_waitcnt lgkmcnt(8)
    s_mov_b32 s31, 23040
    ds_read_b128 a[76:79], v9 offset:24640
    v_mfma_f32_16x16x32_bf16 v[228:231], a[156:159], v[60:63], v[228:231]
    s_waitcnt vmcnt(4)
    buffer_load_dword a254, v31, s[60:63], s31 offen
    v_mfma_f32_16x16x32_bf16 v[224:227], a[156:159], v[56:59], v[224:227]
    ds_read_b128 a[80:83], v8 offset:24768
    v_mfma_f32_16x16x32_bf16 v[220:223], a[156:159], v[52:55], v[220:223]
    s_waitcnt lgkmcnt(8)
    ds_read_b128 a[84:87], v9 offset:24768
    v_mfma_f32_16x16x32_bf16 v[232:235], a[160:163], v[52:55], v[232:235]
    ds_read_b128 a[88:91], v8 offset:24896
    v_mfma_f32_16x16x32_bf16 v[236:239], a[160:163], v[56:59], v[236:239]
    ds_read_b128 a[92:95], v9 offset:24896
    v_mfma_f32_16x16x32_bf16 v[240:243], a[160:163], v[60:63], v[240:243]
    s_waitcnt lgkmcnt(9)
    ds_read_b128 a[96:99], v8 offset:30784
    v_mfma_f32_16x16x32_bf16 v[252:255], a[164:167], v[60:63], v[252:255]
    ds_read_b128 a[100:103], v9 offset:30784
    v_mfma_f32_16x16x32_bf16 v[248:251], a[164:167], v[56:59], v[248:251]
    ds_read_b128 a[104:107], v8 offset:30912
    v_mfma_f32_16x16x32_bf16 v[244:247], a[164:167], v[52:55], v[244:247]
    s_waitcnt lgkmcnt(8)
    ds_read_b128 a[108:111], v9 offset:30912
    ds_read_b128 a[112:115], v8 offset:31040
    ds_read_b128 a[116:119], v9 offset:31040
    v_mfma_f32_16x16x32_bf16 v[64:67], a[72:75], a[0:3], v[40:43]
    v_exp_f32 v88, v88
    v_mfma_f32_16x16x32_bf16 v[68:71], a[72:75], a[4:7], v[44:47]
    v_exp_f32 v89, v89
    v_mfma_f32_16x16x32_bf16 v[72:75], a[72:75], a[8:11], v[48:51]
    s_waitcnt lgkmcnt(10)
    v_exp_f32 v90, v90
    v_mfma_f32_16x16x32_bf16 v[64:67], a[76:79], a[12:15], v[64:67]
    v_exp_f32 v91, v91
    v_mfma_f32_16x16x32_bf16 v[68:71], a[76:79], a[16:19], v[68:71]
    v_cvt_pk_bf16_f32 v52, v88, v89
    v_cvt_pk_bf16_f32 v53, v90, v91
    v_mfma_f32_16x16x32_bf16 v[72:75], a[76:79], a[20:23], v[72:75]
    s_waitcnt lgkmcnt(9)
    v_exp_f32 v100, v100
    v_mfma_f32_16x16x32_bf16 v[64:67], a[80:83], a[24:27], v[64:67]
    v_exp_f32 v101, v101
    v_mfma_f32_16x16x32_bf16 v[68:71], a[80:83], a[28:31], v[68:71]
    v_exp_f32 v102, v102
    v_mfma_f32_16x16x32_bf16 v[72:75], a[80:83], a[32:35], v[72:75]
    s_waitcnt lgkmcnt(8)
    v_exp_f32 v103, v103
    v_mfma_f32_16x16x32_bf16 v[64:67], a[84:87], a[36:39], v[64:67]
    v_cvt_pk_bf16_f32 v54, v100, v101
    v_cvt_pk_bf16_f32 v55, v102, v103
    v_mfma_f32_16x16x32_bf16 v[68:71], a[84:87], a[40:43], v[68:71]
    v_exp_f32 v92, v92
    v_mfma_f32_16x16x32_bf16 v[72:75], a[84:87], a[44:47], v[72:75]
    s_waitcnt lgkmcnt(7)
    v_exp_f32 v93, v93
    v_mfma_f32_16x16x32_bf16 v[64:67], a[88:91], a[48:51], v[64:67]
    v_exp_f32 v94, v94
    v_mfma_f32_16x16x32_bf16 v[68:71], a[88:91], a[52:55], v[68:71]
    v_exp_f32 v95, v95
    v_mfma_f32_16x16x32_bf16 v[72:75], a[88:91], a[56:59], v[72:75]
    s_waitcnt lgkmcnt(6)
    v_cvt_pk_bf16_f32 v56, v92, v93
    v_cvt_pk_bf16_f32 v57, v94, v95
    v_mfma_f32_16x16x32_bf16 v[64:67], a[92:95], a[60:63], v[64:67]
    v_exp_f32 v104, v104
    v_mfma_f32_16x16x32_bf16 v[68:71], a[92:95], a[64:67], v[68:71]
    v_exp_f32 v105, v105
    v_mfma_f32_16x16x32_bf16 v[72:75], a[92:95], a[68:71], v[72:75]
    s_waitcnt lgkmcnt(5)
    v_exp_f32 v106, v106
    v_mfma_f32_16x16x32_bf16 v[76:79], a[96:99], a[0:3], v[40:43]
    v_exp_f32 v107, v107
    v_mfma_f32_16x16x32_bf16 v[80:83], a[96:99], a[4:7], v[44:47]
    v_cvt_pk_bf16_f32 v58, v104, v105
    v_cvt_pk_bf16_f32 v59, v106, v107
    v_mfma_f32_16x16x32_bf16 v[84:87], a[96:99], a[8:11], v[48:51]
    s_waitcnt lgkmcnt(4)
    v_exp_f32 v96, v96
    v_mfma_f32_16x16x32_bf16 v[76:79], a[100:103], a[12:15], v[76:79]
    v_exp_f32 v97, v97
    v_mfma_f32_16x16x32_bf16 v[80:83], a[100:103], a[16:19], v[80:83]
    v_exp_f32 v98, v98
    v_mfma_f32_16x16x32_bf16 v[84:87], a[100:103], a[20:23], v[84:87]
    s_waitcnt lgkmcnt(3)
    s_waitcnt lgkmcnt(0)
    s_barrier
    v_exp_f32 v99, v99
    v_mfma_f32_16x16x32_bf16 v[76:79], a[104:107], a[24:27], v[76:79]
    ds_read_b64_tr_b16 a[120:121], v12 offset:12320
    v_add_f32 v37, v37, v88
    v_mfma_f32_16x16x32_bf16 v[80:83], a[104:107], a[28:31], v[80:83]
    v_cvt_pk_bf16_f32 v60, v96, v97
    v_cvt_pk_bf16_f32 v61, v98, v99
    v_mfma_f32_16x16x32_bf16 v[84:87], a[104:107], a[32:35], v[84:87]
    ds_read_b64_tr_b16 a[122:123], v12 offset:18464
    v_add_f32 v37, v37, v89
    v_mfma_f32_16x16x32_bf16 v[76:79], a[108:111], a[36:39], v[76:79]
    v_exp_f32 v108, v108
    v_mfma_f32_16x16x32_bf16 v[80:83], a[108:111], a[40:43], v[80:83]
    ds_read_b64_tr_b16 a[124:125], v13 offset:12320
    v_add_f32 v37, v37, v90
    v_mfma_f32_16x16x32_bf16 v[84:87], a[108:111], a[44:47], v[84:87]
    v_exp_f32 v109, v109
    v_mfma_f32_16x16x32_bf16 v[76:79], a[112:115], a[48:51], v[76:79]
    ds_read_b64_tr_b16 a[126:127], v13 offset:18464
    v_add_f32 v37, v37, v91
    v_mfma_f32_16x16x32_bf16 v[80:83], a[112:115], a[52:55], v[80:83]
    v_exp_f32 v110, v110
    v_mfma_f32_16x16x32_bf16 v[84:87], a[112:115], a[56:59], v[84:87]
    ds_read_b64_tr_b16 a[128:129], v14 offset:12320
    v_add_f32 v37, v37, v100
    v_mfma_f32_16x16x32_bf16 v[76:79], a[116:119], a[60:63], v[76:79]
    v_exp_f32 v111, v111
    v_mfma_f32_16x16x32_bf16 v[80:83], a[116:119], a[64:67], v[80:83]
    ds_read_b64_tr_b16 a[130:131], v14 offset:18464
    v_add_f32 v37, v37, v101
    v_mfma_f32_16x16x32_bf16 v[84:87], a[116:119], a[68:71], v[84:87]
    s_waitcnt lgkmcnt(4)
    v_cvt_pk_bf16_f32 v62, v108, v109
    v_cvt_pk_bf16_f32 v63, v110, v111
    v_mfma_f32_16x16x32_bf16 v[112:115], a[120:123], v[52:55], v[112:115]
    ds_read_b64_tr_b16 a[132:133], v15 offset:12320
    v_add_f32 v38, v38, v92
    v_mfma_f32_16x16x32_bf16 v[116:119], a[120:123], v[56:59], v[116:119]
    ds_read_b64_tr_b16 a[134:135], v15 offset:18464
    v_add_f32 v39, v39, v96
    v_mfma_f32_16x16x32_bf16 v[120:123], a[120:123], v[60:63], v[120:123]
    s_waitcnt lgkmcnt(4)
    ds_read_b64_tr_b16 a[136:137], v12 offset:12448
    v_add_f32 v38, v38, v93
    v_mfma_f32_16x16x32_bf16 v[132:135], a[124:127], v[60:63], v[132:135]
    buffer_load_dwordx4 v21, s[12:15], s39 offen offset:1024 nt lds
    v_mfma_f32_16x16x32_bf16 v[128:131], a[124:127], v[56:59], v[128:131]
    ds_read_b64_tr_b16 a[138:139], v12 offset:18592
    v_add_f32 v39, v39, v97
    v_mfma_f32_16x16x32_bf16 v[124:127], a[124:127], v[52:55], v[124:127]
    s_waitcnt lgkmcnt(4)
    ds_read_b64_tr_b16 a[140:141], v13 offset:12448
    v_add_f32 v38, v38, v94
    v_mfma_f32_16x16x32_bf16 v[136:139], a[128:131], v[52:55], v[136:139]
    ds_read_b64_tr_b16 a[142:143], v13 offset:18592
    v_add_f32 v39, v39, v98
    v_mfma_f32_16x16x32_bf16 v[140:143], a[128:131], v[56:59], v[140:143]
    ds_read_b64_tr_b16 a[144:145], v14 offset:12448
    v_add_f32 v38, v38, v95
    v_mfma_f32_16x16x32_bf16 v[144:147], a[128:131], v[60:63], v[144:147]
    s_waitcnt lgkmcnt(5)
    ds_read_b64_tr_b16 a[146:147], v14 offset:18592
    v_add_f32 v39, v39, v99
    v_mfma_f32_16x16x32_bf16 v[156:159], a[132:135], v[60:63], v[156:159]
    ds_read_b64_tr_b16 a[148:149], v15 offset:12448
    v_add_f32 v38, v38, v104
    v_mfma_f32_16x16x32_bf16 v[152:155], a[132:135], v[56:59], v[152:155]
    ds_read_b64_tr_b16 a[150:151], v15 offset:18592
    v_add_f32 v39, v39, v108
    v_mfma_f32_16x16x32_bf16 v[148:151], a[132:135], v[52:55], v[148:151]
    s_waitcnt lgkmcnt(6)
    buffer_load_dwordx4 v22, s[12:15], s39 offen offset:2048 nt lds
    v_mfma_f32_16x16x32_bf16 v[160:163], a[136:139], v[52:55], v[160:163]
    ds_read_b64_tr_b16 a[152:153], v12 offset:12576
    v_add_f32 v38, v38, v105
    v_mfma_f32_16x16x32_bf16 v[164:167], a[136:139], v[56:59], v[164:167]
    ds_read_b64_tr_b16 a[154:155], v12 offset:18720
    v_add_f32 v39, v39, v109
    v_mfma_f32_16x16x32_bf16 v[168:171], a[136:139], v[60:63], v[168:171]
    s_waitcnt lgkmcnt(6)
    ds_read_b64_tr_b16 a[156:157], v13 offset:12576
    v_add_f32 v37, v37, v102
    v_mfma_f32_16x16x32_bf16 v[180:183], a[140:143], v[60:63], v[180:183]
    ds_read_b64_tr_b16 a[158:159], v13 offset:18720
    v_add_f32 v38, v38, v106
    v_mfma_f32_16x16x32_bf16 v[176:179], a[140:143], v[56:59], v[176:179]
    ds_read_b64_tr_b16 a[160:161], v14 offset:12576
    v_add_f32 v39, v39, v110
    v_mfma_f32_16x16x32_bf16 v[172:175], a[140:143], v[52:55], v[172:175]
    s_waitcnt lgkmcnt(7)
    s_add_u32 s39, s34, 135168
    ds_read_b64_tr_b16 a[162:163], v14 offset:18720
    v_add_f32 v37, v37, v103
    v_mfma_f32_16x16x32_bf16 v[184:187], a[144:147], v[52:55], v[184:187]
    s_add_u32 m0, s34, 110880
    ds_read_b64_tr_b16 a[164:165], v15 offset:12576
    v_add_f32 v38, v38, v107
    v_mfma_f32_16x16x32_bf16 v[188:191], a[144:147], v[56:59], v[188:191]
    buffer_load_dwordx4 v23, s[16:19], s39 offen offset:0 nt lds
    v_mfma_f32_16x16x32_bf16 v[192:195], a[144:147], v[60:63], v[192:195]
    s_waitcnt lgkmcnt(7)
    ds_read_b64_tr_b16 a[166:167], v15 offset:18720
    v_add_f32 v39, v39, v111
    v_mfma_f32_16x16x32_bf16 v[204:207], a[148:151], v[60:63], v[204:207]
    s_add_u32 s30, s34, 86240
    v_lshl_add_u32 v29, v1, 4, s30
    v_mfma_f32_16x16x32_bf16 v[200:203], a[148:151], v[56:59], v[200:203]
    ds_write_b128 v29, a[192:195] offset:0
    v_mfma_f32_16x16x32_bf16 v[196:199], a[148:151], v[52:55], v[196:199]
    s_waitcnt lgkmcnt(7)
    ds_write_b128 v29, a[196:199] offset:1024
    v_mfma_f32_16x16x32_bf16 v[208:211], a[152:155], v[52:55], v[208:211]
    ds_write_b128 v29, a[200:203] offset:2048
    v_mfma_f32_16x16x32_bf16 v[212:215], a[152:155], v[56:59], v[212:215]
    ds_read_b128 a[72:75], v10 offset:0
    v_mfma_f32_16x16x32_bf16 v[216:219], a[152:155], v[60:63], v[216:219]
    s_waitcnt lgkmcnt(8)
    s_mov_b32 s31, 26880
    ds_read_b128 a[76:79], v11 offset:0
    v_mfma_f32_16x16x32_bf16 v[228:231], a[156:159], v[60:63], v[228:231]
    buffer_load_dword a255, v31, s[60:63], s31 offen
    v_mfma_f32_16x16x32_bf16 v[224:227], a[156:159], v[56:59], v[224:227]
    ds_read_b128 a[80:83], v10 offset:128
    v_mfma_f32_16x16x32_bf16 v[220:223], a[156:159], v[52:55], v[220:223]
    s_waitcnt lgkmcnt(8)
    ds_read_b128 a[84:87], v11 offset:128
    v_mfma_f32_16x16x32_bf16 v[232:235], a[160:163], v[52:55], v[232:235]
    ds_read_b128 a[88:91], v10 offset:256
    v_mfma_f32_16x16x32_bf16 v[236:239], a[160:163], v[56:59], v[236:239]
    ds_read_b128 a[92:95], v11 offset:256
    v_mfma_f32_16x16x32_bf16 v[240:243], a[160:163], v[60:63], v[240:243]
    s_waitcnt lgkmcnt(9)
    ds_read_b128 a[96:99], v10 offset:6144
    v_mfma_f32_16x16x32_bf16 v[252:255], a[164:167], v[60:63], v[252:255]
    ds_read_b128 a[100:103], v11 offset:6144
    v_mfma_f32_16x16x32_bf16 v[248:251], a[164:167], v[56:59], v[248:251]
    ds_read_b128 a[104:107], v10 offset:6272
    v_mfma_f32_16x16x32_bf16 v[244:247], a[164:167], v[52:55], v[244:247]
    s_waitcnt lgkmcnt(8)
    ds_read_b128 a[108:111], v11 offset:6272
    ds_read_b128 a[112:115], v10 offset:6400
    ds_read_b128 a[116:119], v11 offset:6400
    v_mfma_f32_16x16x32_bf16 v[88:91], a[72:75], a[0:3], v[40:43]
    v_exp_f32 v64, v64
    v_mfma_f32_16x16x32_bf16 v[92:95], a[72:75], a[4:7], v[44:47]
    v_exp_f32 v65, v65
    v_mfma_f32_16x16x32_bf16 v[96:99], a[72:75], a[8:11], v[48:51]
    s_waitcnt lgkmcnt(10)
    v_exp_f32 v66, v66
    v_mfma_f32_16x16x32_bf16 v[88:91], a[76:79], a[12:15], v[88:91]
    v_exp_f32 v67, v67
    v_mfma_f32_16x16x32_bf16 v[92:95], a[76:79], a[16:19], v[92:95]
    v_cvt_pk_bf16_f32 v52, v64, v65
    v_cvt_pk_bf16_f32 v53, v66, v67
    v_mfma_f32_16x16x32_bf16 v[96:99], a[76:79], a[20:23], v[96:99]
    s_waitcnt lgkmcnt(9)
    v_exp_f32 v76, v76
    v_mfma_f32_16x16x32_bf16 v[88:91], a[80:83], a[24:27], v[88:91]
    v_exp_f32 v77, v77
    v_mfma_f32_16x16x32_bf16 v[92:95], a[80:83], a[28:31], v[92:95]
    v_exp_f32 v78, v78
    v_mfma_f32_16x16x32_bf16 v[96:99], a[80:83], a[32:35], v[96:99]
    s_waitcnt lgkmcnt(8)
    v_exp_f32 v79, v79
    v_mfma_f32_16x16x32_bf16 v[88:91], a[84:87], a[36:39], v[88:91]
    v_cvt_pk_bf16_f32 v54, v76, v77
    v_cvt_pk_bf16_f32 v55, v78, v79
    v_mfma_f32_16x16x32_bf16 v[92:95], a[84:87], a[40:43], v[92:95]
    v_exp_f32 v68, v68
    v_mfma_f32_16x16x32_bf16 v[96:99], a[84:87], a[44:47], v[96:99]
    s_waitcnt lgkmcnt(7)
    v_exp_f32 v69, v69
    v_mfma_f32_16x16x32_bf16 v[88:91], a[88:91], a[48:51], v[88:91]
    v_exp_f32 v70, v70
    v_mfma_f32_16x16x32_bf16 v[92:95], a[88:91], a[52:55], v[92:95]
    v_exp_f32 v71, v71
    v_mfma_f32_16x16x32_bf16 v[96:99], a[88:91], a[56:59], v[96:99]
    s_waitcnt lgkmcnt(6)
    v_cvt_pk_bf16_f32 v56, v68, v69
    v_cvt_pk_bf16_f32 v57, v70, v71
    v_mfma_f32_16x16x32_bf16 v[88:91], a[92:95], a[60:63], v[88:91]
    v_exp_f32 v80, v80
    v_mfma_f32_16x16x32_bf16 v[92:95], a[92:95], a[64:67], v[92:95]
    v_exp_f32 v81, v81
    v_mfma_f32_16x16x32_bf16 v[96:99], a[92:95], a[68:71], v[96:99]
    s_waitcnt lgkmcnt(5)
    v_exp_f32 v82, v82
    v_mfma_f32_16x16x32_bf16 v[100:103], a[96:99], a[0:3], v[40:43]
    v_exp_f32 v83, v83
    v_mfma_f32_16x16x32_bf16 v[104:107], a[96:99], a[4:7], v[44:47]
    v_cvt_pk_bf16_f32 v58, v80, v81
    v_cvt_pk_bf16_f32 v59, v82, v83
    v_mfma_f32_16x16x32_bf16 v[108:111], a[96:99], a[8:11], v[48:51]
    s_waitcnt lgkmcnt(4)
    v_exp_f32 v72, v72
    v_mfma_f32_16x16x32_bf16 v[100:103], a[100:103], a[12:15], v[100:103]
    v_exp_f32 v73, v73
    v_mfma_f32_16x16x32_bf16 v[104:107], a[100:103], a[16:19], v[104:107]
    v_exp_f32 v74, v74
    v_mfma_f32_16x16x32_bf16 v[108:111], a[100:103], a[20:23], v[108:111]
    s_waitcnt lgkmcnt(3)
    s_waitcnt lgkmcnt(0)
    s_barrier
    v_exp_f32 v75, v75
    v_mfma_f32_16x16x32_bf16 v[100:103], a[104:107], a[24:27], v[100:103]
    ds_read_b64_tr_b16 a[120:121], v12 offset:24640
    v_add_f32 v37, v37, v64
    v_mfma_f32_16x16x32_bf16 v[104:107], a[104:107], a[28:31], v[104:107]
    v_cvt_pk_bf16_f32 v60, v72, v73
    v_cvt_pk_bf16_f32 v61, v74, v75
    v_mfma_f32_16x16x32_bf16 v[108:111], a[104:107], a[32:35], v[108:111]
    ds_read_b64_tr_b16 a[122:123], v12 offset:30784
    v_add_f32 v37, v37, v65
    v_mfma_f32_16x16x32_bf16 v[100:103], a[108:111], a[36:39], v[100:103]
    v_exp_f32 v84, v84
    v_mfma_f32_16x16x32_bf16 v[104:107], a[108:111], a[40:43], v[104:107]
    ds_read_b64_tr_b16 a[124:125], v13 offset:24640
    v_add_f32 v37, v37, v66
    v_mfma_f32_16x16x32_bf16 v[108:111], a[108:111], a[44:47], v[108:111]
    v_exp_f32 v85, v85
    v_mfma_f32_16x16x32_bf16 v[100:103], a[112:115], a[48:51], v[100:103]
    ds_read_b64_tr_b16 a[126:127], v13 offset:30784
    v_add_f32 v37, v37, v67
    v_mfma_f32_16x16x32_bf16 v[104:107], a[112:115], a[52:55], v[104:107]
    v_exp_f32 v86, v86
    v_mfma_f32_16x16x32_bf16 v[108:111], a[112:115], a[56:59], v[108:111]
    ds_read_b64_tr_b16 a[128:129], v14 offset:24640
    v_add_f32 v37, v37, v76
    v_mfma_f32_16x16x32_bf16 v[100:103], a[116:119], a[60:63], v[100:103]
    v_exp_f32 v87, v87
    v_mfma_f32_16x16x32_bf16 v[104:107], a[116:119], a[64:67], v[104:107]
    ds_read_b64_tr_b16 a[130:131], v14 offset:30784
    v_add_f32 v37, v37, v77
    v_mfma_f32_16x16x32_bf16 v[108:111], a[116:119], a[68:71], v[108:111]
    s_waitcnt lgkmcnt(4)
    v_cvt_pk_bf16_f32 v62, v84, v85
    v_cvt_pk_bf16_f32 v63, v86, v87
    v_mfma_f32_16x16x32_bf16 v[112:115], a[120:123], v[52:55], v[112:115]
    ds_read_b64_tr_b16 a[132:133], v15 offset:24640
    v_add_f32 v38, v38, v68
    v_mfma_f32_16x16x32_bf16 v[116:119], a[120:123], v[56:59], v[116:119]
    ds_read_b64_tr_b16 a[134:135], v15 offset:30784
    v_add_f32 v39, v39, v72
    v_mfma_f32_16x16x32_bf16 v[120:123], a[120:123], v[60:63], v[120:123]
    s_waitcnt lgkmcnt(4)
    ds_read_b64_tr_b16 a[136:137], v12 offset:24768
    v_add_f32 v38, v38, v69
    v_mfma_f32_16x16x32_bf16 v[132:135], a[124:127], v[60:63], v[132:135]
    buffer_load_dwordx4 v24, s[16:19], s39 offen offset:1024 nt lds
    v_mfma_f32_16x16x32_bf16 v[128:131], a[124:127], v[56:59], v[128:131]
    ds_read_b64_tr_b16 a[138:139], v12 offset:30912
    v_add_f32 v39, v39, v73
    v_mfma_f32_16x16x32_bf16 v[124:127], a[124:127], v[52:55], v[124:127]
    s_waitcnt lgkmcnt(4)
    ds_read_b64_tr_b16 a[140:141], v13 offset:24768
    v_add_f32 v38, v38, v70
    v_mfma_f32_16x16x32_bf16 v[136:139], a[128:131], v[52:55], v[136:139]
    ds_read_b64_tr_b16 a[142:143], v13 offset:30912
    v_add_f32 v39, v39, v74
    v_mfma_f32_16x16x32_bf16 v[140:143], a[128:131], v[56:59], v[140:143]
    ds_read_b64_tr_b16 a[144:145], v14 offset:24768
    v_add_f32 v38, v38, v71
    v_mfma_f32_16x16x32_bf16 v[144:147], a[128:131], v[60:63], v[144:147]
    s_waitcnt lgkmcnt(5)
    ds_read_b64_tr_b16 a[146:147], v14 offset:30912
    v_add_f32 v39, v39, v75
    v_mfma_f32_16x16x32_bf16 v[156:159], a[132:135], v[60:63], v[156:159]
    buffer_load_dwordx4 v25, s[16:19], s39 offen offset:2048 nt lds
    v_mfma_f32_16x16x32_bf16 v[152:155], a[132:135], v[56:59], v[152:155]
    ds_read_b64_tr_b16 a[148:149], v15 offset:24768
    v_add_f32 v38, v38, v80
    v_mfma_f32_16x16x32_bf16 v[148:151], a[132:135], v[52:55], v[148:151]
    s_waitcnt lgkmcnt(5)
    ds_read_b64_tr_b16 a[150:151], v15 offset:30912
    v_add_f32 v39, v39, v84
    v_mfma_f32_16x16x32_bf16 v[160:163], a[136:139], v[52:55], v[160:163]
    ds_read_b64_tr_b16 a[152:153], v12 offset:24896
    v_add_f32 v38, v38, v81
    v_mfma_f32_16x16x32_bf16 v[164:167], a[136:139], v[56:59], v[164:167]
    ds_read_b64_tr_b16 a[154:155], v12 offset:31040
    v_add_f32 v39, v39, v85
    v_mfma_f32_16x16x32_bf16 v[168:171], a[136:139], v[60:63], v[168:171]
    s_waitcnt lgkmcnt(6)
    s_add_u32 s39, s34, 159744
    ds_read_b64_tr_b16 a[156:157], v13 offset:24896
    v_add_f32 v37, v37, v78
    v_mfma_f32_16x16x32_bf16 v[180:183], a[140:143], v[60:63], v[180:183]
    s_add_u32 m0, s34, 12320
    ds_read_b64_tr_b16 a[158:159], v13 offset:31040
    v_add_f32 v38, v38, v82
    v_mfma_f32_16x16x32_bf16 v[176:179], a[140:143], v[56:59], v[176:179]
    buffer_load_dwordx4 v20, s[12:15], s39 offen offset:0 nt lds
    v_mfma_f32_16x16x32_bf16 v[172:175], a[140:143], v[52:55], v[172:175]
    s_waitcnt lgkmcnt(6)
    ds_read_b64_tr_b16 a[160:161], v14 offset:24896
    v_add_f32 v39, v39, v86
    v_mfma_f32_16x16x32_bf16 v[184:187], a[144:147], v[52:55], v[184:187]
    ds_read_b64_tr_b16 a[162:163], v14 offset:31040
    v_add_f32 v37, v37, v79
    v_mfma_f32_16x16x32_bf16 v[188:191], a[144:147], v[56:59], v[188:191]
    ds_read_b64_tr_b16 a[164:165], v15 offset:24896
    v_add_f32 v38, v38, v83
    v_mfma_f32_16x16x32_bf16 v[192:195], a[144:147], v[60:63], v[192:195]
    s_waitcnt lgkmcnt(7)
    ds_read_b64_tr_b16 a[166:167], v15 offset:31040
    v_add_f32 v39, v39, v87
    v_mfma_f32_16x16x32_bf16 v[204:207], a[148:151], v[60:63], v[204:207]
    ds_read_b128 a[72:75], v10 offset:12320
    v_mfma_f32_16x16x32_bf16 v[200:203], a[148:151], v[56:59], v[200:203]
    buffer_load_dwordx4 v21, s[12:15], s39 offen offset:1024 nt lds
    v_mfma_f32_16x16x32_bf16 v[196:199], a[148:151], v[52:55], v[196:199]
    s_waitcnt lgkmcnt(7)
    ds_read_b128 a[76:79], v11 offset:12320
    v_mfma_f32_16x16x32_bf16 v[208:211], a[152:155], v[52:55], v[208:211]
    ds_read_b128 a[80:83], v10 offset:12448
    v_mfma_f32_16x16x32_bf16 v[212:215], a[152:155], v[56:59], v[212:215]
    ds_read_b128 a[84:87], v11 offset:12448
    v_mfma_f32_16x16x32_bf16 v[216:219], a[152:155], v[60:63], v[216:219]
    s_waitcnt lgkmcnt(8)
    ds_read_b128 a[88:91], v10 offset:12576
    v_mfma_f32_16x16x32_bf16 v[228:231], a[156:159], v[60:63], v[228:231]
    ds_read_b128 a[92:95], v11 offset:12576
    v_mfma_f32_16x16x32_bf16 v[224:227], a[156:159], v[56:59], v[224:227]
    ds_read_b128 a[96:99], v10 offset:18464
    v_mfma_f32_16x16x32_bf16 v[220:223], a[156:159], v[52:55], v[220:223]
    s_waitcnt lgkmcnt(9)
    buffer_load_dwordx4 v22, s[12:15], s39 offen offset:2048 nt lds
    v_mfma_f32_16x16x32_bf16 v[232:235], a[160:163], v[52:55], v[232:235]
    ds_read_b128 a[100:103], v11 offset:18464
    v_mfma_f32_16x16x32_bf16 v[236:239], a[160:163], v[56:59], v[236:239]
    ds_read_b128 a[104:107], v10 offset:18592
    v_mfma_f32_16x16x32_bf16 v[240:243], a[160:163], v[60:63], v[240:243]
    s_waitcnt lgkmcnt(9)
    ds_read_b128 a[108:111], v11 offset:18592
    v_mfma_f32_16x16x32_bf16 v[252:255], a[164:167], v[60:63], v[252:255]
    ds_read_b128 a[112:115], v10 offset:18720
    v_mfma_f32_16x16x32_bf16 v[248:251], a[164:167], v[56:59], v[248:251]
    ds_read_b128 a[116:119], v11 offset:18720
    v_mfma_f32_16x16x32_bf16 v[244:247], a[164:167], v[52:55], v[244:247]
    s_waitcnt lgkmcnt(11)
    v_mfma_f32_16x16x32_bf16 v[64:67], a[72:75], a[0:3], v[40:43]
    v_exp_f32 v88, v88
    v_mfma_f32_16x16x32_bf16 v[68:71], a[72:75], a[4:7], v[44:47]
    v_exp_f32 v89, v89
    v_mfma_f32_16x16x32_bf16 v[72:75], a[72:75], a[8:11], v[48:51]
    s_waitcnt lgkmcnt(10)
    v_exp_f32 v90, v90
    v_mfma_f32_16x16x32_bf16 v[64:67], a[76:79], a[12:15], v[64:67]
    v_exp_f32 v91, v91
    v_mfma_f32_16x16x32_bf16 v[68:71], a[76:79], a[16:19], v[68:71]
    v_cvt_pk_bf16_f32 v52, v88, v89
    v_cvt_pk_bf16_f32 v53, v90, v91
    v_mfma_f32_16x16x32_bf16 v[72:75], a[76:79], a[20:23], v[72:75]
    s_waitcnt lgkmcnt(9)
    v_exp_f32 v100, v100
    v_mfma_f32_16x16x32_bf16 v[64:67], a[80:83], a[24:27], v[64:67]
    v_exp_f32 v101, v101
    v_mfma_f32_16x16x32_bf16 v[68:71], a[80:83], a[28:31], v[68:71]
    v_exp_f32 v102, v102
    v_mfma_f32_16x16x32_bf16 v[72:75], a[80:83], a[32:35], v[72:75]
    s_waitcnt lgkmcnt(8)
    v_exp_f32 v103, v103
    v_mfma_f32_16x16x32_bf16 v[64:67], a[84:87], a[36:39], v[64:67]
    v_cvt_pk_bf16_f32 v54, v100, v101
    v_cvt_pk_bf16_f32 v55, v102, v103
    v_mfma_f32_16x16x32_bf16 v[68:71], a[84:87], a[40:43], v[68:71]
    v_exp_f32 v92, v92
    v_mfma_f32_16x16x32_bf16 v[72:75], a[84:87], a[44:47], v[72:75]
    s_waitcnt lgkmcnt(7)
    v_exp_f32 v93, v93
    v_mfma_f32_16x16x32_bf16 v[64:67], a[88:91], a[48:51], v[64:67]
    v_exp_f32 v94, v94
    v_mfma_f32_16x16x32_bf16 v[68:71], a[88:91], a[52:55], v[68:71]
    v_exp_f32 v95, v95
    v_mfma_f32_16x16x32_bf16 v[72:75], a[88:91], a[56:59], v[72:75]
    s_waitcnt lgkmcnt(6)
    v_cvt_pk_bf16_f32 v56, v92, v93
    v_cvt_pk_bf16_f32 v57, v94, v95
    v_mfma_f32_16x16x32_bf16 v[64:67], a[92:95], a[60:63], v[64:67]
    v_exp_f32 v104, v104
    v_mfma_f32_16x16x32_bf16 v[68:71], a[92:95], a[64:67], v[68:71]
    v_exp_f32 v105, v105
    v_mfma_f32_16x16x32_bf16 v[72:75], a[92:95], a[68:71], v[72:75]
    s_waitcnt lgkmcnt(5)
    v_exp_f32 v106, v106
    v_mfma_f32_16x16x32_bf16 v[76:79], a[96:99], a[0:3], v[40:43]
    v_exp_f32 v107, v107
    v_mfma_f32_16x16x32_bf16 v[80:83], a[96:99], a[4:7], v[44:47]
    v_cvt_pk_bf16_f32 v58, v104, v105
    v_cvt_pk_bf16_f32 v59, v106, v107
    v_mfma_f32_16x16x32_bf16 v[84:87], a[96:99], a[8:11], v[48:51]
    s_waitcnt lgkmcnt(4)
    v_exp_f32 v96, v96
    v_mfma_f32_16x16x32_bf16 v[76:79], a[100:103], a[12:15], v[76:79]
    v_exp_f32 v97, v97
    v_mfma_f32_16x16x32_bf16 v[80:83], a[100:103], a[16:19], v[80:83]
    v_exp_f32 v98, v98
    v_mfma_f32_16x16x32_bf16 v[84:87], a[100:103], a[20:23], v[84:87]
    s_waitcnt lgkmcnt(3)
    s_waitcnt lgkmcnt(0)
    s_barrier
    v_exp_f32 v99, v99
    v_mfma_f32_16x16x32_bf16 v[76:79], a[104:107], a[24:27], v[76:79]
    ds_read_b64_tr_b16 a[120:121], v16 offset:0
    v_add_f32 v37, v37, v88
    v_mfma_f32_16x16x32_bf16 v[80:83], a[104:107], a[28:31], v[80:83]
    v_cvt_pk_bf16_f32 v60, v96, v97
    v_cvt_pk_bf16_f32 v61, v98, v99
    v_mfma_f32_16x16x32_bf16 v[84:87], a[104:107], a[32:35], v[84:87]
    ds_read_b64_tr_b16 a[122:123], v16 offset:6144
    v_add_f32 v37, v37, v89
    v_mfma_f32_16x16x32_bf16 v[76:79], a[108:111], a[36:39], v[76:79]
    v_exp_f32 v108, v108
    v_mfma_f32_16x16x32_bf16 v[80:83], a[108:111], a[40:43], v[80:83]
    ds_read_b64_tr_b16 a[124:125], v17 offset:0
    v_add_f32 v37, v37, v90
    v_mfma_f32_16x16x32_bf16 v[84:87], a[108:111], a[44:47], v[84:87]
    v_exp_f32 v109, v109
    v_mfma_f32_16x16x32_bf16 v[76:79], a[112:115], a[48:51], v[76:79]
    ds_read_b64_tr_b16 a[126:127], v17 offset:6144
    v_add_f32 v37, v37, v91
    v_mfma_f32_16x16x32_bf16 v[80:83], a[112:115], a[52:55], v[80:83]
    v_exp_f32 v110, v110
    v_mfma_f32_16x16x32_bf16 v[84:87], a[112:115], a[56:59], v[84:87]
    ds_read_b64_tr_b16 a[128:129], v18 offset:0
    v_add_f32 v37, v37, v100
    v_mfma_f32_16x16x32_bf16 v[76:79], a[116:119], a[60:63], v[76:79]
    v_exp_f32 v111, v111
    v_mfma_f32_16x16x32_bf16 v[80:83], a[116:119], a[64:67], v[80:83]
    ds_read_b64_tr_b16 a[130:131], v18 offset:6144
    v_add_f32 v37, v37, v101
    v_mfma_f32_16x16x32_bf16 v[84:87], a[116:119], a[68:71], v[84:87]
    s_waitcnt lgkmcnt(4)
    v_cvt_pk_bf16_f32 v62, v108, v109
    v_cvt_pk_bf16_f32 v63, v110, v111
    v_mfma_f32_16x16x32_bf16 v[112:115], a[120:123], v[52:55], v[112:115]
    ds_read_b64_tr_b16 a[132:133], v19 offset:0
    v_add_f32 v38, v38, v92
    v_mfma_f32_16x16x32_bf16 v[116:119], a[120:123], v[56:59], v[116:119]
    s_add_u32 s39, s34, 147456
    ds_read_b64_tr_b16 a[134:135], v19 offset:6144
    v_add_f32 v39, v39, v96
    v_mfma_f32_16x16x32_bf16 v[120:123], a[120:123], v[60:63], v[120:123]
    s_waitcnt lgkmcnt(4)
    s_add_u32 m0, s34, 123200
    ds_read_b64_tr_b16 a[136:137], v16 offset:128
    v_add_f32 v38, v38, v93
    v_mfma_f32_16x16x32_bf16 v[132:135], a[124:127], v[60:63], v[132:135]
    buffer_load_dwordx4 v23, s[16:19], s39 offen offset:0 nt lds
    v_mfma_f32_16x16x32_bf16 v[128:131], a[124:127], v[56:59], v[128:131]
    ds_read_b64_tr_b16 a[138:139], v16 offset:6272
    v_add_f32 v39, v39, v97
    v_mfma_f32_16x16x32_bf16 v[124:127], a[124:127], v[52:55], v[124:127]
    s_waitcnt lgkmcnt(4)
    ds_read_b64_tr_b16 a[140:141], v17 offset:128
    v_add_f32 v38, v38, v94
    v_mfma_f32_16x16x32_bf16 v[136:139], a[128:131], v[52:55], v[136:139]
    buffer_load_dwordx4 v24, s[16:19], s39 offen offset:1024 nt lds
    v_mfma_f32_16x16x32_bf16 v[140:143], a[128:131], v[56:59], v[140:143]
    ds_read_b64_tr_b16 a[142:143], v17 offset:6272
    v_add_f32 v39, v39, v98
    v_mfma_f32_16x16x32_bf16 v[144:147], a[128:131], v[60:63], v[144:147]
    s_waitcnt lgkmcnt(4)
    ds_read_b64_tr_b16 a[144:145], v18 offset:128
    v_add_f32 v38, v38, v95
    v_mfma_f32_16x16x32_bf16 v[156:159], a[132:135], v[60:63], v[156:159]
    buffer_load_dwordx4 v25, s[16:19], s39 offen offset:2048 nt lds
    v_mfma_f32_16x16x32_bf16 v[152:155], a[132:135], v[56:59], v[152:155]
    s_add_u32 s39, s34, 172032
    ds_read_b64_tr_b16 a[146:147], v18 offset:6272
    v_add_f32 v39, v39, v99
    v_mfma_f32_16x16x32_bf16 v[148:151], a[132:135], v[52:55], v[148:151]
    s_waitcnt lgkmcnt(4)
    s_add_u32 m0, s34, 24640
    ds_read_b64_tr_b16 a[148:149], v19 offset:128
    v_add_f32 v38, v38, v104
    v_mfma_f32_16x16x32_bf16 v[160:163], a[136:139], v[52:55], v[160:163]
    buffer_load_dwordx4 v20, s[12:15], s39 offen offset:0 nt lds
    v_mfma_f32_16x16x32_bf16 v[164:167], a[136:139], v[56:59], v[164:167]
    ds_read_b64_tr_b16 a[150:151], v19 offset:6272
    v_add_f32 v39, v39, v108
    v_mfma_f32_16x16x32_bf16 v[168:171], a[136:139], v[60:63], v[168:171]
    s_waitcnt lgkmcnt(4)
    s_add_u32 s39, s84, 0
    ds_read_b64_tr_b16 a[152:153], v16 offset:256
    v_add_f32 v38, v38, v105
    v_mfma_f32_16x16x32_bf16 v[180:183], a[140:143], v[60:63], v[180:183]
    s_add_u32 m0, s34, 73920
    ds_read_b64_tr_b16 a[154:155], v16 offset:6400
    v_add_f32 v39, v39, v109
    v_mfma_f32_16x16x32_bf16 v[176:179], a[140:143], v[56:59], v[176:179]
    buffer_load_dwordx4 v33, s[60:63], s39 offen offset:0  lds
    v_mfma_f32_16x16x32_bf16 v[172:175], a[140:143], v[52:55], v[172:175]
    s_waitcnt lgkmcnt(4)
    ds_read_b64_tr_b16 a[156:157], v17 offset:256
    v_add_f32 v37, v37, v102
    v_mfma_f32_16x16x32_bf16 v[184:187], a[144:147], v[52:55], v[184:187]
    ds_read_b64_tr_b16 a[158:159], v17 offset:6400
    v_add_f32 v38, v38, v106
    v_mfma_f32_16x16x32_bf16 v[188:191], a[144:147], v[56:59], v[188:191]
    buffer_load_dwordx4 v34, s[60:63], s39 offen offset:1024  lds
    v_mfma_f32_16x16x32_bf16 v[192:195], a[144:147], v[60:63], v[192:195]
    s_waitcnt lgkmcnt(4)
    ds_read_b64_tr_b16 a[160:161], v18 offset:256
    v_add_f32 v39, v39, v110
    v_mfma_f32_16x16x32_bf16 v[204:207], a[148:151], v[60:63], v[204:207]
    ds_read_b64_tr_b16 a[162:163], v18 offset:6400
    v_add_f32 v37, v37, v103
    v_mfma_f32_16x16x32_bf16 v[200:203], a[148:151], v[56:59], v[200:203]
    buffer_load_dwordx4 v35, s[60:63], s39 offen offset:2048  lds
    v_mfma_f32_16x16x32_bf16 v[196:199], a[148:151], v[52:55], v[196:199]
    s_waitcnt lgkmcnt(4)
    ds_read_b64_tr_b16 a[164:165], v19 offset:256
    v_add_f32 v38, v38, v107
    v_mfma_f32_16x16x32_bf16 v[208:211], a[152:155], v[52:55], v[208:211]
    s_add_u32 s39, s84, 40960
    ds_read_b64_tr_b16 a[166:167], v19 offset:6400
    v_add_f32 v39, v39, v111
    v_mfma_f32_16x16x32_bf16 v[212:215], a[152:155], v[56:59], v[212:215]
    s_add_u32 m0, s34, 49280
    ds_read_b128 a[72:75], v10 offset:24640
    v_mfma_f32_16x16x32_bf16 v[216:219], a[152:155], v[60:63], v[216:219]
    s_waitcnt lgkmcnt(5)
    buffer_load_dwordx4 v33, s[60:63], s39 offen offset:0  lds
    v_mfma_f32_16x16x32_bf16 v[228:231], a[156:159], v[60:63], v[228:231]
    ds_read_b128 a[76:79], v11 offset:24640
    v_mfma_f32_16x16x32_bf16 v[224:227], a[156:159], v[56:59], v[224:227]
    ds_read_b128 a[80:83], v10 offset:24768
    v_mfma_f32_16x16x32_bf16 v[220:223], a[156:159], v[52:55], v[220:223]
    s_waitcnt lgkmcnt(5)
    buffer_load_dwordx4 v34, s[60:63], s39 offen offset:1024  lds
    v_mfma_f32_16x16x32_bf16 v[232:235], a[160:163], v[52:55], v[232:235]
    ds_read_b128 a[84:87], v11 offset:24768
    v_mfma_f32_16x16x32_bf16 v[236:239], a[160:163], v[56:59], v[236:239]
    ds_read_b128 a[88:91], v10 offset:24896
    v_mfma_f32_16x16x32_bf16 v[240:243], a[160:163], v[60:63], v[240:243]
    s_waitcnt lgkmcnt(5)
    global_load_dword v36, v36, s[52:53] sc1
    v_mfma_f32_16x16x32_bf16 v[252:255], a[164:167], v[60:63], v[252:255]
    ds_read_b128 a[92:95], v11 offset:24896
    v_mfma_f32_16x16x32_bf16 v[248:251], a[164:167], v[56:59], v[248:251]
    ds_read_b128 a[96:99], v10 offset:30784
    v_mfma_f32_16x16x32_bf16 v[244:247], a[164:167], v[52:55], v[244:247]
    s_waitcnt lgkmcnt(6)
    ds_read_b128 a[100:103], v11 offset:30784
    ds_read_b128 a[104:107], v10 offset:30912
    ds_read_b128 a[108:111], v11 offset:30912
    ds_read_b128 a[112:115], v10 offset:31040
    ds_read_b128 a[116:119], v11 offset:31040
    v_mfma_f32_16x16x32_bf16 v[88:91], a[72:75], a[0:3], v[40:43]
    v_exp_f32 v64, v64
    v_mfma_f32_16x16x32_bf16 v[92:95], a[72:75], a[4:7], v[44:47]
    v_exp_f32 v65, v65
    v_mfma_f32_16x16x32_bf16 v[96:99], a[72:75], a[8:11], v[48:51]
    s_waitcnt lgkmcnt(10)
    v_exp_f32 v66, v66
    v_mfma_f32_16x16x32_bf16 v[88:91], a[76:79], a[12:15], v[88:91]
    v_exp_f32 v67, v67
    v_mfma_f32_16x16x32_bf16 v[92:95], a[76:79], a[16:19], v[92:95]
    v_cvt_pk_bf16_f32 v52, v64, v65
    v_cvt_pk_bf16_f32 v53, v66, v67
    v_mfma_f32_16x16x32_bf16 v[96:99], a[76:79], a[20:23], v[96:99]
    s_waitcnt lgkmcnt(9)
    v_exp_f32 v76, v76
    v_mfma_f32_16x16x32_bf16 v[88:91], a[80:83], a[24:27], v[88:91]
    v_exp_f32 v77, v77
    v_mfma_f32_16x16x32_bf16 v[92:95], a[80:83], a[28:31], v[92:95]
    v_exp_f32 v78, v78
    v_mfma_f32_16x16x32_bf16 v[96:99], a[80:83], a[32:35], v[96:99]
    s_waitcnt lgkmcnt(8)
    v_exp_f32 v79, v79
    v_mfma_f32_16x16x32_bf16 v[88:91], a[84:87], a[36:39], v[88:91]
    v_cvt_pk_bf16_f32 v54, v76, v77
    v_cvt_pk_bf16_f32 v55, v78, v79
    v_mfma_f32_16x16x32_bf16 v[92:95], a[84:87], a[40:43], v[92:95]
    v_exp_f32 v68, v68
    v_mfma_f32_16x16x32_bf16 v[96:99], a[84:87], a[44:47], v[96:99]
    s_waitcnt lgkmcnt(7)
    v_exp_f32 v69, v69
    v_mfma_f32_16x16x32_bf16 v[88:91], a[88:91], a[48:51], v[88:91]
    v_exp_f32 v70, v70
    v_mfma_f32_16x16x32_bf16 v[92:95], a[88:91], a[52:55], v[92:95]
    v_exp_f32 v71, v71
    v_mfma_f32_16x16x32_bf16 v[96:99], a[88:91], a[56:59], v[96:99]
    s_waitcnt lgkmcnt(6)
    v_cvt_pk_bf16_f32 v56, v68, v69
    v_cvt_pk_bf16_f32 v57, v70, v71
    v_mfma_f32_16x16x32_bf16 v[88:91], a[92:95], a[60:63], v[88:91]
    v_exp_f32 v80, v80
    v_mfma_f32_16x16x32_bf16 v[92:95], a[92:95], a[64:67], v[92:95]
    v_exp_f32 v81, v81
    v_mfma_f32_16x16x32_bf16 v[96:99], a[92:95], a[68:71], v[96:99]
    s_waitcnt lgkmcnt(5)
    v_exp_f32 v82, v82
    v_mfma_f32_16x16x32_bf16 v[100:103], a[96:99], a[0:3], v[40:43]
    v_exp_f32 v83, v83
    v_mfma_f32_16x16x32_bf16 v[104:107], a[96:99], a[4:7], v[44:47]
    v_cvt_pk_bf16_f32 v58, v80, v81
    v_cvt_pk_bf16_f32 v59, v82, v83
    v_mfma_f32_16x16x32_bf16 v[108:111], a[96:99], a[8:11], v[48:51]
    s_waitcnt lgkmcnt(4)
    v_exp_f32 v72, v72
    v_mfma_f32_16x16x32_bf16 v[100:103], a[100:103], a[12:15], v[100:103]
    v_exp_f32 v73, v73
    v_mfma_f32_16x16x32_bf16 v[104:107], a[100:103], a[16:19], v[104:107]
    v_exp_f32 v74, v74
    v_mfma_f32_16x16x32_bf16 v[108:111], a[100:103], a[20:23], v[108:111]
    s_waitcnt lgkmcnt(3)
    s_waitcnt vmcnt(17) lgkmcnt(0)
    s_barrier
    v_exp_f32 v75, v75
    v_mfma_f32_16x16x32_bf16 v[100:103], a[104:107], a[24:27], v[100:103]
    ds_read_b64_tr_b16 a[120:121], v16 offset:12320
    v_add_f32 v37, v37, v64
    v_mfma_f32_16x16x32_bf16 v[104:107], a[104:107], a[28:31], v[104:107]
    v_cvt_pk_bf16_f32 v60, v72, v73
    v_cvt_pk_bf16_f32 v61, v74, v75
    v_mfma_f32_16x16x32_bf16 v[108:111], a[104:107], a[32:35], v[108:111]
    ds_read_b64_tr_b16 a[122:123], v16 offset:18464
    v_add_f32 v37, v37, v65
    v_mfma_f32_16x16x32_bf16 v[100:103], a[108:111], a[36:39], v[100:103]
    v_exp_f32 v84, v84
    v_mfma_f32_16x16x32_bf16 v[104:107], a[108:111], a[40:43], v[104:107]
    ds_read_b64_tr_b16 a[124:125], v17 offset:12320
    v_add_f32 v37, v37, v66
    v_mfma_f32_16x16x32_bf16 v[108:111], a[108:111], a[44:47], v[108:111]
    v_exp_f32 v85, v85
    v_mfma_f32_16x16x32_bf16 v[100:103], a[112:115], a[48:51], v[100:103]
    ds_read_b64_tr_b16 a[126:127], v17 offset:18464
    v_add_f32 v37, v37, v67
    v_mfma_f32_16x16x32_bf16 v[104:107], a[112:115], a[52:55], v[104:107]
    v_exp_f32 v86, v86
    v_mfma_f32_16x16x32_bf16 v[108:111], a[112:115], a[56:59], v[108:111]
    ds_read_b64_tr_b16 a[128:129], v18 offset:12320
    v_add_f32 v37, v37, v76
    v_mfma_f32_16x16x32_bf16 v[100:103], a[116:119], a[60:63], v[100:103]
    v_exp_f32 v87, v87
    v_mfma_f32_16x16x32_bf16 v[104:107], a[116:119], a[64:67], v[104:107]
    ds_read_b64_tr_b16 a[130:131], v18 offset:18464
    v_add_f32 v37, v37, v77
    v_mfma_f32_16x16x32_bf16 v[108:111], a[116:119], a[68:71], v[108:111]
    s_waitcnt lgkmcnt(4)
    v_cvt_pk_bf16_f32 v62, v84, v85
    v_cvt_pk_bf16_f32 v63, v86, v87
    v_mfma_f32_16x16x32_bf16 v[112:115], a[120:123], v[52:55], v[112:115]
    ds_read_b64_tr_b16 a[132:133], v19 offset:12320
    v_add_f32 v38, v38, v68
    v_mfma_f32_16x16x32_bf16 v[116:119], a[120:123], v[56:59], v[116:119]
    s_add_u32 s39, s34, 172032
    ds_read_b64_tr_b16 a[134:135], v19 offset:18464
    v_add_f32 v39, v39, v72
    v_mfma_f32_16x16x32_bf16 v[120:123], a[120:123], v[60:63], v[120:123]
    s_waitcnt lgkmcnt(4)
    s_add_u32 m0, s34, 24640
    ds_read_b64_tr_b16 a[136:137], v16 offset:12448
    v_add_f32 v38, v38, v69
    v_mfma_f32_16x16x32_bf16 v[132:135], a[124:127], v[60:63], v[132:135]
    buffer_load_dwordx4 v21, s[12:15], s39 offen offset:1024 nt lds
    v_mfma_f32_16x16x32_bf16 v[128:131], a[124:127], v[56:59], v[128:131]
    ds_read_b64_tr_b16 a[138:139], v16 offset:18592
    v_add_f32 v39, v39, v73
    v_mfma_f32_16x16x32_bf16 v[124:127], a[124:127], v[52:55], v[124:127]
    s_waitcnt lgkmcnt(4)
    ds_read_b64_tr_b16 a[140:141], v17 offset:12448
    v_add_f32 v38, v38, v70
    v_mfma_f32_16x16x32_bf16 v[136:139], a[128:131], v[52:55], v[136:139]
    buffer_load_dwordx4 v22, s[12:15], s39 offen offset:2048 nt lds
    v_mfma_f32_16x16x32_bf16 v[140:143], a[128:131], v[56:59], v[140:143]
    ds_read_b64_tr_b16 a[142:143], v17 offset:18592
    v_add_f32 v39, v39, v74
    v_mfma_f32_16x16x32_bf16 v[144:147], a[128:131], v[60:63], v[144:147]
    s_waitcnt lgkmcnt(4)
    s_add_u32 s39, s34, 159744
    ds_read_b64_tr_b16 a[144:145], v18 offset:12448
    v_add_f32 v38, v38, v71
    v_mfma_f32_16x16x32_bf16 v[156:159], a[132:135], v[60:63], v[156:159]
    s_add_u32 m0, s34, 135520
    ds_read_b64_tr_b16 a[146:147], v18 offset:18592
    v_add_f32 v39, v39, v75
    v_mfma_f32_16x16x32_bf16 v[152:155], a[132:135], v[56:59], v[152:155]
    buffer_load_dwordx4 v23, s[16:19], s39 offen offset:0 nt lds
    v_mfma_f32_16x16x32_bf16 v[148:151], a[132:135], v[52:55], v[148:151]
    s_waitcnt lgkmcnt(4)
    ds_read_b64_tr_b16 a[148:149], v19 offset:12448
    v_add_f32 v38, v38, v80
    v_mfma_f32_16x16x32_bf16 v[160:163], a[136:139], v[52:55], v[160:163]
    ds_read_b64_tr_b16 a[150:151], v19 offset:18592
    v_add_f32 v39, v39, v84
    v_mfma_f32_16x16x32_bf16 v[164:167], a[136:139], v[56:59], v[164:167]
    ds_read_b64_tr_b16 a[152:153], v16 offset:12576
    v_add_f32 v38, v38, v81
    v_mfma_f32_16x16x32_bf16 v[168:171], a[136:139], v[60:63], v[168:171]
    s_waitcnt lgkmcnt(5)
    buffer_load_dwordx4 v24, s[16:19], s39 offen offset:1024 nt lds
    v_mfma_f32_16x16x32_bf16 v[180:183], a[140:143], v[60:63], v[180:183]
    ds_read_b64_tr_b16 a[154:155], v16 offset:18720
    v_add_f32 v39, v39, v85
    v_mfma_f32_16x16x32_bf16 v[176:179], a[140:143], v[56:59], v[176:179]
    ds_read_b64_tr_b16 a[156:157], v17 offset:12576
    v_add_f32 v37, v37, v78
    v_mfma_f32_16x16x32_bf16 v[172:175], a[140:143], v[52:55], v[172:175]
    s_waitcnt lgkmcnt(5)
    buffer_load_dwordx4 v25, s[16:19], s39 offen offset:2048 nt lds
    v_mfma_f32_16x16x32_bf16 v[184:187], a[144:147], v[52:55], v[184:187]
    ds_read_b64_tr_b16 a[158:159], v17 offset:18720
    v_add_f32 v38, v38, v82
    v_mfma_f32_16x16x32_bf16 v[188:191], a[144:147], v[56:59], v[188:191]
    s_add_u32 s39, s84, 40960
    ds_read_b64_tr_b16 a[160:161], v18 offset:12576
    v_add_f32 v39, v39, v86
    v_mfma_f32_16x16x32_bf16 v[192:195], a[144:147], v[60:63], v[192:195]
    s_waitcnt lgkmcnt(5)
    s_add_u32 m0, s34, 49280
    ds_read_b64_tr_b16 a[162:163], v18 offset:18720
    v_add_f32 v37, v37, v79
    v_mfma_f32_16x16x32_bf16 v[204:207], a[148:151], v[60:63], v[204:207]
    buffer_load_dwordx4 v35, s[60:63], s39 offen offset:2048  lds
    v_mfma_f32_16x16x32_bf16 v[200:203], a[148:151], v[56:59], v[200:203]
    ds_read_b64_tr_b16 a[164:165], v19 offset:12576
    v_add_f32 v38, v38, v83
    v_mfma_f32_16x16x32_bf16 v[196:199], a[148:151], v[52:55], v[196:199]
    s_waitcnt lgkmcnt(5)
    s_add_u32 s39, s84, 81920
    ds_read_b64_tr_b16 a[166:167], v19 offset:18720
    v_add_f32 v39, v39, v87
    v_mfma_f32_16x16x32_bf16 v[208:211], a[152:155], v[52:55], v[208:211]
    s_add_u32 m0, s34, 61600
    ds_read_b128 a[72:75], v8 offset:0
    v_mfma_f32_16x16x32_bf16 v[212:215], a[152:155], v[56:59], v[212:215]
    buffer_load_dwordx4 v33, s[60:63], s39 offen offset:0  lds
    v_mfma_f32_16x16x32_bf16 v[216:219], a[152:155], v[60:63], v[216:219]
    s_waitcnt lgkmcnt(5)
    ds_read_b128 a[76:79], v9 offset:0
    v_mfma_f32_16x16x32_bf16 v[228:231], a[156:159], v[60:63], v[228:231]
    ds_read_b128 a[80:83], v8 offset:128
    v_mfma_f32_16x16x32_bf16 v[224:227], a[156:159], v[56:59], v[224:227]
    buffer_load_dwordx4 v34, s[60:63], s39 offen offset:1024  lds
    v_mfma_f32_16x16x32_bf16 v[220:223], a[156:159], v[52:55], v[220:223]
    s_waitcnt lgkmcnt(5)
    ds_read_b128 a[84:87], v9 offset:128
    v_mfma_f32_16x16x32_bf16 v[232:235], a[160:163], v[52:55], v[232:235]
    ds_read_b128 a[88:91], v8 offset:256
    v_mfma_f32_16x16x32_bf16 v[236:239], a[160:163], v[56:59], v[236:239]
    ds_read_b128 a[92:95], v9 offset:256
    v_mfma_f32_16x16x32_bf16 v[240:243], a[160:163], v[60:63], v[240:243]
    s_waitcnt lgkmcnt(6)
    buffer_load_dwordx4 v35, s[60:63], s39 offen offset:2048  lds
    v_mfma_f32_16x16x32_bf16 v[252:255], a[164:167], v[60:63], v[252:255]
    ds_read_b128 a[96:99], v8 offset:6144
    v_mfma_f32_16x16x32_bf16 v[248:251], a[164:167], v[56:59], v[248:251]
    ds_read_b128 a[100:103], v9 offset:6144
    v_mfma_f32_16x16x32_bf16 v[244:247], a[164:167], v[52:55], v[244:247]
    s_waitcnt lgkmcnt(7)
    ds_read_b128 a[104:107], v8 offset:6272
    ds_read_b128 a[108:111], v9 offset:6272
    ds_read_b128 a[112:115], v8 offset:6400
    ds_read_b128 a[116:119], v9 offset:6400
    v_mfma_f32_16x16x32_bf16 v[64:67], a[72:75], a[0:3], v[40:43]
    v_exp_f32 v88, v88
    v_mfma_f32_16x16x32_bf16 v[68:71], a[72:75], a[4:7], v[44:47]
    v_exp_f32 v89, v89
    v_mfma_f32_16x16x32_bf16 v[72:75], a[72:75], a[8:11], v[48:51]
    s_waitcnt lgkmcnt(10)
    v_exp_f32 v90, v90
    v_mfma_f32_16x16x32_bf16 v[64:67], a[76:79], a[12:15], v[64:67]
    v_exp_f32 v91, v91
    v_mfma_f32_16x16x32_bf16 v[68:71], a[76:79], a[16:19], v[68:71]
    v_cvt_pk_bf16_f32 v52, v88, v89
    v_cvt_pk_bf16_f32 v53, v90, v91
    v_mfma_f32_16x16x32_bf16 v[72:75], a[76:79], a[20:23], v[72:75]
    s_waitcnt lgkmcnt(9)
    v_exp_f32 v100, v100
    v_mfma_f32_16x16x32_bf16 v[64:67], a[80:83], a[24:27], v[64:67]
    v_exp_f32 v101, v101
    v_mfma_f32_16x16x32_bf16 v[68:71], a[80:83], a[28:31], v[68:71]
    v_exp_f32 v102, v102
    v_mfma_f32_16x16x32_bf16 v[72:75], a[80:83], a[32:35], v[72:75]
    s_waitcnt lgkmcnt(8)
    v_exp_f32 v103, v103
    v_mfma_f32_16x16x32_bf16 v[64:67], a[84:87], a[36:39], v[64:67]
    v_cvt_pk_bf16_f32 v54, v100, v101
    v_cvt_pk_bf16_f32 v55, v102, v103
    v_mfma_f32_16x16x32_bf16 v[68:71], a[84:87], a[40:43], v[68:71]
    v_exp_f32 v92, v92
    v_mfma_f32_16x16x32_bf16 v[72:75], a[84:87], a[44:47], v[72:75]
    s_waitcnt lgkmcnt(7)
    v_exp_f32 v93, v93
    v_mfma_f32_16x16x32_bf16 v[64:67], a[88:91], a[48:51], v[64:67]
    v_exp_f32 v94, v94
    v_mfma_f32_16x16x32_bf16 v[68:71], a[88:91], a[52:55], v[68:71]
    v_exp_f32 v95, v95
    v_mfma_f32_16x16x32_bf16 v[72:75], a[88:91], a[56:59], v[72:75]
    s_waitcnt lgkmcnt(6)
    v_cvt_pk_bf16_f32 v56, v92, v93
    v_cvt_pk_bf16_f32 v57, v94, v95
    v_mfma_f32_16x16x32_bf16 v[64:67], a[92:95], a[60:63], v[64:67]
    v_exp_f32 v104, v104
    v_mfma_f32_16x16x32_bf16 v[68:71], a[92:95], a[64:67], v[68:71]
    v_exp_f32 v105, v105
    v_mfma_f32_16x16x32_bf16 v[72:75], a[92:95], a[68:71], v[72:75]
    s_waitcnt lgkmcnt(5)
    v_exp_f32 v106, v106
    v_mfma_f32_16x16x32_bf16 v[76:79], a[96:99], a[0:3], v[40:43]
    v_exp_f32 v107, v107
    v_mfma_f32_16x16x32_bf16 v[80:83], a[96:99], a[4:7], v[44:47]
    v_cvt_pk_bf16_f32 v58, v104, v105
    v_cvt_pk_bf16_f32 v59, v106, v107
    v_mfma_f32_16x16x32_bf16 v[84:87], a[96:99], a[8:11], v[48:51]
    s_waitcnt lgkmcnt(4)
    v_exp_f32 v96, v96
    v_mfma_f32_16x16x32_bf16 v[76:79], a[100:103], a[12:15], v[76:79]
    v_exp_f32 v97, v97
    v_mfma_f32_16x16x32_bf16 v[80:83], a[100:103], a[16:19], v[80:83]
    v_exp_f32 v98, v98
    v_mfma_f32_16x16x32_bf16 v[84:87], a[100:103], a[20:23], v[84:87]
    s_waitcnt lgkmcnt(3)
    s_waitcnt vmcnt(19) lgkmcnt(0)
    s_barrier
    v_exp_f32 v99, v99
    v_mfma_f32_16x16x32_bf16 v[76:79], a[104:107], a[24:27], v[76:79]
    ds_read_b64_tr_b16 a[120:121], v16 offset:24640
    v_add_f32 v37, v37, v88
    v_mfma_f32_16x16x32_bf16 v[80:83], a[104:107], a[28:31], v[80:83]
    v_cvt_pk_bf16_f32 v60, v96, v97
    v_cvt_pk_bf16_f32 v61, v98, v99
    v_mfma_f32_16x16x32_bf16 v[84:87], a[104:107], a[32:35], v[84:87]
    ds_read_b64_tr_b16 a[122:123], v16 offset:30784
    v_add_f32 v37, v37, v89
    v_mfma_f32_16x16x32_bf16 v[76:79], a[108:111], a[36:39], v[76:79]
    v_exp_f32 v108, v108
    v_mfma_f32_16x16x32_bf16 v[80:83], a[108:111], a[40:43], v[80:83]
    ds_read_b64_tr_b16 a[124:125], v17 offset:24640
    v_add_f32 v37, v37, v90
    v_mfma_f32_16x16x32_bf16 v[84:87], a[108:111], a[44:47], v[84:87]
    v_exp_f32 v109, v109
    v_mfma_f32_16x16x32_bf16 v[76:79], a[112:115], a[48:51], v[76:79]
    ds_read_b64_tr_b16 a[126:127], v17 offset:30784
    v_add_f32 v37, v37, v91
    v_mfma_f32_16x16x32_bf16 v[80:83], a[112:115], a[52:55], v[80:83]
    v_exp_f32 v110, v110
    v_mfma_f32_16x16x32_bf16 v[84:87], a[112:115], a[56:59], v[84:87]
    ds_read_b64_tr_b16 a[128:129], v18 offset:24640
    v_add_f32 v37, v37, v100
    v_mfma_f32_16x16x32_bf16 v[76:79], a[116:119], a[60:63], v[76:79]
    v_exp_f32 v111, v111
    v_mfma_f32_16x16x32_bf16 v[80:83], a[116:119], a[64:67], v[80:83]
    ds_read_b64_tr_b16 a[130:131], v18 offset:30784
    v_add_f32 v37, v37, v101
    v_mfma_f32_16x16x32_bf16 v[84:87], a[116:119], a[68:71], v[84:87]
    s_waitcnt lgkmcnt(4)
    v_cvt_pk_bf16_f32 v62, v108, v109
    v_cvt_pk_bf16_f32 v63, v110, v111
    v_mfma_f32_16x16x32_bf16 v[112:115], a[120:123], v[52:55], v[112:115]
    ds_read_b64_tr_b16 a[132:133], v19 offset:24640
    v_add_f32 v38, v38, v92
    v_mfma_f32_16x16x32_bf16 v[116:119], a[120:123], v[56:59], v[116:119]
    s_add_u32 s39, s34, 184320
    ds_read_b64_tr_b16 a[134:135], v19 offset:30784
    v_add_f32 v39, v39, v96
    v_mfma_f32_16x16x32_bf16 v[120:123], a[120:123], v[60:63], v[120:123]
    s_waitcnt lgkmcnt(4)
    s_add_u32 m0, s34, 36960
    ds_read_b64_tr_b16 a[136:137], v16 offset:24768
    v_add_f32 v38, v38, v93
    v_mfma_f32_16x16x32_bf16 v[132:135], a[124:127], v[60:63], v[132:135]
    buffer_load_dwordx4 v20, s[12:15], s39 offen offset:0 nt lds
    v_mfma_f32_16x16x32_bf16 v[128:131], a[124:127], v[56:59], v[128:131]
    ds_read_b64_tr_b16 a[138:139], v16 offset:30912
    v_add_f32 v39, v39, v97
    v_mfma_f32_16x16x32_bf16 v[124:127], a[124:127], v[52:55], v[124:127]
    s_waitcnt lgkmcnt(4)
    ds_read_b64_tr_b16 a[140:141], v17 offset:24768
    v_add_f32 v38, v38, v94
    v_mfma_f32_16x16x32_bf16 v[136:139], a[128:131], v[52:55], v[136:139]
    buffer_load_dwordx4 v21, s[12:15], s39 offen offset:1024 nt lds
    v_mfma_f32_16x16x32_bf16 v[140:143], a[128:131], v[56:59], v[140:143]
    ds_read_b64_tr_b16 a[142:143], v17 offset:30912
    v_add_f32 v39, v39, v98
    v_mfma_f32_16x16x32_bf16 v[144:147], a[128:131], v[60:63], v[144:147]
    s_waitcnt lgkmcnt(4)
    ds_read_b64_tr_b16 a[144:145], v18 offset:24768
    v_add_f32 v38, v38, v95
    v_mfma_f32_16x16x32_bf16 v[156:159], a[132:135], v[60:63], v[156:159]
    ds_read_b64_tr_b16 a[146:147], v18 offset:30912
    v_add_f32 v39, v39, v99
    v_mfma_f32_16x16x32_bf16 v[152:155], a[132:135], v[56:59], v[152:155]
    buffer_load_dwordx4 v22, s[12:15], s39 offen offset:2048 nt lds
    v_mfma_f32_16x16x32_bf16 v[148:151], a[132:135], v[52:55], v[148:151]
    s_waitcnt lgkmcnt(4)
    ds_read_b64_tr_b16 a[148:149], v19 offset:24768
    v_add_f32 v38, v38, v104
    v_mfma_f32_16x16x32_bf16 v[160:163], a[136:139], v[52:55], v[160:163]
    s_add_u32 s39, s34, 172032
    ds_read_b64_tr_b16 a[150:151], v19 offset:30912
    v_add_f32 v39, v39, v108
    v_mfma_f32_16x16x32_bf16 v[164:167], a[136:139], v[56:59], v[164:167]
    s_add_u32 m0, s34, 147840
    ds_read_b64_tr_b16 a[152:153], v16 offset:24896
    v_add_f32 v38, v38, v105
    v_mfma_f32_16x16x32_bf16 v[168:171], a[136:139], v[60:63], v[168:171]
    s_waitcnt lgkmcnt(5)
    buffer_load_dwordx4 v23, s[16:19], s39 offen offset:0 nt lds
    v_mfma_f32_16x16x32_bf16 v[180:183], a[140:143], v[60:63], v[180:183]
    ds_read_b64_tr_b16 a[154:155], v16 offset:31040
    v_add_f32 v39, v39, v109
    v_mfma_f32_16x16x32_bf16 v[176:179], a[140:143], v[56:59], v[176:179]
    ds_read_b64_tr_b16 a[156:157], v17 offset:24896
    v_add_f32 v37, v37, v102
    v_mfma_f32_16x16x32_bf16 v[172:175], a[140:143], v[52:55], v[172:175]
    s_waitcnt lgkmcnt(5)
    buffer_load_dwordx4 v24, s[16:19], s39 offen offset:1024 nt lds
    v_mfma_f32_16x16x32_bf16 v[184:187], a[144:147], v[52:55], v[184:187]
    ds_read_b64_tr_b16 a[158:159], v17 offset:31040
    v_add_f32 v38, v38, v106
    v_mfma_f32_16x16x32_bf16 v[188:191], a[144:147], v[56:59], v[188:191]
    s_add_u32 s39, s84, 122880
    ds_read_b64_tr_b16 a[160:161], v18 offset:24896
    v_add_f32 v39, v39, v110
    v_mfma_f32_16x16x32_bf16 v[192:195], a[144:147], v[60:63], v[192:195]
    s_waitcnt lgkmcnt(5)
    s_add_u32 m0, s34, 0
    ds_read_b64_tr_b16 a[162:163], v18 offset:31040
    v_add_f32 v37, v37, v103
    v_mfma_f32_16x16x32_bf16 v[204:207], a[148:151], v[60:63], v[204:207]
    buffer_load_dwordx4 v33, s[60:63], s39 offen offset:0  lds
    v_mfma_f32_16x16x32_bf16 v[200:203], a[148:151], v[56:59], v[200:203]
    ds_read_b64_tr_b16 a[164:165], v19 offset:24896
    v_add_f32 v38, v38, v107
    v_mfma_f32_16x16x32_bf16 v[196:199], a[148:151], v[52:55], v[196:199]
    s_waitcnt lgkmcnt(5)
    ds_read_b64_tr_b16 a[166:167], v19 offset:31040
    v_add_f32 v39, v39, v111
    v_mfma_f32_16x16x32_bf16 v[208:211], a[152:155], v[52:55], v[208:211]
    ds_read_b128 a[72:75], v8 offset:12320
    v_mfma_f32_16x16x32_bf16 v[212:215], a[152:155], v[56:59], v[212:215]
    buffer_load_dwordx4 v34, s[60:63], s39 offen offset:1024  lds
    v_mfma_f32_16x16x32_bf16 v[216:219], a[152:155], v[60:63], v[216:219]
    s_waitcnt lgkmcnt(5)
    ds_read_b128 a[76:79], v9 offset:12320
    v_mfma_f32_16x16x32_bf16 v[228:231], a[156:159], v[60:63], v[228:231]
    ds_read_b128 a[80:83], v8 offset:12448
    v_mfma_f32_16x16x32_bf16 v[224:227], a[156:159], v[56:59], v[224:227]
    buffer_load_dwordx4 v35, s[60:63], s39 offen offset:2048  lds
    v_mfma_f32_16x16x32_bf16 v[220:223], a[156:159], v[52:55], v[220:223]
    s_waitcnt lgkmcnt(5)
    ds_read_b128 a[84:87], v9 offset:12448
    v_mfma_f32_16x16x32_bf16 v[232:235], a[160:163], v[52:55], v[232:235]
    s_add_u32 s39, s84, 163840
    ds_read_b128 a[88:91], v8 offset:12576
    v_mfma_f32_16x16x32_bf16 v[236:239], a[160:163], v[56:59], v[236:239]
    s_add_u32 m0, s34, 98560
    ds_read_b128 a[92:95], v9 offset:12576
    v_mfma_f32_16x16x32_bf16 v[240:243], a[160:163], v[60:63], v[240:243]
    s_waitcnt lgkmcnt(6)
    buffer_load_dwordx4 v33, s[60:63], s39 offen offset:0  lds
    v_mfma_f32_16x16x32_bf16 v[252:255], a[164:167], v[60:63], v[252:255]
    ds_read_b128 a[96:99], v8 offset:18464
    v_mfma_f32_16x16x32_bf16 v[248:251], a[164:167], v[56:59], v[248:251]
    ds_read_b128 a[100:103], v9 offset:18464
    v_mfma_f32_16x16x32_bf16 v[244:247], a[164:167], v[52:55], v[244:247]
    s_waitcnt lgkmcnt(7)
    ds_read_b128 a[104:107], v8 offset:18592
    ds_read_b128 a[108:111], v9 offset:18592
    ds_read_b128 a[112:115], v8 offset:18720
    ds_read_b128 a[116:119], v9 offset:18720
    v_mfma_f32_16x16x32_bf16 v[88:91], a[72:75], a[0:3], v[40:43]
    v_exp_f32 v64, v64
    v_mfma_f32_16x16x32_bf16 v[92:95], a[72:75], a[4:7], v[44:47]
    v_exp_f32 v65, v65
    v_mfma_f32_16x16x32_bf16 v[96:99], a[72:75], a[8:11], v[48:51]
    s_waitcnt lgkmcnt(10)
    v_exp_f32 v66, v66
    v_mfma_f32_16x16x32_bf16 v[88:91], a[76:79], a[12:15], v[88:91]
    v_exp_f32 v67, v67
    v_mfma_f32_16x16x32_bf16 v[92:95], a[76:79], a[16:19], v[92:95]
    v_cvt_pk_bf16_f32 v52, v64, v65
    v_cvt_pk_bf16_f32 v53, v66, v67
    v_mfma_f32_16x16x32_bf16 v[96:99], a[76:79], a[20:23], v[96:99]
    s_waitcnt lgkmcnt(9)
    v_exp_f32 v76, v76
    v_mfma_f32_16x16x32_bf16 v[88:91], a[80:83], a[24:27], v[88:91]
    v_exp_f32 v77, v77
    v_mfma_f32_16x16x32_bf16 v[92:95], a[80:83], a[28:31], v[92:95]
    v_exp_f32 v78, v78
    v_mfma_f32_16x16x32_bf16 v[96:99], a[80:83], a[32:35], v[96:99]
    s_waitcnt lgkmcnt(8)
    v_exp_f32 v79, v79
    v_mfma_f32_16x16x32_bf16 v[88:91], a[84:87], a[36:39], v[88:91]
    v_cvt_pk_bf16_f32 v54, v76, v77
    v_cvt_pk_bf16_f32 v55, v78, v79
    v_mfma_f32_16x16x32_bf16 v[92:95], a[84:87], a[40:43], v[92:95]
    v_exp_f32 v68, v68
    v_mfma_f32_16x16x32_bf16 v[96:99], a[84:87], a[44:47], v[96:99]
    s_waitcnt lgkmcnt(7)
    v_exp_f32 v69, v69
    v_mfma_f32_16x16x32_bf16 v[88:91], a[88:91], a[48:51], v[88:91]
    v_exp_f32 v70, v70
    v_mfma_f32_16x16x32_bf16 v[92:95], a[88:91], a[52:55], v[92:95]
    v_exp_f32 v71, v71
    v_mfma_f32_16x16x32_bf16 v[96:99], a[88:91], a[56:59], v[96:99]
    s_waitcnt lgkmcnt(6)
    v_cvt_pk_bf16_f32 v56, v68, v69
    v_cvt_pk_bf16_f32 v57, v70, v71
    v_mfma_f32_16x16x32_bf16 v[88:91], a[92:95], a[60:63], v[88:91]
    v_exp_f32 v80, v80
    v_mfma_f32_16x16x32_bf16 v[92:95], a[92:95], a[64:67], v[92:95]
    v_exp_f32 v81, v81
    v_mfma_f32_16x16x32_bf16 v[96:99], a[92:95], a[68:71], v[96:99]
    s_waitcnt lgkmcnt(5)
    v_exp_f32 v82, v82
    v_mfma_f32_16x16x32_bf16 v[100:103], a[96:99], a[0:3], v[40:43]
    v_exp_f32 v83, v83
    v_mfma_f32_16x16x32_bf16 v[104:107], a[96:99], a[4:7], v[44:47]
    v_cvt_pk_bf16_f32 v58, v80, v81
    v_cvt_pk_bf16_f32 v59, v82, v83
    v_mfma_f32_16x16x32_bf16 v[108:111], a[96:99], a[8:11], v[48:51]
    s_waitcnt lgkmcnt(4)
    v_exp_f32 v72, v72
    v_mfma_f32_16x16x32_bf16 v[100:103], a[100:103], a[12:15], v[100:103]
    v_exp_f32 v73, v73
    v_mfma_f32_16x16x32_bf16 v[104:107], a[100:103], a[16:19], v[104:107]
    v_exp_f32 v74, v74
    v_mfma_f32_16x16x32_bf16 v[108:111], a[100:103], a[20:23], v[108:111]
    s_waitcnt lgkmcnt(3)
    s_waitcnt vmcnt(16) lgkmcnt(0)
    s_barrier
    v_exp_f32 v75, v75
    v_mfma_f32_16x16x32_bf16 v[100:103], a[104:107], a[24:27], v[100:103]
    ds_read_b64_tr_b16 a[120:121], v12 offset:0
    v_add_f32 v37, v37, v64
    v_mfma_f32_16x16x32_bf16 v[104:107], a[104:107], a[28:31], v[104:107]
    v_cvt_pk_bf16_f32 v60, v72, v73
    v_cvt_pk_bf16_f32 v61, v74, v75
    v_mfma_f32_16x16x32_bf16 v[108:111], a[104:107], a[32:35], v[108:111]
    ds_read_b64_tr_b16 a[122:123], v12 offset:6144
    v_add_f32 v37, v37, v65
    v_mfma_f32_16x16x32_bf16 v[100:103], a[108:111], a[36:39], v[100:103]
    v_exp_f32 v84, v84
    v_mfma_f32_16x16x32_bf16 v[104:107], a[108:111], a[40:43], v[104:107]
    ds_read_b64_tr_b16 a[124:125], v13 offset:0
    v_add_f32 v37, v37, v66
    v_mfma_f32_16x16x32_bf16 v[108:111], a[108:111], a[44:47], v[108:111]
    v_exp_f32 v85, v85
    v_mfma_f32_16x16x32_bf16 v[100:103], a[112:115], a[48:51], v[100:103]
    ds_read_b64_tr_b16 a[126:127], v13 offset:6144
    v_add_f32 v37, v37, v67
    v_mfma_f32_16x16x32_bf16 v[104:107], a[112:115], a[52:55], v[104:107]
    v_exp_f32 v86, v86
    v_mfma_f32_16x16x32_bf16 v[108:111], a[112:115], a[56:59], v[108:111]
    ds_read_b64_tr_b16 a[128:129], v14 offset:0
    v_add_f32 v37, v37, v76
    v_mfma_f32_16x16x32_bf16 v[100:103], a[116:119], a[60:63], v[100:103]
    v_exp_f32 v87, v87
    v_mfma_f32_16x16x32_bf16 v[104:107], a[116:119], a[64:67], v[104:107]
    ds_read_b64_tr_b16 a[130:131], v14 offset:6144
    v_add_f32 v37, v37, v77
    v_mfma_f32_16x16x32_bf16 v[108:111], a[116:119], a[68:71], v[108:111]
    s_waitcnt lgkmcnt(4)
    v_cvt_pk_bf16_f32 v62, v84, v85
    v_cvt_pk_bf16_f32 v63, v86, v87
    v_mfma_f32_16x16x32_bf16 v[112:115], a[120:123], v[52:55], v[112:115]
    ds_read_b64_tr_b16 a[132:133], v15 offset:0
    v_add_f32 v38, v38, v68
    v_mfma_f32_16x16x32_bf16 v[116:119], a[120:123], v[56:59], v[116:119]
    s_add_u32 s39, s34, 172032
    ds_read_b64_tr_b16 a[134:135], v15 offset:6144
    v_add_f32 v39, v39, v72
    v_mfma_f32_16x16x32_bf16 v[120:123], a[120:123], v[60:63], v[120:123]
    s_waitcnt lgkmcnt(4)
    s_add_u32 m0, s34, 147840
    ds_read_b64_tr_b16 a[136:137], v12 offset:128
    v_add_f32 v38, v38, v69
    v_mfma_f32_16x16x32_bf16 v[132:135], a[124:127], v[60:63], v[132:135]
    buffer_load_dwordx4 v25, s[16:19], s39 offen offset:2048 nt lds
    v_mfma_f32_16x16x32_bf16 v[128:131], a[124:127], v[56:59], v[128:131]
    s_add_u32 s39, s34, 184320
    ds_read_b64_tr_b16 a[138:139], v12 offset:6272
    v_add_f32 v39, v39, v73
    v_mfma_f32_16x16x32_bf16 v[124:127], a[124:127], v[52:55], v[124:127]
    s_waitcnt lgkmcnt(4)
    s_add_u32 m0, s34, 86240
    ds_read_b64_tr_b16 a[140:141], v13 offset:128
    v_add_f32 v38, v38, v70
    v_mfma_f32_16x16x32_bf16 v[136:139], a[128:131], v[52:55], v[136:139]
    buffer_load_dwordx4 v23, s[16:19], s39 offen offset:0 nt lds
    v_mfma_f32_16x16x32_bf16 v[140:143], a[128:131], v[56:59], v[140:143]
    ds_read_b64_tr_b16 a[142:143], v13 offset:6272
    v_add_f32 v39, v39, v74
    v_mfma_f32_16x16x32_bf16 v[144:147], a[128:131], v[60:63], v[144:147]
    s_waitcnt lgkmcnt(4)
    ds_read_b64_tr_b16 a[144:145], v14 offset:128
    v_add_f32 v38, v38, v71
    v_mfma_f32_16x16x32_bf16 v[156:159], a[132:135], v[60:63], v[156:159]
    ds_read_b64_tr_b16 a[146:147], v14 offset:6272
    v_add_f32 v39, v39, v75
    v_mfma_f32_16x16x32_bf16 v[152:155], a[132:135], v[56:59], v[152:155]
    buffer_load_dwordx4 v24, s[16:19], s39 offen offset:1024 nt lds
    v_mfma_f32_16x16x32_bf16 v[148:151], a[132:135], v[52:55], v[148:151]
    s_waitcnt lgkmcnt(4)
    ds_read_b64_tr_b16 a[148:149], v15 offset:128
    v_add_f32 v38, v38, v80
    v_mfma_f32_16x16x32_bf16 v[160:163], a[136:139], v[52:55], v[160:163]
    ds_read_b64_tr_b16 a[150:151], v15 offset:6272
    v_add_f32 v39, v39, v84
    v_mfma_f32_16x16x32_bf16 v[164:167], a[136:139], v[56:59], v[164:167]
    ds_read_b64_tr_b16 a[152:153], v12 offset:256
    v_add_f32 v38, v38, v81
    v_mfma_f32_16x16x32_bf16 v[168:171], a[136:139], v[60:63], v[168:171]
    s_waitcnt lgkmcnt(5)
    buffer_load_dwordx4 v25, s[16:19], s39 offen offset:2048 nt lds
    v_mfma_f32_16x16x32_bf16 v[180:183], a[140:143], v[60:63], v[180:183]
    s_add_u32 s39, s84, 163840
    ds_read_b64_tr_b16 a[154:155], v12 offset:6400
    v_add_f32 v39, v39, v85
    v_mfma_f32_16x16x32_bf16 v[176:179], a[140:143], v[56:59], v[176:179]
    s_add_u32 m0, s34, 98560
    ds_read_b64_tr_b16 a[156:157], v13 offset:256
    v_add_f32 v37, v37, v78
    v_mfma_f32_16x16x32_bf16 v[172:175], a[140:143], v[52:55], v[172:175]
    s_waitcnt lgkmcnt(5)
    buffer_load_dwordx4 v34, s[60:63], s39 offen offset:1024  lds
    v_mfma_f32_16x16x32_bf16 v[184:187], a[144:147], v[52:55], v[184:187]
    ds_read_b64_tr_b16 a[158:159], v13 offset:6400
    v_add_f32 v38, v38, v82
    v_mfma_f32_16x16x32_bf16 v[188:191], a[144:147], v[56:59], v[188:191]
    ds_read_b64_tr_b16 a[160:161], v14 offset:256
    v_add_f32 v39, v39, v86
    v_mfma_f32_16x16x32_bf16 v[192:195], a[144:147], v[60:63], v[192:195]
    s_waitcnt lgkmcnt(5)
    ds_read_b64_tr_b16 a[162:163], v14 offset:6400
    v_add_f32 v37, v37, v79
    v_mfma_f32_16x16x32_bf16 v[204:207], a[148:151], v[60:63], v[204:207]
    buffer_load_dwordx4 v35, s[60:63], s39 offen offset:2048  lds
    v_mfma_f32_16x16x32_bf16 v[200:203], a[148:151], v[56:59], v[200:203]
    ds_read_b64_tr_b16 a[164:165], v15 offset:256
    v_add_f32 v38, v38, v83
    v_mfma_f32_16x16x32_bf16 v[196:199], a[148:151], v[52:55], v[196:199]
    s_waitcnt lgkmcnt(5)
    s_add_u32 s39, s84, 204800
    ds_read_b64_tr_b16 a[166:167], v15 offset:6400
    v_add_f32 v39, v39, v87
    v_mfma_f32_16x16x32_bf16 v[208:211], a[152:155], v[52:55], v[208:211]
    s_add_u32 m0, s34, 12320
    ds_read_b128 a[72:75], v8 offset:24640
    v_mfma_f32_16x16x32_bf16 v[212:215], a[152:155], v[56:59], v[212:215]
    buffer_load_dwordx4 v33, s[60:63], s39 offen offset:0  lds
    v_mfma_f32_16x16x32_bf16 v[216:219], a[152:155], v[60:63], v[216:219]
    s_waitcnt lgkmcnt(5)
    ds_read_b128 a[76:79], v9 offset:24640
    v_mfma_f32_16x16x32_bf16 v[228:231], a[156:159], v[60:63], v[228:231]
    ds_read_b128 a[80:83], v8 offset:24768
    v_mfma_f32_16x16x32_bf16 v[224:227], a[156:159], v[56:59], v[224:227]
    buffer_load_dwordx4 v34, s[60:63], s39 offen offset:1024  lds
    v_mfma_f32_16x16x32_bf16 v[220:223], a[156:159], v[52:55], v[220:223]
    s_waitcnt lgkmcnt(5)
    ds_read_b128 a[84:87], v9 offset:24768
    v_mfma_f32_16x16x32_bf16 v[232:235], a[160:163], v[52:55], v[232:235]
    ds_read_b128 a[88:91], v8 offset:24896
    v_mfma_f32_16x16x32_bf16 v[236:239], a[160:163], v[56:59], v[236:239]
    ds_read_b128 a[92:95], v9 offset:24896
    v_mfma_f32_16x16x32_bf16 v[240:243], a[160:163], v[60:63], v[240:243]
    s_waitcnt lgkmcnt(6)
    buffer_load_dwordx4 v35, s[60:63], s39 offen offset:2048  lds
    v_mfma_f32_16x16x32_bf16 v[252:255], a[164:167], v[60:63], v[252:255]
    ds_read_b128 a[96:99], v8 offset:30784
    v_mfma_f32_16x16x32_bf16 v[248:251], a[164:167], v[56:59], v[248:251]
    ds_read_b128 a[100:103], v9 offset:30784
    v_mfma_f32_16x16x32_bf16 v[244:247], a[164:167], v[52:55], v[244:247]
    s_waitcnt lgkmcnt(7)
    ds_read_b128 a[104:107], v8 offset:30912
    ds_read_b128 a[108:111], v9 offset:30912
    ds_read_b128 a[112:115], v8 offset:31040
    ds_read_b128 a[116:119], v9 offset:31040
    v_mfma_f32_16x16x32_bf16 v[64:67], a[72:75], a[0:3], v[40:43]
    v_exp_f32 v88, v88
    v_mfma_f32_16x16x32_bf16 v[68:71], a[72:75], a[4:7], v[44:47]
    v_exp_f32 v89, v89
    v_mfma_f32_16x16x32_bf16 v[72:75], a[72:75], a[8:11], v[48:51]
    s_waitcnt lgkmcnt(10)
    v_exp_f32 v90, v90
    v_mfma_f32_16x16x32_bf16 v[64:67], a[76:79], a[12:15], v[64:67]
    v_exp_f32 v91, v91
    v_mfma_f32_16x16x32_bf16 v[68:71], a[76:79], a[16:19], v[68:71]
    v_cvt_pk_bf16_f32 v52, v88, v89
    v_cvt_pk_bf16_f32 v53, v90, v91
    v_mfma_f32_16x16x32_bf16 v[72:75], a[76:79], a[20:23], v[72:75]
    s_waitcnt lgkmcnt(9)
    v_exp_f32 v100, v100
    v_mfma_f32_16x16x32_bf16 v[64:67], a[80:83], a[24:27], v[64:67]
    v_exp_f32 v101, v101
    v_mfma_f32_16x16x32_bf16 v[68:71], a[80:83], a[28:31], v[68:71]
    v_exp_f32 v102, v102
    v_mfma_f32_16x16x32_bf16 v[72:75], a[80:83], a[32:35], v[72:75]
    s_waitcnt lgkmcnt(8)
    v_exp_f32 v103, v103
    v_mfma_f32_16x16x32_bf16 v[64:67], a[84:87], a[36:39], v[64:67]
    v_cvt_pk_bf16_f32 v54, v100, v101
    v_cvt_pk_bf16_f32 v55, v102, v103
    v_mfma_f32_16x16x32_bf16 v[68:71], a[84:87], a[40:43], v[68:71]
    v_exp_f32 v92, v92
    v_mfma_f32_16x16x32_bf16 v[72:75], a[84:87], a[44:47], v[72:75]
    s_waitcnt lgkmcnt(7)
    v_exp_f32 v93, v93
    v_mfma_f32_16x16x32_bf16 v[64:67], a[88:91], a[48:51], v[64:67]
    v_exp_f32 v94, v94
    v_mfma_f32_16x16x32_bf16 v[68:71], a[88:91], a[52:55], v[68:71]
    v_exp_f32 v95, v95
    v_mfma_f32_16x16x32_bf16 v[72:75], a[88:91], a[56:59], v[72:75]
    s_waitcnt lgkmcnt(6)
    v_cvt_pk_bf16_f32 v56, v92, v93
    v_cvt_pk_bf16_f32 v57, v94, v95
    v_mfma_f32_16x16x32_bf16 v[64:67], a[92:95], a[60:63], v[64:67]
    v_exp_f32 v104, v104
    v_mfma_f32_16x16x32_bf16 v[68:71], a[92:95], a[64:67], v[68:71]
    v_exp_f32 v105, v105
    v_mfma_f32_16x16x32_bf16 v[72:75], a[92:95], a[68:71], v[72:75]
    s_waitcnt lgkmcnt(5)
    v_exp_f32 v106, v106
    v_mfma_f32_16x16x32_bf16 v[76:79], a[96:99], a[0:3], v[40:43]
    v_exp_f32 v107, v107
    v_mfma_f32_16x16x32_bf16 v[80:83], a[96:99], a[4:7], v[44:47]
    v_cvt_pk_bf16_f32 v58, v104, v105
    v_cvt_pk_bf16_f32 v59, v106, v107
    v_mfma_f32_16x16x32_bf16 v[84:87], a[96:99], a[8:11], v[48:51]
    s_waitcnt lgkmcnt(4)
    v_exp_f32 v96, v96
    v_mfma_f32_16x16x32_bf16 v[76:79], a[100:103], a[12:15], v[76:79]
    v_exp_f32 v97, v97
    v_mfma_f32_16x16x32_bf16 v[80:83], a[100:103], a[16:19], v[80:83]
    v_exp_f32 v98, v98
    v_mfma_f32_16x16x32_bf16 v[84:87], a[100:103], a[20:23], v[84:87]
    s_waitcnt lgkmcnt(3)
    s_waitcnt vmcnt(15) lgkmcnt(0)
    s_barrier
    v_exp_f32 v99, v99
    v_mfma_f32_16x16x32_bf16 v[76:79], a[104:107], a[24:27], v[76:79]
    ds_read_b64_tr_b16 a[120:121], v12 offset:12320
    v_add_f32 v37, v37, v88
    v_mfma_f32_16x16x32_bf16 v[80:83], a[104:107], a[28:31], v[80:83]
    v_cvt_pk_bf16_f32 v60, v96, v97
    v_cvt_pk_bf16_f32 v61, v98, v99
    v_mfma_f32_16x16x32_bf16 v[84:87], a[104:107], a[32:35], v[84:87]
    ds_read_b64_tr_b16 a[122:123], v12 offset:18464
    v_add_f32 v37, v37, v89
    v_mfma_f32_16x16x32_bf16 v[76:79], a[108:111], a[36:39], v[76:79]
    v_exp_f32 v108, v108
    v_mfma_f32_16x16x32_bf16 v[80:83], a[108:111], a[40:43], v[80:83]
    ds_read_b64_tr_b16 a[124:125], v13 offset:12320
    v_add_f32 v37, v37, v90
    v_mfma_f32_16x16x32_bf16 v[84:87], a[108:111], a[44:47], v[84:87]
    v_exp_f32 v109, v109
    v_mfma_f32_16x16x32_bf16 v[76:79], a[112:115], a[48:51], v[76:79]
    ds_read_b64_tr_b16 a[126:127], v13 offset:18464
    v_add_f32 v37, v37, v91
    v_mfma_f32_16x16x32_bf16 v[80:83], a[112:115], a[52:55], v[80:83]
    v_exp_f32 v110, v110
    v_mfma_f32_16x16x32_bf16 v[84:87], a[112:115], a[56:59], v[84:87]
    ds_read_b64_tr_b16 a[128:129], v14 offset:12320
    v_add_f32 v37, v37, v100
    v_mfma_f32_16x16x32_bf16 v[76:79], a[116:119], a[60:63], v[76:79]
    v_exp_f32 v111, v111
    v_mfma_f32_16x16x32_bf16 v[80:83], a[116:119], a[64:67], v[80:83]
    ds_read_b64_tr_b16 a[130:131], v14 offset:18464
    v_add_f32 v37, v37, v101
    v_mfma_f32_16x16x32_bf16 v[84:87], a[116:119], a[68:71], v[84:87]
    s_waitcnt lgkmcnt(4)
    v_cvt_pk_bf16_f32 v62, v108, v109
    v_cvt_pk_bf16_f32 v63, v110, v111
    v_mfma_f32_16x16x32_bf16 v[112:115], a[120:123], v[52:55], v[112:115]
    ds_read_b64_tr_b16 a[132:133], v15 offset:12320
    v_add_f32 v38, v38, v92
    v_mfma_f32_16x16x32_bf16 v[116:119], a[120:123], v[56:59], v[116:119]
    s_add_u32 s39, s85, 0
    ds_read_b64_tr_b16 a[134:135], v15 offset:18464
    v_add_f32 v39, v39, v96
    v_mfma_f32_16x16x32_bf16 v[120:123], a[120:123], v[60:63], v[120:123]
    s_waitcnt lgkmcnt(4)
    s_add_u32 m0, s34, 110880
    ds_read_b64_tr_b16 a[136:137], v12 offset:12448
    v_add_f32 v38, v38, v93
    v_mfma_f32_16x16x32_bf16 v[132:135], a[124:127], v[60:63], v[132:135]
    buffer_load_dwordx4 v33, s[60:63], s39 offen offset:0  lds
    v_mfma_f32_16x16x32_bf16 v[128:131], a[124:127], v[56:59], v[128:131]
    ds_read_b64_tr_b16 a[138:139], v12 offset:18592
    v_add_f32 v39, v39, v97
    v_mfma_f32_16x16x32_bf16 v[124:127], a[124:127], v[52:55], v[124:127]
    s_waitcnt lgkmcnt(4)
    ds_read_b64_tr_b16 a[140:141], v13 offset:12448
    v_add_f32 v38, v38, v94
    v_mfma_f32_16x16x32_bf16 v[136:139], a[128:131], v[52:55], v[136:139]
    buffer_load_dwordx4 v34, s[60:63], s39 offen offset:1024  lds
    v_mfma_f32_16x16x32_bf16 v[140:143], a[128:131], v[56:59], v[140:143]
    ds_read_b64_tr_b16 a[142:143], v13 offset:18592
    v_add_f32 v39, v39, v98
    v_mfma_f32_16x16x32_bf16 v[144:147], a[128:131], v[60:63], v[144:147]
    s_waitcnt lgkmcnt(4)
    ds_read_b64_tr_b16 a[144:145], v14 offset:12448
    v_add_f32 v38, v38, v95
    v_mfma_f32_16x16x32_bf16 v[156:159], a[132:135], v[60:63], v[156:159]
    buffer_load_dwordx4 v35, s[60:63], s39 offen offset:2048  lds
    v_mfma_f32_16x16x32_bf16 v[152:155], a[132:135], v[56:59], v[152:155]
    s_add_u32 s39, s85, 40960
    ds_read_b64_tr_b16 a[146:147], v14 offset:18592
    v_add_f32 v39, v39, v99
    v_mfma_f32_16x16x32_bf16 v[148:151], a[132:135], v[52:55], v[148:151]
    s_waitcnt lgkmcnt(4)
    s_add_u32 m0, s34, 24640
    ds_read_b64_tr_b16 a[148:149], v15 offset:12448
    v_add_f32 v38, v38, v104
    v_mfma_f32_16x16x32_bf16 v[160:163], a[136:139], v[52:55], v[160:163]
    buffer_load_dwordx4 v33, s[60:63], s39 offen offset:0  lds
    v_mfma_f32_16x16x32_bf16 v[164:167], a[136:139], v[56:59], v[164:167]
    ds_read_b64_tr_b16 a[150:151], v15 offset:18592
    v_add_f32 v39, v39, v108
    v_mfma_f32_16x16x32_bf16 v[168:171], a[136:139], v[60:63], v[168:171]
    s_waitcnt lgkmcnt(4)
    ds_read_b64_tr_b16 a[152:153], v12 offset:12576
    v_add_f32 v38, v38, v105
    v_mfma_f32_16x16x32_bf16 v[180:183], a[140:143], v[60:63], v[180:183]
    ds_read_b64_tr_b16 a[154:155], v12 offset:18720
    v_add_f32 v39, v39, v109
    v_mfma_f32_16x16x32_bf16 v[176:179], a[140:143], v[56:59], v[176:179]
    buffer_load_dwordx4 v34, s[60:63], s39 offen offset:1024  lds
    v_mfma_f32_16x16x32_bf16 v[172:175], a[140:143], v[52:55], v[172:175]
    s_waitcnt lgkmcnt(4)
    ds_read_b64_tr_b16 a[156:157], v13 offset:12576
    v_add_f32 v37, v37, v102
    v_mfma_f32_16x16x32_bf16 v[184:187], a[144:147], v[52:55], v[184:187]
    ds_read_b64_tr_b16 a[158:159], v13 offset:18720
    v_add_f32 v38, v38, v106
    v_mfma_f32_16x16x32_bf16 v[188:191], a[144:147], v[56:59], v[188:191]
    buffer_load_dwordx4 v35, s[60:63], s39 offen offset:2048  lds
    v_mfma_f32_16x16x32_bf16 v[192:195], a[144:147], v[60:63], v[192:195]
    s_waitcnt lgkmcnt(4)
    s_add_u32 s39, s86, 0
    ds_read_b64_tr_b16 a[160:161], v14 offset:12576
    v_add_f32 v39, v39, v110
    v_mfma_f32_16x16x32_bf16 v[204:207], a[148:151], v[60:63], v[204:207]
    s_add_u32 m0, s34, 123200
    ds_read_b64_tr_b16 a[162:163], v14 offset:18720
    v_add_f32 v37, v37, v103
    v_mfma_f32_16x16x32_bf16 v[200:203], a[148:151], v[56:59], v[200:203]
    buffer_load_dwordx4 v33, s[60:63], s39 offen offset:0  lds
    v_mfma_f32_16x16x32_bf16 v[196:199], a[148:151], v[52:55], v[196:199]
    s_waitcnt lgkmcnt(4)
    ds_read_b64_tr_b16 a[164:165], v15 offset:12576
    v_add_f32 v38, v38, v107
    v_mfma_f32_16x16x32_bf16 v[208:211], a[152:155], v[52:55], v[208:211]
    ds_read_b64_tr_b16 a[166:167], v15 offset:18720
    v_add_f32 v39, v39, v111
    v_mfma_f32_16x16x32_bf16 v[212:215], a[152:155], v[56:59], v[212:215]
    ds_read_b128 a[72:75], v10 offset:0
    v_mfma_f32_16x16x32_bf16 v[216:219], a[152:155], v[60:63], v[216:219]
    s_waitcnt lgkmcnt(5)
    buffer_load_dwordx4 v34, s[60:63], s39 offen offset:1024  lds
    v_mfma_f32_16x16x32_bf16 v[228:231], a[156:159], v[60:63], v[228:231]
    ds_read_b128 a[76:79], v11 offset:0
    v_mfma_f32_16x16x32_bf16 v[224:227], a[156:159], v[56:59], v[224:227]
    ds_read_b128 a[80:83], v10 offset:128
    v_mfma_f32_16x16x32_bf16 v[220:223], a[156:159], v[52:55], v[220:223]
    s_waitcnt lgkmcnt(5)
    buffer_load_dwordx4 v35, s[60:63], s39 offen offset:2048  lds
    v_mfma_f32_16x16x32_bf16 v[232:235], a[160:163], v[52:55], v[232:235]
    ds_read_b128 a[84:87], v11 offset:128
    v_mfma_f32_16x16x32_bf16 v[236:239], a[160:163], v[56:59], v[236:239]
    s_add_u32 s0, s56, L_TOUCH_END-L_PCBASE-16384
    s_addc_u32 s1, s57, 0
    ds_read_b128 a[88:91], v10 offset:256
    v_mfma_f32_16x16x32_bf16 v[240:243], a[160:163], v[60:63], v[240:243]
    s_waitcnt lgkmcnt(5)
    global_load_dword a255, v0, s[0:1]
    v_mfma_f32_16x16x32_bf16 v[252:255], a[164:167], v[60:63], v[252:255]
    ds_read_b128 a[92:95], v11 offset:256
    v_mfma_f32_16x16x32_bf16 v[248:251], a[164:167], v[56:59], v[248:251]
    ds_read_b128 a[96:99], v10 offset:6144
    v_mfma_f32_16x16x32_bf16 v[244:247], a[164:167], v[52:55], v[244:247]
    s_waitcnt lgkmcnt(6)
    ds_read_b128 a[100:103], v11 offset:6144
    ds_read_b128 a[104:107], v10 offset:6272
    ds_read_b128 a[108:111], v11 offset:6272
    ds_read_b128 a[112:115], v10 offset:6400
    ds_read_b128 a[116:119], v11 offset:6400
    v_mfma_f32_16x16x32_bf16 v[88:91], a[72:75], a[0:3], v[40:43]
    v_exp_f32 v64, v64
    v_mfma_f32_16x16x32_bf16 v[92:95], a[72:75], a[4:7], v[44:47]
    v_exp_f32 v65, v65
    v_mfma_f32_16x16x32_bf16 v[96:99], a[72:75], a[8:11], v[48:51]
    s_waitcnt lgkmcnt(10)
    v_exp_f32 v66, v66
    v_mfma_f32_16x16x32_bf16 v[88:91], a[76:79], a[12:15], v[88:91]
    v_exp_f32 v67, v67
    v_mfma_f32_16x16x32_bf16 v[92:95], a[76:79], a[16:19], v[92:95]
    v_cvt_pk_bf16_f32 v52, v64, v65
    v_cvt_pk_bf16_f32 v53, v66, v67
    v_mfma_f32_16x16x32_bf16 v[96:99], a[76:79], a[20:23], v[96:99]
    s_waitcnt lgkmcnt(9)
    v_exp_f32 v76, v76
    v_mfma_f32_16x16x32_bf16 v[88:91], a[80:83], a[24:27], v[88:91]
    v_exp_f32 v77, v77
    v_mfma_f32_16x16x32_bf16 v[92:95], a[80:83], a[28:31], v[92:95]
    v_exp_f32 v78, v78
    v_mfma_f32_16x16x32_bf16 v[96:99], a[80:83], a[32:35], v[96:99]
    s_waitcnt lgkmcnt(8)
    v_exp_f32 v79, v79
    v_mfma_f32_16x16x32_bf16 v[88:91], a[84:87], a[36:39], v[88:91]
    v_cvt_pk_bf16_f32 v54, v76, v77
    v_cvt_pk_bf16_f32 v55, v78, v79
    v_mfma_f32_16x16x32_bf16 v[92:95], a[84:87], a[40:43], v[92:95]
    v_exp_f32 v68, v68
    v_mfma_f32_16x16x32_bf16 v[96:99], a[84:87], a[44:47], v[96:99]
    s_waitcnt lgkmcnt(7)
    v_exp_f32 v69, v69
    v_mfma_f32_16x16x32_bf16 v[88:91], a[88:91], a[48:51], v[88:91]
    v_exp_f32 v70, v70
    v_mfma_f32_16x16x32_bf16 v[92:95], a[88:91], a[52:55], v[92:95]
    v_exp_f32 v71, v71
    v_mfma_f32_16x16x32_bf16 v[96:99], a[88:91], a[56:59], v[96:99]
    s_waitcnt lgkmcnt(6)
    v_cvt_pk_bf16_f32 v56, v68, v69
    v_cvt_pk_bf16_f32 v57, v70, v71
    v_mfma_f32_16x16x32_bf16 v[88:91], a[92:95], a[60:63], v[88:91]
    v_exp_f32 v80, v80
    v_mfma_f32_16x16x32_bf16 v[92:95], a[92:95], a[64:67], v[92:95]
    v_exp_f32 v81, v81
    v_mfma_f32_16x16x32_bf16 v[96:99], a[92:95], a[68:71], v[96:99]
    s_waitcnt lgkmcnt(5)
    v_exp_f32 v82, v82
    v_mfma_f32_16x16x32_bf16 v[100:103], a[96:99], a[0:3], v[40:43]
    v_exp_f32 v83, v83
    v_mfma_f32_16x16x32_bf16 v[104:107], a[96:99], a[4:7], v[44:47]
    v_cvt_pk_bf16_f32 v58, v80, v81
    v_cvt_pk_bf16_f32 v59, v82, v83
    v_mfma_f32_16x16x32_bf16 v[108:111], a[96:99], a[8:11], v[48:51]
    s_waitcnt lgkmcnt(4)
    v_exp_f32 v72, v72
    v_mfma_f32_16x16x32_bf16 v[100:103], a[100:103], a[12:15], v[100:103]
    v_exp_f32 v73, v73
    v_mfma_f32_16x16x32_bf16 v[104:107], a[100:103], a[16:19], v[104:107]
    v_exp_f32 v74, v74
    v_mfma_f32_16x16x32_bf16 v[108:111], a[100:103], a[20:23], v[108:111]
    s_waitcnt lgkmcnt(3)
    s_waitcnt vmcnt(18) lgkmcnt(0)
    s_barrier
    v_exp_f32 v75, v75
    v_mfma_f32_16x16x32_bf16 v[100:103], a[104:107], a[24:27], v[100:103]
    ds_read_b64_tr_b16 a[120:121], v12 offset:24640
    v_add_f32 v37, v37, v64
    v_mfma_f32_16x16x32_bf16 v[104:107], a[104:107], a[28:31], v[104:107]
    v_cvt_pk_bf16_f32 v60, v72, v73
    v_cvt_pk_bf16_f32 v61, v74, v75
    v_mfma_f32_16x16x32_bf16 v[108:111], a[104:107], a[32:35], v[108:111]
    ds_read_b64_tr_b16 a[122:123], v12 offset:30784
    v_add_f32 v37, v37, v65
    v_mfma_f32_16x16x32_bf16 v[100:103], a[108:111], a[36:39], v[100:103]
    v_exp_f32 v84, v84
    v_mfma_f32_16x16x32_bf16 v[104:107], a[108:111], a[40:43], v[104:107]
    ds_read_b64_tr_b16 a[124:125], v13 offset:24640
    v_add_f32 v37, v37, v66
    v_mfma_f32_16x16x32_bf16 v[108:111], a[108:111], a[44:47], v[108:111]
    v_exp_f32 v85, v85
    v_mfma_f32_16x16x32_bf16 v[100:103], a[112:115], a[48:51], v[100:103]
    ds_read_b64_tr_b16 a[126:127], v13 offset:30784
    v_add_f32 v37, v37, v67
    v_mfma_f32_16x16x32_bf16 v[104:107], a[112:115], a[52:55], v[104:107]
    v_exp_f32 v86, v86
    v_mfma_f32_16x16x32_bf16 v[108:111], a[112:115], a[56:59], v[108:111]
    ds_read_b64_tr_b16 a[128:129], v14 offset:24640
    v_add_f32 v37, v37, v76
    v_mfma_f32_16x16x32_bf16 v[100:103], a[116:119], a[60:63], v[100:103]
    v_exp_f32 v87, v87
    v_mfma_f32_16x16x32_bf16 v[104:107], a[116:119], a[64:67], v[104:107]
    ds_read_b64_tr_b16 a[130:131], v14 offset:30784
    v_add_f32 v37, v37, v77
    v_mfma_f32_16x16x32_bf16 v[108:111], a[116:119], a[68:71], v[108:111]
    s_waitcnt lgkmcnt(4)
    v_cvt_pk_bf16_f32 v62, v84, v85
    v_cvt_pk_bf16_f32 v63, v86, v87
    v_mfma_f32_16x16x32_bf16 v[112:115], a[120:123], v[52:55], v[112:115]
    s_add_u32 s39, s86, 40960
    ds_read_b64_tr_b16 a[132:133], v15 offset:24640
    v_add_f32 v38, v38, v68
    v_add_f32 v39, v39, v72
    v_add_f32 v38, v38, v69
    v_mfma_f32_16x16x32_bf16 v[116:119], a[120:123], v[56:59], v[116:119]
    s_add_u32 m0, s34, 36960
    ds_read_b64_tr_b16 a[134:135], v15 offset:30784
    v_add_f32 v39, v39, v73
    v_add_f32 v38, v38, v70
    v_add_f32 v39, v39, v74
    v_mfma_f32_16x16x32_bf16 v[120:123], a[120:123], v[60:63], v[120:123]
    s_waitcnt lgkmcnt(4)
    ds_read_b64_tr_b16 a[136:137], v12 offset:24768
    buffer_load_dwordx4 v33, s[60:63], s39 offen offset:0  lds
    v_add_f32 v38, v38, v71
    v_mfma_f32_16x16x32_bf16 v[132:135], a[124:127], v[60:63], v[132:135]
    ds_read_b64_tr_b16 a[138:139], v12 offset:30912
    v_add_f32 v39, v39, v75
    v_add_f32 v38, v38, v80
    v_mfma_f32_16x16x32_bf16 v[128:131], a[124:127], v[56:59], v[128:131]
    ds_read_b64_tr_b16 a[140:141], v13 offset:24768
    v_add_f32 v39, v39, v84
    v_add_f32 v38, v38, v81
    v_add_f32 v39, v39, v85
    v_mfma_f32_16x16x32_bf16 v[124:127], a[124:127], v[52:55], v[124:127]
    s_waitcnt lgkmcnt(5)
    ds_read_b64_tr_b16 a[142:143], v13 offset:30912
    v_add_f32 v37, v37, v78
    v_add_f32 v38, v38, v82
    v_add_f32 v39, v39, v86
    v_mfma_f32_16x16x32_bf16 v[136:139], a[128:131], v[52:55], v[136:139]
    ds_read_b64_tr_b16 a[144:145], v14 offset:24768
    buffer_load_dwordx4 v34, s[60:63], s39 offen offset:1024  lds
    v_add_f32 v37, v37, v79
    v_mfma_f32_16x16x32_bf16 v[140:143], a[128:131], v[56:59], v[140:143]
    ds_read_b64_tr_b16 a[146:147], v14 offset:30912
    v_add_f32 v38, v38, v83
    v_add_f32 v39, v39, v87
    v_mfma_f32_16x16x32_bf16 v[144:147], a[128:131], v[60:63], v[144:147]
    s_waitcnt lgkmcnt(6)
    ds_read_b64_tr_b16 a[148:149], v15 offset:24768
    v_exp_f32 v88, v88
    v_exp_f32 v89, v89
    v_mfma_f32_16x16x32_bf16 v[156:159], a[132:135], v[60:63], v[156:159]
    ds_read_b64_tr_b16 a[150:151], v15 offset:30912
    v_exp_f32 v90, v90
    v_mfma_f32_16x16x32_bf16 v[152:155], a[132:135], v[56:59], v[152:155]
    ds_read_b64_tr_b16 a[152:153], v12 offset:24896
    v_exp_f32 v91, v91
    v_cvt_pk_bf16_f32 v40, v88, v89
    v_mfma_f32_16x16x32_bf16 v[148:151], a[132:135], v[52:55], v[148:151]
    s_waitcnt lgkmcnt(7)
    ds_read_b64_tr_b16 a[154:155], v12 offset:31040
    buffer_load_dwordx4 v35, s[60:63], s39 offen offset:2048  lds
    v_cvt_pk_bf16_f32 v41, v90, v91
    v_mfma_f32_16x16x32_bf16 v[160:163], a[136:139], v[52:55], v[160:163]
    ds_read_b64_tr_b16 a[156:157], v13 offset:24896
    v_exp_f32 v100, v100
    v_mfma_f32_16x16x32_bf16 v[164:167], a[136:139], v[56:59], v[164:167]
    s_add_u32 s39, s87, 0
    ds_read_b64_tr_b16 a[158:159], v13 offset:31040
    v_exp_f32 v101, v101
    v_exp_f32 v102, v102
    v_mfma_f32_16x16x32_bf16 v[168:171], a[136:139], v[60:63], v[168:171]
    s_waitcnt lgkmcnt(8)
    s_add_u32 m0, s34, 135520
    ds_read_b64_tr_b16 a[160:161], v14 offset:24896
    v_exp_f32 v103, v103
    v_cvt_pk_bf16_f32 v42, v100, v101
    v_mfma_f32_16x16x32_bf16 v[180:183], a[140:143], v[60:63], v[180:183]
    ds_read_b64_tr_b16 a[162:163], v14 offset:31040
    buffer_load_dwordx4 v33, s[60:63], s39 offen offset:0  lds
    v_mfma_f32_16x16x32_bf16 v[176:179], a[140:143], v[56:59], v[176:179]
    ds_read_b64_tr_b16 a[164:165], v15 offset:24896
    v_cvt_pk_bf16_f32 v43, v102, v103
    v_exp_f32 v92, v92
    v_mfma_f32_16x16x32_bf16 v[172:175], a[140:143], v[52:55], v[172:175]
    s_waitcnt lgkmcnt(9)
    ds_read_b64_tr_b16 a[166:167], v15 offset:31040
    v_exp_f32 v93, v93
    v_mfma_f32_16x16x32_bf16 v[184:187], a[144:147], v[52:55], v[184:187]
    v_exp_f32 v94, v94
    v_exp_f32 v95, v95
    v_cvt_pk_bf16_f32 v44, v92, v93
    v_mfma_f32_16x16x32_bf16 v[188:191], a[144:147], v[56:59], v[188:191]
    v_cvt_pk_bf16_f32 v45, v94, v95
    v_exp_f32 v104, v104
    v_mfma_f32_16x16x32_bf16 v[192:195], a[144:147], v[60:63], v[192:195]
    s_waitcnt lgkmcnt(8)
    buffer_load_dwordx4 v34, s[60:63], s39 offen offset:1024  lds
    v_exp_f32 v105, v105
    v_mfma_f32_16x16x32_bf16 v[204:207], a[148:151], v[60:63], v[204:207]
    v_exp_f32 v106, v106
    v_exp_f32 v107, v107
    v_mfma_f32_16x16x32_bf16 v[200:203], a[148:151], v[56:59], v[200:203]
    v_cvt_pk_bf16_f32 v46, v104, v105
    v_cvt_pk_bf16_f32 v47, v106, v107
    v_exp_f32 v96, v96
    v_mfma_f32_16x16x32_bf16 v[196:199], a[148:151], v[52:55], v[196:199]
    s_waitcnt lgkmcnt(6)
    v_exp_f32 v97, v97
    v_exp_f32 v98, v98
    v_mfma_f32_16x16x32_bf16 v[208:211], a[152:155], v[52:55], v[208:211]
    buffer_load_dwordx4 v35, s[60:63], s39 offen offset:2048  lds
    v_exp_f32 v99, v99
    v_mfma_f32_16x16x32_bf16 v[212:215], a[152:155], v[56:59], v[212:215]
    v_cvt_pk_bf16_f32 v48, v96, v97
    v_cvt_pk_bf16_f32 v49, v98, v99
    v_exp_f32 v108, v108
    v_mfma_f32_16x16x32_bf16 v[216:219], a[152:155], v[60:63], v[216:219]
    s_waitcnt lgkmcnt(4)
    v_exp_f32 v109, v109
    v_exp_f32 v110, v110
    v_mfma_f32_16x16x32_bf16 v[228:231], a[156:159], v[60:63], v[228:231]
    v_exp_f32 v111, v111
    v_cvt_pk_bf16_f32 v50, v108, v109
    v_mfma_f32_16x16x32_bf16 v[224:227], a[156:159], v[56:59], v[224:227]
    v_cvt_pk_bf16_f32 v51, v110, v111
    v_add_f32 v37, v37, v88
    v_add_f32 v38, v38, v92
    v_add_f32 v39, v39, v96
    v_mfma_f32_16x16x32_bf16 v[220:223], a[156:159], v[52:55], v[220:223]
    s_waitcnt lgkmcnt(2)
    s_waitcnt vmcnt(21) lgkmcnt(0)
    s_barrier
    v_add_f32 v37, v37, v89
    v_add_f32 v38, v38, v93
    v_add_f32 v39, v39, v97
    v_add_f32 v37, v37, v90
    v_mfma_f32_16x16x32_bf16 v[232:235], a[160:163], v[52:55], v[232:235]
    ds_read_b64_tr_b16 a[120:121], v16 offset:0
    v_add_f32 v38, v38, v94
    v_add_f32 v39, v39, v98
    v_add_f32 v37, v37, v91
    v_mfma_f32_16x16x32_bf16 v[236:239], a[160:163], v[56:59], v[236:239]
    ds_read_b64_tr_b16 a[122:123], v16 offset:6144
    v_add_f32 v38, v38, v95
    v_add_f32 v39, v39, v99
    v_add_f32 v37, v37, v100
    v_mfma_f32_16x16x32_bf16 v[240:243], a[160:163], v[60:63], v[240:243]
    ds_read_b64_tr_b16 a[124:125], v17 offset:0
    v_add_f32 v38, v38, v104
    v_add_f32 v39, v39, v108
    v_add_f32 v37, v37, v101
    v_mfma_f32_16x16x32_bf16 v[252:255], a[164:167], v[60:63], v[252:255]
    ds_read_b64_tr_b16 a[126:127], v17 offset:6144
    v_add_f32 v38, v38, v105
    v_add_f32 v39, v39, v109
    v_mfma_f32_16x16x32_bf16 v[248:251], a[164:167], v[56:59], v[248:251]
    ds_read_b64_tr_b16 a[128:129], v18 offset:0
    v_add_f32 v37, v37, v102
    v_add_f32 v38, v38, v106
    v_add_f32 v39, v39, v110
    v_mfma_f32_16x16x32_bf16 v[244:247], a[164:167], v[52:55], v[244:247]
    ds_read_b64_tr_b16 a[130:131], v18 offset:6144
    v_add_f32 v37, v37, v103
    v_add_f32 v38, v38, v107
    v_add_f32 v39, v39, v111
    v_lshlrev_b32 v0, 4, v1
    v_mov_b32 v29, v37
    v_mov_b32 v30, v38
    v_mov_b32 v31, v39
    v_permlane32_swap_b32 v29, v37
    v_permlane32_swap_b32 v30, v38
    v_permlane32_swap_b32 v31, v39
    v_add_f32 v37, v37, v29
    v_add_f32 v38, v38, v30
    v_add_f32 v39, v39, v31
    v_mov_b32 v29, v37
    v_mov_b32 v30, v38
    v_mov_b32 v31, v39
    v_permlane16_swap_b32 v29, v37
    v_permlane16_swap_b32 v30, v38
    v_permlane16_swap_b32 v31, v39
    v_add_f32 v37, v37, v29
    v_add_f32 v38, v38, v30
    v_add_f32 v39, v39, v31
    v_add_f32 v30, v37, v38
    v_add_f32 v30, v30, v39
    s_mov_b32 s29, 0x53800000
    v_cmp_nlt_f32 vcc, v30, s29
    v_rcp_f32 v37, v37
    v_rcp_f32 v38, v38
    v_rcp_f32 v39, v39
    s_cmp_lg_u64 vcc, 0
    s_cselect_b32 s29, 1, 0
    s_lshl_b32 s30, s24, 2
    s_add_u32 s30, s30, 160160
    v_mov_b32 v29, s29
    v_mov_b32 v30, s30
    s_waitcnt lgkmcnt(4)
    v_mfma_f32_16x16x32_bf16 v[112:115], a[120:123], v[40:43], v[112:115]
    ds_write_b32 v30, v29
    v_mfma_f32_16x16x32_bf16 v[116:119], a[120:123], v[44:47], v[116:119]
    ds_read_b64_tr_b16 a[132:133], v19 offset:0
    v_mfma_f32_16x16x32_bf16 v[120:123], a[120:123], v[48:51], v[120:123]
    s_waitcnt lgkmcnt(4)
    ds_read_b64_tr_b16 a[134:135], v19 offset:6144
    v_mov_b32 v31, 160160
    v_mfma_f32_16x16x32_bf16 v[132:135], a[124:127], v[48:51], v[132:135]
    ds_read_b64_tr_b16 a[136:137], v16 offset:128
    v_mfma_f32_16x16x32_bf16 v[128:131], a[124:127], v[44:47], v[128:131]
    ds_read_b64_tr_b16 a[138:139], v16 offset:6272
    v_mfma_f32_16x16x32_bf16 v[124:127], a[124:127], v[40:43], v[124:127]
    s_waitcnt lgkmcnt(5)
    ds_read_b64_tr_b16 a[140:141], v17 offset:128
    v_mfma_f32_16x16x32_bf16 v[136:139], a[128:131], v[40:43], v[136:139]
    ds_read_b64_tr_b16 a[142:143], v17 offset:6272
    v_mfma_f32_16x16x32_bf16 v[140:143], a[128:131], v[44:47], v[140:143]
    ds_read_b64_tr_b16 a[144:145], v18 offset:128
    v_mfma_f32_16x16x32_bf16 v[144:147], a[128:131], v[48:51], v[144:147]
    s_waitcnt lgkmcnt(5)
    ds_read_b64_tr_b16 a[146:147], v18 offset:6272
    v_mul_f32 v112, v112, v37
    v_mul_f32 v113, v113, v37
    v_mul_f32 v114, v114, v37
    v_mul_f32 v115, v115, v37
    v_mul_f32 v124, v124, v37
    v_mul_f32 v125, v125, v37
    v_mfma_f32_16x16x32_bf16 v[156:159], a[132:135], v[48:51], v[156:159]
    ds_read_b64_tr_b16 a[148:149], v19 offset:128
    v_mul_f32 v126, v126, v37
    v_mul_f32 v127, v127, v37
    v_cvt_pk_bf16_f32 v52, v112, v113
    v_cvt_pk_bf16_f32 v53, v114, v115
    v_cvt_pk_bf16_f32 v54, v124, v125
    v_cvt_pk_bf16_f32 v55, v126, v127
    s_mov_b32 s38, 0
    buffer_store_dwordx4 v[52:55], v0, s[20:23], s38 offen offset:0 sc1
    v_mfma_f32_16x16x32_bf16 v[152:155], a[132:135], v[44:47], v[152:155]
    ds_read_b64_tr_b16 a[150:151], v19 offset:6272
    v_mul_f32 v116, v116, v38
    v_mul_f32 v117, v117, v38
    v_mul_f32 v118, v118, v38
    v_mul_f32 v119, v119, v38
    v_mul_f32 v128, v128, v38
    v_mul_f32 v129, v129, v38
    v_mfma_f32_16x16x32_bf16 v[148:151], a[132:135], v[40:43], v[148:151]
    s_waitcnt lgkmcnt(6)
    ds_read_b64_tr_b16 a[152:153], v16 offset:256
    v_mul_f32 v130, v130, v38
    v_mul_f32 v131, v131, v38
    v_cvt_pk_bf16_f32 v56, v116, v117
    v_cvt_pk_bf16_f32 v57, v118, v119
    v_cvt_pk_bf16_f32 v58, v128, v129
    v_cvt_pk_bf16_f32 v59, v130, v131
    buffer_store_dwordx4 v[56:59], v0, s[20:23], s38 offen offset:1024 sc1
    v_mfma_f32_16x16x32_bf16 v[160:163], a[136:139], v[40:43], v[160:163]
    ds_read_b64_tr_b16 a[154:155], v16 offset:6400
    v_mul_f32 v120, v120, v39
    v_mul_f32 v121, v121, v39
    v_mul_f32 v122, v122, v39
    v_mul_f32 v123, v123, v39
    v_mul_f32 v132, v132, v39
    v_mul_f32 v133, v133, v39
    v_mfma_f32_16x16x32_bf16 v[164:167], a[136:139], v[44:47], v[164:167]
    ds_read_b64_tr_b16 a[156:157], v17 offset:256
    v_mul_f32 v134, v134, v39
    v_mul_f32 v135, v135, v39
    v_cvt_pk_bf16_f32 v60, v120, v121
    v_cvt_pk_bf16_f32 v61, v122, v123
    v_cvt_pk_bf16_f32 v62, v132, v133
    v_cvt_pk_bf16_f32 v63, v134, v135
    buffer_store_dwordx4 v[60:63], v0, s[20:23], s38 offen offset:2048 sc1
    v_mfma_f32_16x16x32_bf16 v[168:171], a[136:139], v[48:51], v[168:171]
    s_waitcnt lgkmcnt(7)
    ds_read_b64_tr_b16 a[158:159], v17 offset:6400
    v_mul_f32 v136, v136, v37
    v_mul_f32 v137, v137, v37
    v_mfma_f32_16x16x32_bf16 v[180:183], a[140:143], v[48:51], v[180:183]
    ds_read_b64_tr_b16 a[160:161], v18 offset:256
    v_mul_f32 v138, v138, v37
    v_mul_f32 v139, v139, v37
    v_mfma_f32_16x16x32_bf16 v[176:179], a[140:143], v[44:47], v[176:179]
    ds_read_b64_tr_b16 a[162:163], v18 offset:6400
    v_mul_f32 v148, v148, v37
    v_mfma_f32_16x16x32_bf16 v[172:175], a[140:143], v[40:43], v[172:175]
    s_waitcnt lgkmcnt(8)
    ds_read_b64_tr_b16 a[164:165], v19 offset:256
    v_mul_f32 v149, v149, v37
    v_mul_f32 v150, v150, v37
    v_mfma_f32_16x16x32_bf16 v[184:187], a[144:147], v[40:43], v[184:187]
    ds_read_b64_tr_b16 a[166:167], v19 offset:6400
    v_mul_f32 v151, v151, v37
    v_cvt_pk_bf16_f32 v64, v136, v137
    v_mfma_f32_16x16x32_bf16 v[188:191], a[144:147], v[44:47], v[188:191]
    v_cvt_pk_bf16_f32 v65, v138, v139
    v_mfma_f32_16x16x32_bf16 v[192:195], a[144:147], v[48:51], v[192:195]
    s_waitcnt lgkmcnt(8)
    v_cvt_pk_bf16_f32 v66, v148, v149
    v_cvt_pk_bf16_f32 v67, v150, v151
    s_mov_b32 s38, 3072
    buffer_store_dwordx4 v[64:67], v0, s[20:23], s38 offen offset:0 sc1
    v_mfma_f32_16x16x32_bf16 v[204:207], a[148:151], v[48:51], v[204:207]
    v_mul_f32 v140, v140, v38
    v_mul_f32 v141, v141, v38
    v_mfma_f32_16x16x32_bf16 v[200:203], a[148:151], v[44:47], v[200:203]
    v_mul_f32 v142, v142, v38
    v_mfma_f32_16x16x32_bf16 v[196:199], a[148:151], v[40:43], v[196:199]
    s_waitcnt lgkmcnt(6)
    v_mul_f32 v143, v143, v38
    v_mul_f32 v152, v152, v38
    v_mfma_f32_16x16x32_bf16 v[208:211], a[152:155], v[40:43], v[208:211]
    v_mul_f32 v153, v153, v38
    v_mfma_f32_16x16x32_bf16 v[212:215], a[152:155], v[44:47], v[212:215]
    v_mul_f32 v154, v154, v38
    v_mul_f32 v155, v155, v38
    v_mfma_f32_16x16x32_bf16 v[216:219], a[152:155], v[48:51], v[216:219]
    s_waitcnt lgkmcnt(4)
    v_cvt_pk_bf16_f32 v68, v140, v141
    v_cvt_pk_bf16_f32 v69, v142, v143
    v_mfma_f32_16x16x32_bf16 v[228:231], a[156:159], v[48:51], v[228:231]
    v_cvt_pk_bf16_f32 v70, v152, v153
    v_mfma_f32_16x16x32_bf16 v[224:227], a[156:159], v[44:47], v[224:227]
    v_cvt_pk_bf16_f32 v71, v154, v155
    buffer_store_dwordx4 v[68:71], v0, s[20:23], s38 offen offset:1024 sc1
    v_mul_f32 v144, v144, v39
    v_mfma_f32_16x16x32_bf16 v[220:223], a[156:159], v[40:43], v[220:223]
    s_waitcnt lgkmcnt(2)
    v_mul_f32 v145, v145, v39
    v_mul_f32 v146, v146, v39
    v_mfma_f32_16x16x32_bf16 v[232:235], a[160:163], v[40:43], v[232:235]
    v_mul_f32 v147, v147, v39
    v_mfma_f32_16x16x32_bf16 v[236:239], a[160:163], v[44:47], v[236:239]
    v_mul_f32 v156, v156, v39
    v_mul_f32 v157, v157, v39
    v_mfma_f32_16x16x32_bf16 v[240:243], a[160:163], v[48:51], v[240:243]
    s_waitcnt lgkmcnt(0)
    v_mul_f32 v158, v158, v39
    v_mul_f32 v159, v159, v39
    v_mfma_f32_16x16x32_bf16 v[252:255], a[164:167], v[48:51], v[252:255]
    v_cvt_pk_bf16_f32 v72, v144, v145
    v_mfma_f32_16x16x32_bf16 v[248:251], a[164:167], v[44:47], v[248:251]
    v_cvt_pk_bf16_f32 v73, v146, v147
    v_cvt_pk_bf16_f32 v74, v156, v157
    v_mfma_f32_16x16x32_bf16 v[244:247], a[164:167], v[40:43], v[244:247]
    v_cvt_pk_bf16_f32 v75, v158, v159
    buffer_store_dwordx4 v[72:75], v0, s[20:23], s38 offen offset:2048 sc1
    s_barrier
    ds_read_b128 v[8:11], v31
    v_mov_b32 v30, v37
    v_mov_b32 v31, v37
    v_mov_b32 v4, v38
    v_mov_b32 v5, v38
    v_mov_b32 v38, v39
    v_pk_mul_f32 v[160:161], v[160:161], v[30:31]
    v_pk_mul_f32 v[162:163], v[162:163], v[30:31]
    v_pk_mul_f32 v[172:173], v[172:173], v[30:31]
    v_pk_mul_f32 v[174:175], v[174:175], v[30:31]
    v_pk_mul_f32 v[164:165], v[164:165], v[4:5]
    v_pk_mul_f32 v[166:167], v[166:167], v[4:5]
    v_pk_mul_f32 v[176:177], v[176:177], v[4:5]
    v_pk_mul_f32 v[178:179], v[178:179], v[4:5]
    v_pk_mul_f32 v[168:169], v[168:169], v[38:39]
    v_pk_mul_f32 v[170:171], v[170:171], v[38:39]
    v_pk_mul_f32 v[180:181], v[180:181], v[38:39]
    v_pk_mul_f32 v[182:183], v[182:183], v[38:39]
    v_cvt_pk_bf16_f32 v76, v160, v161
    v_cvt_pk_bf16_f32 v77, v162, v163
    v_cvt_pk_bf16_f32 v78, v172, v173
    v_cvt_pk_bf16_f32 v79, v174, v175
    v_cvt_pk_bf16_f32 v80, v164, v165
    v_cvt_pk_bf16_f32 v81, v166, v167
    v_cvt_pk_bf16_f32 v82, v176, v177
    v_cvt_pk_bf16_f32 v83, v178, v179
    v_cvt_pk_bf16_f32 v84, v168, v169
    v_cvt_pk_bf16_f32 v85, v170, v171
    v_cvt_pk_bf16_f32 v86, v180, v181
    v_cvt_pk_bf16_f32 v87, v182, v183
    s_waitcnt lgkmcnt(0)
    v_or3_b32 v8, v8, v9, v10
    v_or_b32 v8, v8, v11
    s_nop 0
    v_readfirstlane_b32 s29, v8
    s_nop 0
    s_cmp_gt_u32 s29, s35
    s_cbranch_scc1 L_FALLBACK
    v_pk_mul_f32 v[184:185], v[184:185], v[30:31]
    v_pk_mul_f32 v[186:187], v[186:187], v[30:31]
    v_pk_mul_f32 v[196:197], v[196:197], v[30:31]
    v_pk_mul_f32 v[198:199], v[198:199], v[30:31]
    v_pk_mul_f32 v[188:189], v[188:189], v[4:5]
    v_pk_mul_f32 v[190:191], v[190:191], v[4:5]
    v_pk_mul_f32 v[200:201], v[200:201], v[4:5]
    v_pk_mul_f32 v[202:203], v[202:203], v[4:5]
    v_pk_mul_f32 v[192:193], v[192:193], v[38:39]
    v_pk_mul_f32 v[194:195], v[194:195], v[38:39]
    v_pk_mul_f32 v[204:205], v[204:205], v[38:39]
    v_pk_mul_f32 v[206:207], v[206:207], v[38:39]
    v_cvt_pk_bf16_f32 v88, v184, v185
    v_cvt_pk_bf16_f32 v89, v186, v187
    v_cvt_pk_bf16_f32 v90, v196, v197
    v_cvt_pk_bf16_f32 v91, v198, v199
    v_cvt_pk_bf16_f32 v92, v188, v189
    v_cvt_pk_bf16_f32 v93, v190, v191
    v_cvt_pk_bf16_f32 v94, v200, v201
    v_cvt_pk_bf16_f32 v95, v202, v203
    v_cvt_pk_bf16_f32 v96, v192, v193
    v_cvt_pk_bf16_f32 v97, v194, v195
    v_cvt_pk_bf16_f32 v98, v204, v205
    v_cvt_pk_bf16_f32 v99, v206, v207
    v_pk_mul_f32 v[208:209], v[208:209], v[30:31]
    v_pk_mul_f32 v[210:211], v[210:211], v[30:31]
    v_pk_mul_f32 v[220:221], v[220:221], v[30:31]
    v_pk_mul_f32 v[222:223], v[222:223], v[30:31]
    v_pk_mul_f32 v[212:213], v[212:213], v[4:5]
    v_pk_mul_f32 v[214:215], v[214:215], v[4:5]
    v_pk_mul_f32 v[224:225], v[224:225], v[4:5]
    v_pk_mul_f32 v[226:227], v[226:227], v[4:5]
    v_pk_mul_f32 v[216:217], v[216:217], v[38:39]
    v_pk_mul_f32 v[218:219], v[218:219], v[38:39]
    v_pk_mul_f32 v[228:229], v[228:229], v[38:39]
    v_pk_mul_f32 v[230:231], v[230:231], v[38:39]
    v_cvt_pk_bf16_f32 v100, v208, v209
    v_cvt_pk_bf16_f32 v101, v210, v211
    v_cvt_pk_bf16_f32 v102, v220, v221
    v_cvt_pk_bf16_f32 v103, v222, v223
    v_cvt_pk_bf16_f32 v104, v212, v213
    v_cvt_pk_bf16_f32 v105, v214, v215
    v_cvt_pk_bf16_f32 v106, v224, v225
    v_cvt_pk_bf16_f32 v107, v226, v227
    v_cvt_pk_bf16_f32 v108, v216, v217
    v_cvt_pk_bf16_f32 v109, v218, v219
    v_cvt_pk_bf16_f32 v110, v228, v229
    v_cvt_pk_bf16_f32 v111, v230, v231
    v_pk_mul_f32 v[232:233], v[232:233], v[30:31]
    v_pk_mul_f32 v[234:235], v[234:235], v[30:31]
    v_pk_mul_f32 v[244:245], v[244:245], v[30:31]
    v_pk_mul_f32 v[246:247], v[246:247], v[30:31]
    v_pk_mul_f32 v[236:237], v[236:237], v[4:5]
    v_pk_mul_f32 v[238:239], v[238:239], v[4:5]
    v_pk_mul_f32 v[248:249], v[248:249], v[4:5]
    v_pk_mul_f32 v[250:251], v[250:251], v[4:5]
    v_pk_mul_f32 v[240:241], v[240:241], v[38:39]
    v_pk_mul_f32 v[242:243], v[242:243], v[38:39]
    v_pk_mul_f32 v[252:253], v[252:253], v[38:39]
    v_pk_mul_f32 v[254:255], v[254:255], v[38:39]
    v_cvt_pk_bf16_f32 v40, v232, v233
    v_cvt_pk_bf16_f32 v41, v234, v235
    v_cvt_pk_bf16_f32 v42, v244, v245
    v_cvt_pk_bf16_f32 v43, v246, v247
    v_cvt_pk_bf16_f32 v44, v236, v237
    v_cvt_pk_bf16_f32 v45, v238, v239
    v_cvt_pk_bf16_f32 v46, v248, v249
    v_cvt_pk_bf16_f32 v47, v250, v251
    v_cvt_pk_bf16_f32 v48, v240, v241
    v_cvt_pk_bf16_f32 v49, v242, v243
    v_cvt_pk_bf16_f32 v50, v252, v253
    v_cvt_pk_bf16_f32 v51, v254, v255
    s_and_b32 s29, s27, 1
    s_cmp_eq_u32 s29, 1
    s_cselect_b64 vcc, -1, 0
    v_add_u32 v128, 0, v18
    v_cndmask_b32 v128, v16, v128, vcc
    v_subrev_u32 v112, 86240, v128
    v_add_u32 v116, 61600, v112
    v_add_u32 v120, 123200, v112
    v_add_u32 v128, 0, v19
    v_cndmask_b32 v128, v17, v128, vcc
    v_subrev_u32 v113, 86240, v128
    v_add_u32 v117, 61600, v113
    v_add_u32 v121, 123200, v113
    v_add_u32 v128, 128, v16
    v_cndmask_b32 v128, v18, v128, vcc
    v_subrev_u32 v114, 86240, v128
    v_add_u32 v118, 61600, v114
    v_add_u32 v122, 123200, v114
    v_add_u32 v128, 128, v17
    v_cndmask_b32 v128, v19, v128, vcc
    v_subrev_u32 v115, 86240, v128
    v_add_u32 v119, 61600, v115
    v_add_u32 v123, 123200, v115
    ds_read_b64_tr_b16 a[216:217], v116 offset:12320
    ds_read_b64_tr_b16 a[218:219], v116 offset:18464
    ds_read_b64_tr_b16 a[220:221], v117 offset:12320
    ds_read_b64_tr_b16 a[222:223], v117 offset:18464
    ds_read_b64_tr_b16 a[224:225], v118 offset:12320
    ds_read_b64_tr_b16 a[226:227], v118 offset:18464
    v_min_u32 v125, 2, v1
    s_add_u32 s29, s27, 1
    v_add_u32 v125, s29, v125
    v_and_b32 v125, 3, v125
    s_and_b32 s29, s2, 0xe7
    s_lshl_b32 s29, s29, 2
    s_add_u32 s29, s29, s24
    s_lshl_b32 s29, s29, 7
    v_lshl_add_u32 v125, v125, 12, s29
    v_mov_b32 v129, 1
    v_readfirstlane_b32 s29, v36
    s_nop 0
    s_cmp_ge_u32 s29, 32
    s_cbranch_scc0 L_INIT_SPIN
L_INIT_OK:
    s_waitcnt lgkmcnt(4)
    v_mfma_f32_16x16x32_bf16 v[136:139], a[216:219], v[52:55], 0
    s_add_u32 s39, s87, 40960
    s_add_u32 m0, s34, 147840
    ds_read_b64_tr_b16 a[228:229], v119 offset:12320
    ds_read_b64_tr_b16 a[230:231], v119 offset:18464
    v_mfma_f32_16x16x32_bf16 v[140:143], a[216:219], v[56:59], 0
    buffer_load_dwordx4 v33, s[60:63], s39 offen offset:0  lds
    v_mfma_f32_16x16x32_bf16 v[144:147], a[216:219], v[60:63], 0
    s_waitcnt lgkmcnt(4)
    ds_read_b64_tr_b16 a[232:233], v116 offset:12448
    ds_read_b64_tr_b16 a[234:235], v116 offset:18592
    v_mfma_f32_16x16x32_bf16 v[156:159], a[220:223], v[60:63], 0
    buffer_load_dwordx4 v34, s[60:63], s39 offen offset:1024  lds
    v_mfma_f32_16x16x32_bf16 v[152:155], a[220:223], v[56:59], 0
    ds_read_b64_tr_b16 a[236:237], v117 offset:12448
    ds_read_b64_tr_b16 a[238:239], v117 offset:18592
    v_mfma_f32_16x16x32_bf16 v[148:151], a[220:223], v[52:55], 0
    s_waitcnt lgkmcnt(6)
    v_mfma_f32_16x16x32_bf16 v[160:163], a[224:227], v[52:55], 0
    ds_read_b64_tr_b16 a[240:241], v118 offset:12448
    ds_read_b64_tr_b16 a[242:243], v118 offset:18592
    v_mfma_f32_16x16x32_bf16 v[164:167], a[224:227], v[56:59], 0
    buffer_load_dwordx4 v35, s[60:63], s39 offen offset:2048  lds
    v_mfma_f32_16x16x32_bf16 v[168:171], a[224:227], v[60:63], 0
    s_waitcnt lgkmcnt(6)
    ds_read_b64_tr_b16 a[244:245], v119 offset:12448
    ds_read_b64_tr_b16 a[246:247], v119 offset:18592
    v_mfma_f32_16x16x32_bf16 v[180:183], a[228:231], v[60:63], 0
    s_add_u32 s39, s85, 81920
    v_mfma_f32_16x16x32_bf16 v[176:179], a[228:231], v[56:59], 0
    s_add_u32 m0, s34, 86240
    ds_read_b64_tr_b16 a[248:249], v116 offset:12576
    ds_read_b64_tr_b16 a[250:251], v116 offset:18720
    v_mfma_f32_16x16x32_bf16 v[172:175], a[228:231], v[52:55], 0
    s_waitcnt lgkmcnt(8)
    buffer_load_dwordx4 v33, s[60:63], s39 offen offset:0  lds
    v_mfma_f32_16x16x32_bf16 v[184:187], a[232:235], v[52:55], 0
    ds_read_b64_tr_b16 a[252:253], v117 offset:12576
    s_waitcnt vmcnt(16)
    ds_read_b64_tr_b16 a[254:255], v117 offset:18720
    v_mfma_f32_16x16x32_bf16 v[188:191], a[232:235], v[56:59], 0
    v_mfma_f32_16x16x32_bf16 v[192:195], a[232:235], v[60:63], 0
    s_waitcnt lgkmcnt(8)
    buffer_load_dwordx4 v34, s[60:63], s39 offen offset:1024  lds
    v_mfma_f32_16x16x32_bf16 v[204:207], a[236:239], v[60:63], 0
    v_mfma_f32_16x16x32_bf16 v[200:203], a[236:239], v[56:59], 0
    buffer_load_dwordx4 v35, s[60:63], s39 offen offset:2048  lds
    v_mfma_f32_16x16x32_bf16 v[196:199], a[236:239], v[52:55], 0
    s_waitcnt lgkmcnt(6)
    v_mfma_f32_16x16x32_bf16 v[208:211], a[240:243], v[52:55], 0
    v_mfma_f32_16x16x32_bf16 v[212:215], a[240:243], v[56:59], 0
    s_waitcnt lgkmcnt(0)
    s_barrier
    s_add_u32 s39, s85, 122880
    v_mfma_f32_16x16x32_bf16 v[216:219], a[240:243], v[60:63], 0
    s_add_u32 m0, s34, 73920
    ds_read_b64_tr_b16 a[216:217], v112 offset:49280
    ds_read_b64_tr_b16 a[218:219], v112 offset:55424
    v_mfma_f32_16x16x32_bf16 v[228:231], a[244:247], v[60:63], 0
    buffer_load_dwordx4 v33, s[60:63], s39 offen offset:0  lds
    v_mfma_f32_16x16x32_bf16 v[224:227], a[244:247], v[56:59], 0
    ds_read_b64_tr_b16 a[220:221], v113 offset:49280
    ds_read_b64_tr_b16 a[222:223], v113 offset:55424
    v_mfma_f32_16x16x32_bf16 v[220:223], a[244:247], v[52:55], 0
    v_mfma_f32_16x16x32_bf16 v[232:235], a[248:251], v[52:55], 0
    ds_read_b64_tr_b16 a[224:225], v114 offset:49280
    ds_read_b64_tr_b16 a[226:227], v114 offset:55424
    v_mfma_f32_16x16x32_bf16 v[236:239], a[248:251], v[56:59], 0
    buffer_load_dwordx4 v34, s[60:63], s39 offen offset:1024  lds
    v_mfma_f32_16x16x32_bf16 v[240:243], a[248:251], v[60:63], 0
    ds_read_b64_tr_b16 a[228:229], v115 offset:49280
    ds_read_b64_tr_b16 a[230:231], v115 offset:55424
    v_mfma_f32_16x16x32_bf16 v[252:255], a[252:255], v[60:63], 0
    v_mfma_f32_16x16x32_bf16 v[248:251], a[252:255], v[56:59], 0
    ds_read_b64_tr_b16 a[232:233], v112 offset:49408
    ds_read_b64_tr_b16 a[234:235], v112 offset:55552
    v_mfma_f32_16x16x32_bf16 v[244:247], a[252:255], v[52:55], 0
    s_waitcnt lgkmcnt(8)
    v_mfma_f32_16x16x32_bf16 v[136:139], a[216:219], v[64:67], v[136:139]
    ds_read_b64_tr_b16 a[236:237], v113 offset:49408
    ds_read_b64_tr_b16 a[238:239], v113 offset:55552
    v_mfma_f32_16x16x32_bf16 v[140:143], a[216:219], v[68:71], v[140:143]
    buffer_load_dwordx4 v35, s[60:63], s39 offen offset:2048  lds
    v_mfma_f32_16x16x32_bf16 v[144:147], a[216:219], v[72:75], v[144:147]
    s_waitcnt lgkmcnt(8)
    ds_read_b64_tr_b16 a[240:241], v114 offset:49408
    ds_read_b64_tr_b16 a[242:243], v114 offset:55552
    v_mfma_f32_16x16x32_bf16 v[156:159], a[220:223], v[72:75], v[156:159]
    v_mfma_f32_16x16x32_bf16 v[152:155], a[220:223], v[68:71], v[152:155]
    ds_read_b64_tr_b16 a[244:245], v115 offset:49408
    ds_read_b64_tr_b16 a[246:247], v115 offset:55552
    v_mfma_f32_16x16x32_bf16 v[148:151], a[220:223], v[64:67], v[148:151]
    s_waitcnt lgkmcnt(10)
    v_mfma_f32_16x16x32_bf16 v[160:163], a[224:227], v[64:67], v[160:163]
    ds_read_b64_tr_b16 a[248:249], v112 offset:49536
    ds_read_b64_tr_b16 a[250:251], v112 offset:55680
    v_mfma_f32_16x16x32_bf16 v[164:167], a[224:227], v[68:71], v[164:167]
    v_mfma_f32_16x16x32_bf16 v[168:171], a[224:227], v[72:75], v[168:171]
    s_waitcnt lgkmcnt(10)
    ds_read_b64_tr_b16 a[252:253], v113 offset:49536
    ds_read_b64_tr_b16 a[254:255], v113 offset:55680
    v_mfma_f32_16x16x32_bf16 v[180:183], a[228:231], v[72:75], v[180:183]
    v_mfma_f32_16x16x32_bf16 v[176:179], a[228:231], v[68:71], v[176:179]
    v_mfma_f32_16x16x32_bf16 v[172:175], a[228:231], v[64:67], v[172:175]
    s_waitcnt lgkmcnt(10)
    v_mfma_f32_16x16x32_bf16 v[184:187], a[232:235], v[64:67], v[184:187]
    v_mfma_f32_16x16x32_bf16 v[188:191], a[232:235], v[68:71], v[188:191]
    v_mfma_f32_16x16x32_bf16 v[192:195], a[232:235], v[72:75], v[192:195]
    s_waitcnt lgkmcnt(8)
    v_mfma_f32_16x16x32_bf16 v[204:207], a[236:239], v[72:75], v[204:207]
    v_mfma_f32_16x16x32_bf16 v[200:203], a[236:239], v[68:71], v[200:203]
    v_mfma_f32_16x16x32_bf16 v[196:199], a[236:239], v[64:67], v[196:199]
    s_waitcnt lgkmcnt(6)
    v_mfma_f32_16x16x32_bf16 v[208:211], a[240:243], v[64:67], v[208:211]
    v_mfma_f32_16x16x32_bf16 v[212:215], a[240:243], v[68:71], v[212:215]
    s_waitcnt lgkmcnt(0)
    s_barrier
    s_add_u32 s39, s86, 81920
    v_mfma_f32_16x16x32_bf16 v[216:219], a[240:243], v[72:75], v[216:219]
    s_add_u32 m0, s34, 49280
    ds_read_b64_tr_b16 a[216:217], v116 offset:0
    ds_read_b64_tr_b16 a[218:219], v116 offset:6144
    v_mfma_f32_16x16x32_bf16 v[228:231], a[244:247], v[72:75], v[228:231]
    buffer_load_dwordx4 v33, s[60:63], s39 offen offset:0  lds
    v_mfma_f32_16x16x32_bf16 v[224:227], a[244:247], v[68:71], v[224:227]
    ds_read_b64_tr_b16 a[220:221], v117 offset:0
    ds_read_b64_tr_b16 a[222:223], v117 offset:6144
    v_mfma_f32_16x16x32_bf16 v[220:223], a[244:247], v[64:67], v[220:223]
    v_mfma_f32_16x16x32_bf16 v[232:235], a[248:251], v[64:67], v[232:235]
    ds_read_b64_tr_b16 a[224:225], v118 offset:0
    ds_read_b64_tr_b16 a[226:227], v118 offset:6144
    v_mfma_f32_16x16x32_bf16 v[236:239], a[248:251], v[68:71], v[236:239]
    buffer_load_dwordx4 v34, s[60:63], s39 offen offset:1024  lds
    v_mfma_f32_16x16x32_bf16 v[240:243], a[248:251], v[72:75], v[240:243]
    ds_read_b64_tr_b16 a[228:229], v119 offset:0
    ds_read_b64_tr_b16 a[230:231], v119 offset:6144
    v_mfma_f32_16x16x32_bf16 v[252:255], a[252:255], v[72:75], v[252:255]
    v_mfma_f32_16x16x32_bf16 v[248:251], a[252:255], v[68:71], v[248:251]
    ds_read_b64_tr_b16 a[232:233], v116 offset:128
    ds_read_b64_tr_b16 a[234:235], v116 offset:6272
    v_mfma_f32_16x16x32_bf16 v[244:247], a[252:255], v[64:67], v[244:247]
    s_waitcnt lgkmcnt(8)
    v_mfma_f32_16x16x32_bf16 v[136:139], a[216:219], v[76:79], v[136:139]
    ds_read_b64_tr_b16 a[236:237], v117 offset:128
    ds_read_b64_tr_b16 a[238:239], v117 offset:6272
    v_mfma_f32_16x16x32_bf16 v[140:143], a[216:219], v[80:83], v[140:143]
    s_waitcnt vmcnt(11)
    s_mov_b64 exec, 1
    buffer_store_dword v129, v7, s[80:83], 0 offen offset:0 sc1
    s_mov_b64 exec, -1
    v_mfma_f32_16x16x32_bf16 v[144:147], a[216:219], v[84:87], v[144:147]
    s_waitcnt lgkmcnt(8)
    ds_read_b64_tr_b16 a[240:241], v118 offset:128
    ds_read_b64_tr_b16 a[242:243], v118 offset:6272
    v_mfma_f32_16x16x32_bf16 v[156:159], a[220:223], v[84:87], v[156:159]
    v_mfma_f32_16x16x32_bf16 v[152:155], a[220:223], v[80:83], v[152:155]
    ds_read_b64_tr_b16 a[244:245], v119 offset:128
    ds_read_b64_tr_b16 a[246:247], v119 offset:6272
    v_mfma_f32_16x16x32_bf16 v[148:151], a[220:223], v[76:79], v[148:151]
    s_waitcnt lgkmcnt(10)
    v_mfma_f32_16x16x32_bf16 v[160:163], a[224:227], v[76:79], v[160:163]
    ds_read_b64_tr_b16 a[248:249], v116 offset:256
    ds_read_b64_tr_b16 a[250:251], v116 offset:6400
    v_mfma_f32_16x16x32_bf16 v[164:167], a[224:227], v[80:83], v[164:167]
    v_mfma_f32_16x16x32_bf16 v[168:171], a[224:227], v[84:87], v[168:171]
    s_waitcnt lgkmcnt(10)
    ds_read_b64_tr_b16 a[252:253], v117 offset:256
    ds_read_b64_tr_b16 a[254:255], v117 offset:6400
    v_mfma_f32_16x16x32_bf16 v[180:183], a[228:231], v[84:87], v[180:183]
    v_mfma_f32_16x16x32_bf16 v[176:179], a[228:231], v[80:83], v[176:179]
    v_mfma_f32_16x16x32_bf16 v[172:175], a[228:231], v[76:79], v[172:175]
    s_waitcnt lgkmcnt(10)
    buffer_load_dwordx4 v35, s[60:63], s39 offen offset:2048  lds
    v_mfma_f32_16x16x32_bf16 v[184:187], a[232:235], v[76:79], v[184:187]
    v_mfma_f32_16x16x32_bf16 v[188:191], a[232:235], v[80:83], v[188:191]
    v_mfma_f32_16x16x32_bf16 v[192:195], a[232:235], v[84:87], v[192:195]
    s_waitcnt lgkmcnt(8)
    v_mfma_f32_16x16x32_bf16 v[204:207], a[236:239], v[84:87], v[204:207]
    v_mfma_f32_16x16x32_bf16 v[200:203], a[236:239], v[80:83], v[200:203]
    v_mfma_f32_16x16x32_bf16 v[196:199], a[236:239], v[76:79], v[196:199]
    s_waitcnt lgkmcnt(6)
    v_mfma_f32_16x16x32_bf16 v[208:211], a[240:243], v[76:79], v[208:211]
    v_mfma_f32_16x16x32_bf16 v[212:215], a[240:243], v[80:83], v[212:215]
    s_waitcnt lgkmcnt(0)
    s_barrier
    s_add_u32 s39, s86, 122880
    v_mfma_f32_16x16x32_bf16 v[216:219], a[240:243], v[84:87], v[216:219]
    s_add_u32 m0, s34, 61600
    ds_read_b64_tr_b16 a[216:217], v112 offset:0
    ds_read_b64_tr_b16 a[218:219], v112 offset:6144
    v_mfma_f32_16x16x32_bf16 v[228:231], a[244:247], v[84:87], v[228:231]
    buffer_load_dwordx4 v33, s[60:63], s39 offen offset:0  lds
    v_mfma_f32_16x16x32_bf16 v[224:227], a[244:247], v[80:83], v[224:227]
    ds_read_b64_tr_b16 a[220:221], v113 offset:0
    ds_read_b64_tr_b16 a[222:223], v113 offset:6144
    v_mfma_f32_16x16x32_bf16 v[220:223], a[244:247], v[76:79], v[220:223]
    v_mfma_f32_16x16x32_bf16 v[232:235], a[248:251], v[76:79], v[232:235]
    ds_read_b64_tr_b16 a[224:225], v114 offset:0
    ds_read_b64_tr_b16 a[226:227], v114 offset:6144
    v_mfma_f32_16x16x32_bf16 v[236:239], a[248:251], v[80:83], v[236:239]
    buffer_load_dwordx4 v34, s[60:63], s39 offen offset:1024  lds
    v_mfma_f32_16x16x32_bf16 v[240:243], a[248:251], v[84:87], v[240:243]
    ds_read_b64_tr_b16 a[228:229], v115 offset:0
    ds_read_b64_tr_b16 a[230:231], v115 offset:6144
    v_mfma_f32_16x16x32_bf16 v[252:255], a[252:255], v[84:87], v[252:255]
    v_mfma_f32_16x16x32_bf16 v[248:251], a[252:255], v[80:83], v[248:251]
    ds_read_b64_tr_b16 a[232:233], v112 offset:128
    ds_read_b64_tr_b16 a[234:235], v112 offset:6272
    v_mfma_f32_16x16x32_bf16 v[244:247], a[252:255], v[76:79], v[244:247]
    s_waitcnt lgkmcnt(8)
    v_mfma_f32_16x16x32_bf16 v[136:139], a[216:219], v[88:91], v[136:139]
    ds_read_b64_tr_b16 a[236:237], v113 offset:128
    ds_read_b64_tr_b16 a[238:239], v113 offset:6272
    v_mfma_f32_16x16x32_bf16 v[140:143], a[216:219], v[92:95], v[140:143]
    v_mov_b32 v130, 1
    s_mov_b64 exec, 7
    v_mov_b32 v130, 0
    buffer_atomic_or v130, v125, s[80:83], 0 offen offset:0 sc0
    s_mov_b64 exec, -1
    v_mfma_f32_16x16x32_bf16 v[144:147], a[216:219], v[96:99], v[144:147]
    s_waitcnt lgkmcnt(8)
    ds_read_b64_tr_b16 a[240:241], v114 offset:128
    ds_read_b64_tr_b16 a[242:243], v114 offset:6272
    v_mfma_f32_16x16x32_bf16 v[156:159], a[220:223], v[96:99], v[156:159]
    v_mfma_f32_16x16x32_bf16 v[152:155], a[220:223], v[92:95], v[152:155]
    ds_read_b64_tr_b16 a[244:245], v115 offset:128
    ds_read_b64_tr_b16 a[246:247], v115 offset:6272
    v_mfma_f32_16x16x32_bf16 v[148:151], a[220:223], v[88:91], v[148:151]
    s_waitcnt lgkmcnt(10)
    v_mfma_f32_16x16x32_bf16 v[160:163], a[224:227], v[88:91], v[160:163]
    ds_read_b64_tr_b16 a[248:249], v112 offset:256
    ds_read_b64_tr_b16 a[250:251], v112 offset:6400
    v_mfma_f32_16x16x32_bf16 v[164:167], a[224:227], v[92:95], v[164:167]
    v_mfma_f32_16x16x32_bf16 v[168:171], a[224:227], v[96:99], v[168:171]
    s_waitcnt lgkmcnt(10)
    ds_read_b64_tr_b16 a[252:253], v113 offset:256
    ds_read_b64_tr_b16 a[254:255], v113 offset:6400
    v_mfma_f32_16x16x32_bf16 v[180:183], a[228:231], v[96:99], v[180:183]
    v_mfma_f32_16x16x32_bf16 v[176:179], a[228:231], v[92:95], v[176:179]
    v_mfma_f32_16x16x32_bf16 v[172:175], a[228:231], v[88:91], v[172:175]
    s_waitcnt lgkmcnt(10)
    buffer_load_dwordx4 v35, s[60:63], s39 offen offset:2048  lds
    v_mfma_f32_16x16x32_bf16 v[184:187], a[232:235], v[88:91], v[184:187]
    v_mfma_f32_16x16x32_bf16 v[188:191], a[232:235], v[92:95], v[188:191]
    v_mfma_f32_16x16x32_bf16 v[192:195], a[232:235], v[96:99], v[192:195]
    s_waitcnt lgkmcnt(8)
    v_mfma_f32_16x16x32_bf16 v[204:207], a[236:239], v[96:99], v[204:207]
    v_mfma_f32_16x16x32_bf16 v[200:203], a[236:239], v[92:95], v[200:203]
    v_mfma_f32_16x16x32_bf16 v[196:199], a[236:239], v[88:91], v[196:199]
    s_waitcnt lgkmcnt(6)
    v_mfma_f32_16x16x32_bf16 v[208:211], a[240:243], v[88:91], v[208:211]
    v_mfma_f32_16x16x32_bf16 v[212:215], a[240:243], v[92:95], v[212:215]
    s_waitcnt lgkmcnt(0)
    s_barrier
    s_add_u32 s39, s87, 81920
    v_mfma_f32_16x16x32_bf16 v[216:219], a[240:243], v[96:99], v[216:219]
    s_add_u32 m0, s34, 0
    ds_read_b64_tr_b16 a[216:217], v116 offset:36960
    ds_read_b64_tr_b16 a[218:219], v116 offset:43104
    v_mfma_f32_16x16x32_bf16 v[228:231], a[244:247], v[96:99], v[228:231]
    buffer_load_dwordx4 v33, s[60:63], s39 offen offset:0  lds
    v_mfma_f32_16x16x32_bf16 v[224:227], a[244:247], v[92:95], v[224:227]
    ds_read_b64_tr_b16 a[220:221], v117 offset:36960
    ds_read_b64_tr_b16 a[222:223], v117 offset:43104
    v_mfma_f32_16x16x32_bf16 v[220:223], a[244:247], v[88:91], v[220:223]
    v_mfma_f32_16x16x32_bf16 v[232:235], a[248:251], v[88:91], v[232:235]
    ds_read_b64_tr_b16 a[224:225], v118 offset:36960
    ds_read_b64_tr_b16 a[226:227], v118 offset:43104
    v_mfma_f32_16x16x32_bf16 v[236:239], a[248:251], v[92:95], v[236:239]
    buffer_load_dwordx4 v34, s[60:63], s39 offen offset:1024  lds
    v_mfma_f32_16x16x32_bf16 v[240:243], a[248:251], v[96:99], v[240:243]
    ds_read_b64_tr_b16 a[228:229], v119 offset:36960
    ds_read_b64_tr_b16 a[230:231], v119 offset:43104
    v_mfma_f32_16x16x32_bf16 v[252:255], a[252:255], v[96:99], v[252:255]
    v_mfma_f32_16x16x32_bf16 v[248:251], a[252:255], v[92:95], v[248:251]
    ds_read_b64_tr_b16 a[232:233], v116 offset:37088
    ds_read_b64_tr_b16 a[234:235], v116 offset:43232
    v_mfma_f32_16x16x32_bf16 v[244:247], a[252:255], v[88:91], v[244:247]
    s_waitcnt lgkmcnt(8)
    v_mfma_f32_16x16x32_bf16 v[136:139], a[216:219], v[100:103], v[136:139]
    ds_read_b64_tr_b16 a[236:237], v117 offset:37088
    ds_read_b64_tr_b16 a[238:239], v117 offset:43232
    v_mfma_f32_16x16x32_bf16 v[140:143], a[216:219], v[104:107], v[140:143]
    buffer_load_dwordx4 v35, s[60:63], s39 offen offset:2048  lds
    v_mfma_f32_16x16x32_bf16 v[144:147], a[216:219], v[108:111], v[144:147]
    s_waitcnt lgkmcnt(8)
    ds_read_b64_tr_b16 a[240:241], v118 offset:37088
    ds_read_b64_tr_b16 a[242:243], v118 offset:43232
    v_mfma_f32_16x16x32_bf16 v[156:159], a[220:223], v[108:111], v[156:159]
    v_mfma_f32_16x16x32_bf16 v[152:155], a[220:223], v[104:107], v[152:155]
    ds_read_b64_tr_b16 a[244:245], v119 offset:37088
    ds_read_b64_tr_b16 a[246:247], v119 offset:43232
    v_mfma_f32_16x16x32_bf16 v[148:151], a[220:223], v[100:103], v[148:151]
    s_waitcnt lgkmcnt(10)
    v_mfma_f32_16x16x32_bf16 v[160:163], a[224:227], v[100:103], v[160:163]
    ds_read_b64_tr_b16 a[248:249], v116 offset:37216
    ds_read_b64_tr_b16 a[250:251], v116 offset:43360
    v_mfma_f32_16x16x32_bf16 v[164:167], a[224:227], v[104:107], v[164:167]
    v_mfma_f32_16x16x32_bf16 v[168:171], a[224:227], v[108:111], v[168:171]
    s_waitcnt lgkmcnt(10)
    ds_read_b64_tr_b16 a[252:253], v117 offset:37216
    ds_read_b64_tr_b16 a[254:255], v117 offset:43360
    v_mfma_f32_16x16x32_bf16 v[180:183], a[228:231], v[108:111], v[180:183]
    v_mfma_f32_16x16x32_bf16 v[176:179], a[228:231], v[104:107], v[176:179]
    v_mfma_f32_16x16x32_bf16 v[172:175], a[228:231], v[100:103], v[172:175]
    s_waitcnt lgkmcnt(10)
    v_mfma_f32_16x16x32_bf16 v[184:187], a[232:235], v[100:103], v[184:187]
    v_mfma_f32_16x16x32_bf16 v[188:191], a[232:235], v[104:107], v[188:191]
    v_mfma_f32_16x16x32_bf16 v[192:195], a[232:235], v[108:111], v[192:195]
    s_waitcnt lgkmcnt(8)
    v_mfma_f32_16x16x32_bf16 v[204:207], a[236:239], v[108:111], v[204:207]
    v_mfma_f32_16x16x32_bf16 v[200:203], a[236:239], v[104:107], v[200:203]
    v_mfma_f32_16x16x32_bf16 v[196:199], a[236:239], v[100:103], v[196:199]
    s_waitcnt lgkmcnt(6)
    v_mfma_f32_16x16x32_bf16 v[208:211], a[240:243], v[100:103], v[208:211]
    v_mfma_f32_16x16x32_bf16 v[212:215], a[240:243], v[104:107], v[212:215]
    s_waitcnt lgkmcnt(0)
    s_barrier
    v_mfma_f32_16x16x32_bf16 v[216:219], a[240:243], v[108:111], v[216:219]
    ds_read_b64_tr_b16 a[216:217], v112 offset:12320
    ds_read_b64_tr_b16 a[218:219], v112 offset:18464
    v_mfma_f32_16x16x32_bf16 v[228:231], a[244:247], v[108:111], v[228:231]
    s_waitcnt vmcnt(4)
    v_cmp_eq_u32 vcc, 1, v130
    s_nop 0
    s_cmp_eq_u64 vcc, exec
    s_cbranch_scc0 L_F1_0_SPIN
L_F1_0_OK:
    v_mfma_f32_16x16x32_bf16 v[224:227], a[244:247], v[104:107], v[224:227]
    ds_read_b64_tr_b16 a[220:221], v113 offset:12320
    ds_read_b64_tr_b16 a[222:223], v113 offset:18464
    v_mfma_f32_16x16x32_bf16 v[220:223], a[244:247], v[100:103], v[220:223]
    v_mfma_f32_16x16x32_bf16 v[232:235], a[248:251], v[100:103], v[232:235]
    s_add_u32 s31, s89, 0
    ds_read_b64_tr_b16 a[224:225], v114 offset:12320
    ds_read_b64_tr_b16 a[226:227], v114 offset:18464
    v_mfma_f32_16x16x32_bf16 v[236:239], a[248:251], v[104:107], v[236:239]
    buffer_load_dwordx4 a[0:3], v0, s[64:67], s31 offen offset:0 sc1
    v_mfma_f32_16x16x32_bf16 v[240:243], a[248:251], v[108:111], v[240:243]
    ds_read_b64_tr_b16 a[228:229], v115 offset:12320
    ds_read_b64_tr_b16 a[230:231], v115 offset:18464
    v_mfma_f32_16x16x32_bf16 v[252:255], a[252:255], v[108:111], v[252:255]
    v_mfma_f32_16x16x32_bf16 v[248:251], a[252:255], v[104:107], v[248:251]
    ds_read_b64_tr_b16 a[232:233], v112 offset:12448
    ds_read_b64_tr_b16 a[234:235], v112 offset:18592
    v_mfma_f32_16x16x32_bf16 v[244:247], a[252:255], v[100:103], v[244:247]
    s_waitcnt lgkmcnt(8)
    v_mfma_f32_16x16x32_bf16 v[136:139], a[216:219], v[40:43], v[136:139]
    ds_read_b64_tr_b16 a[236:237], v113 offset:12448
    ds_read_b64_tr_b16 a[238:239], v113 offset:18592
    v_mfma_f32_16x16x32_bf16 v[140:143], a[216:219], v[44:47], v[140:143]
    buffer_load_dwordx4 a[4:7], v0, s[64:67], s31 offen offset:1024 sc1
    v_mfma_f32_16x16x32_bf16 v[144:147], a[216:219], v[48:51], v[144:147]
    s_waitcnt lgkmcnt(8)
    ds_read_b64_tr_b16 a[240:241], v114 offset:12448
    ds_read_b64_tr_b16 a[242:243], v114 offset:18592
    v_mfma_f32_16x16x32_bf16 v[156:159], a[220:223], v[48:51], v[156:159]
    v_mfma_f32_16x16x32_bf16 v[152:155], a[220:223], v[44:47], v[152:155]
    ds_read_b64_tr_b16 a[244:245], v115 offset:12448
    ds_read_b64_tr_b16 a[246:247], v115 offset:18592
    v_mfma_f32_16x16x32_bf16 v[148:151], a[220:223], v[40:43], v[148:151]
    s_waitcnt lgkmcnt(10)
    buffer_load_dwordx4 a[8:11], v0, s[64:67], s31 offen offset:2048 sc1
    v_mfma_f32_16x16x32_bf16 v[160:163], a[224:227], v[40:43], v[160:163]
    ds_read_b64_tr_b16 a[248:249], v112 offset:12576
    ds_read_b64_tr_b16 a[250:251], v112 offset:18720
    v_mfma_f32_16x16x32_bf16 v[164:167], a[224:227], v[44:47], v[164:167]
    v_mfma_f32_16x16x32_bf16 v[168:171], a[224:227], v[48:51], v[168:171]
    s_waitcnt lgkmcnt(10)
    s_add_u32 s31, s89, 3072
    ds_read_b64_tr_b16 a[252:253], v113 offset:12576
    ds_read_b64_tr_b16 a[254:255], v113 offset:18720
    v_mfma_f32_16x16x32_bf16 v[180:183], a[228:231], v[48:51], v[180:183]
    buffer_load_dwordx4 a[12:15], v0, s[64:67], s31 offen offset:0 sc1
    v_mfma_f32_16x16x32_bf16 v[176:179], a[228:231], v[44:47], v[176:179]
    v_mfma_f32_16x16x32_bf16 v[172:175], a[228:231], v[40:43], v[172:175]
    s_waitcnt lgkmcnt(10)
    buffer_load_dwordx4 a[16:19], v0, s[64:67], s31 offen offset:1024 sc1
    v_mfma_f32_16x16x32_bf16 v[184:187], a[232:235], v[40:43], v[184:187]
    v_mfma_f32_16x16x32_bf16 v[188:191], a[232:235], v[44:47], v[188:191]
    buffer_load_dwordx4 a[20:23], v0, s[64:67], s31 offen offset:2048 sc1
    v_mfma_f32_16x16x32_bf16 v[192:195], a[232:235], v[48:51], v[192:195]
    s_waitcnt lgkmcnt(8)
    s_mov_b32 s38, 6144
    v_mfma_f32_16x16x32_bf16 v[204:207], a[236:239], v[48:51], v[204:207]
    buffer_store_dwordx4 v[76:79], v0, s[20:23], s38 offen offset:0 sc1
    v_mfma_f32_16x16x32_bf16 v[200:203], a[236:239], v[44:47], v[200:203]
    v_mfma_f32_16x16x32_bf16 v[196:199], a[236:239], v[40:43], v[196:199]
    s_waitcnt lgkmcnt(6)
    v_mfma_f32_16x16x32_bf16 v[208:211], a[240:243], v[40:43], v[208:211]
    v_mfma_f32_16x16x32_bf16 v[212:215], a[240:243], v[44:47], v[212:215]
    s_waitcnt lgkmcnt(0)
    s_barrier
    v_mfma_f32_16x16x32_bf16 v[216:219], a[240:243], v[48:51], v[216:219]
    ds_read_b64_tr_b16 a[216:217], v116 offset:49280
    ds_read_b64_tr_b16 a[218:219], v116 offset:55424
    v_mfma_f32_16x16x32_bf16 v[228:231], a[244:247], v[48:51], v[228:231]
    buffer_store_dwordx4 v[80:83], v0, s[20:23], s38 offen offset:1024 sc1
    v_mfma_f32_16x16x32_bf16 v[224:227], a[244:247], v[44:47], v[224:227]
    ds_read_b64_tr_b16 a[220:221], v117 offset:49280
    ds_read_b64_tr_b16 a[222:223], v117 offset:55424
    v_mfma_f32_16x16x32_bf16 v[220:223], a[244:247], v[40:43], v[220:223]
    v_mfma_f32_16x16x32_bf16 v[232:235], a[248:251], v[40:43], v[232:235]
    ds_read_b64_tr_b16 a[224:225], v118 offset:49280
    ds_read_b64_tr_b16 a[226:227], v118 offset:55424
    v_mfma_f32_16x16x32_bf16 v[236:239], a[248:251], v[44:47], v[236:239]
    buffer_store_dwordx4 v[84:87], v0, s[20:23], s38 offen offset:2048 sc1
    v_mfma_f32_16x16x32_bf16 v[240:243], a[248:251], v[48:51], v[240:243]
    ds_read_b64_tr_b16 a[228:229], v119 offset:49280
    ds_read_b64_tr_b16 a[230:231], v119 offset:55424
    v_mfma_f32_16x16x32_bf16 v[252:255], a[252:255], v[48:51], v[252:255]
    v_mfma_f32_16x16x32_bf16 v[248:251], a[252:255], v[44:47], v[248:251]
    ds_read_b64_tr_b16 a[232:233], v116 offset:49408
    ds_read_b64_tr_b16 a[234:235], v116 offset:55552
    v_mfma_f32_16x16x32_bf16 v[244:247], a[252:255], v[40:43], v[244:247]
    s_waitcnt vmcnt(8) lgkmcnt(8)
    v_mfma_f32_16x16x32_bf16 v[136:139], a[216:219], a[0:3], v[136:139]
    s_waitcnt vmcnt(7)
    s_mov_b32 s38, 9216
    ds_read_b64_tr_b16 a[236:237], v117 offset:49408
    ds_read_b64_tr_b16 a[238:239], v117 offset:55552
    v_mfma_f32_16x16x32_bf16 v[140:143], a[216:219], a[4:7], v[140:143]
    s_waitcnt vmcnt(6)
    buffer_store_dwordx4 v[88:91], v0, s[20:23], s38 offen offset:0 sc1
    v_mfma_f32_16x16x32_bf16 v[144:147], a[216:219], a[8:11], v[144:147]
    s_waitcnt lgkmcnt(8)
    ds_read_b64_tr_b16 a[240:241], v118 offset:49408
    ds_read_b64_tr_b16 a[242:243], v118 offset:55552
    v_mfma_f32_16x16x32_bf16 v[156:159], a[220:223], a[8:11], v[156:159]
    v_mfma_f32_16x16x32_bf16 v[152:155], a[220:223], a[4:7], v[152:155]
    ds_read_b64_tr_b16 a[244:245], v119 offset:49408
    ds_read_b64_tr_b16 a[246:247], v119 offset:55552
    v_mfma_f32_16x16x32_bf16 v[148:151], a[220:223], a[0:3], v[148:151]
    s_waitcnt lgkmcnt(10)
    buffer_store_dwordx4 v[92:95], v0, s[20:23], s38 offen offset:1024 sc1
    v_mfma_f32_16x16x32_bf16 v[160:163], a[224:227], a[0:3], v[160:163]
    ds_read_b64_tr_b16 a[248:249], v116 offset:49536
    ds_read_b64_tr_b16 a[250:251], v116 offset:55680
    v_mfma_f32_16x16x32_bf16 v[164:167], a[224:227], a[4:7], v[164:167]
    v_mfma_f32_16x16x32_bf16 v[168:171], a[224:227], a[8:11], v[168:171]
    s_waitcnt lgkmcnt(10)
    ds_read_b64_tr_b16 a[252:253], v117 offset:49536
    ds_read_b64_tr_b16 a[254:255], v117 offset:55680
    v_mfma_f32_16x16x32_bf16 v[180:183], a[228:231], a[8:11], v[180:183]
    buffer_store_dwordx4 v[96:99], v0, s[20:23], s38 offen offset:2048 sc1
    v_mfma_f32_16x16x32_bf16 v[176:179], a[228:231], a[4:7], v[176:179]
    s_add_u32 s31, s90, 0
    v_mfma_f32_16x16x32_bf16 v[172:175], a[228:231], a[0:3], v[172:175]
    s_waitcnt lgkmcnt(10)
    buffer_load_dwordx4 a[72:75], v0, s[64:67], s31 offen offset:0 sc1
    v_mfma_f32_16x16x32_bf16 v[184:187], a[232:235], a[0:3], v[184:187]
    v_mfma_f32_16x16x32_bf16 v[188:191], a[232:235], a[4:7], v[188:191]
    buffer_load_dwordx4 a[76:79], v0, s[64:67], s31 offen offset:1024 sc1
    v_mfma_f32_16x16x32_bf16 v[192:195], a[232:235], a[8:11], v[192:195]
    s_waitcnt lgkmcnt(8)
    v_mfma_f32_16x16x32_bf16 v[204:207], a[236:239], a[8:11], v[204:207]
    buffer_load_dwordx4 a[80:83], v0, s[64:67], s31 offen offset:2048 sc1
    v_mfma_f32_16x16x32_bf16 v[200:203], a[236:239], a[4:7], v[200:203]
    v_mfma_f32_16x16x32_bf16 v[196:199], a[236:239], a[0:3], v[196:199]
    s_waitcnt lgkmcnt(6)
    v_mfma_f32_16x16x32_bf16 v[208:211], a[240:243], a[0:3], v[208:211]
    v_mfma_f32_16x16x32_bf16 v[212:215], a[240:243], a[4:7], v[212:215]
    s_waitcnt lgkmcnt(0)
    s_barrier
    v_mfma_f32_16x16x32_bf16 v[216:219], a[240:243], a[8:11], v[216:219]
    s_add_u32 s31, s90, 3072
    ds_read_b64_tr_b16 a[216:217], v112 offset:24640
    ds_read_b64_tr_b16 a[218:219], v112 offset:30784
    v_mfma_f32_16x16x32_bf16 v[228:231], a[244:247], a[8:11], v[228:231]
    buffer_load_dwordx4 a[84:87], v0, s[64:67], s31 offen offset:0 sc1
    v_mfma_f32_16x16x32_bf16 v[224:227], a[244:247], a[4:7], v[224:227]
    ds_read_b64_tr_b16 a[220:221], v113 offset:24640
    ds_read_b64_tr_b16 a[222:223], v113 offset:30784
    v_mfma_f32_16x16x32_bf16 v[220:223], a[244:247], a[0:3], v[220:223]
    v_mfma_f32_16x16x32_bf16 v[232:235], a[248:251], a[0:3], v[232:235]
    ds_read_b64_tr_b16 a[224:225], v114 offset:24640
    ds_read_b64_tr_b16 a[226:227], v114 offset:30784
    v_mfma_f32_16x16x32_bf16 v[236:239], a[248:251], a[4:7], v[236:239]
    buffer_load_dwordx4 a[88:91], v0, s[64:67], s31 offen offset:1024 sc1
    v_mfma_f32_16x16x32_bf16 v[240:243], a[248:251], a[8:11], v[240:243]
    ds_read_b64_tr_b16 a[228:229], v115 offset:24640
    ds_read_b64_tr_b16 a[230:231], v115 offset:30784
    v_mfma_f32_16x16x32_bf16 v[252:255], a[252:255], a[8:11], v[252:255]
    v_mfma_f32_16x16x32_bf16 v[248:251], a[252:255], a[4:7], v[248:251]
    ds_read_b64_tr_b16 a[232:233], v112 offset:24768
    ds_read_b64_tr_b16 a[234:235], v112 offset:30912
    v_mfma_f32_16x16x32_bf16 v[244:247], a[252:255], a[0:3], v[244:247]
    s_waitcnt vmcnt(13) lgkmcnt(8)
    v_mfma_f32_16x16x32_bf16 v[136:139], a[216:219], a[12:15], v[136:139]
    s_waitcnt vmcnt(12)
    ds_read_b64_tr_b16 a[236:237], v113 offset:24768
    ds_read_b64_tr_b16 a[238:239], v113 offset:30912
    v_mfma_f32_16x16x32_bf16 v[140:143], a[216:219], a[16:19], v[140:143]
    s_waitcnt vmcnt(11)
    buffer_load_dwordx4 a[92:95], v0, s[64:67], s31 offen offset:2048 sc1
    v_mfma_f32_16x16x32_bf16 v[144:147], a[216:219], a[20:23], v[144:147]
    s_waitcnt lgkmcnt(8)
    ds_read_b64_tr_b16 a[240:241], v114 offset:24768
    ds_read_b64_tr_b16 a[242:243], v114 offset:30912
    v_mfma_f32_16x16x32_bf16 v[156:159], a[220:223], a[20:23], v[156:159]
    v_mfma_f32_16x16x32_bf16 v[152:155], a[220:223], a[16:19], v[152:155]
    s_add_u32 s31, s91, 0
    ds_read_b64_tr_b16 a[244:245], v115 offset:24768
    ds_read_b64_tr_b16 a[246:247], v115 offset:30912
    v_mfma_f32_16x16x32_bf16 v[148:151], a[220:223], a[12:15], v[148:151]
    s_waitcnt lgkmcnt(10)
    buffer_load_dwordx4 a[144:147], v0, s[64:67], s31 offen offset:0 sc1
    v_mfma_f32_16x16x32_bf16 v[160:163], a[224:227], a[12:15], v[160:163]
    ds_read_b64_tr_b16 a[248:249], v112 offset:24896
    ds_read_b64_tr_b16 a[250:251], v112 offset:31040
    v_mfma_f32_16x16x32_bf16 v[164:167], a[224:227], a[16:19], v[164:167]
    v_mfma_f32_16x16x32_bf16 v[168:171], a[224:227], a[20:23], v[168:171]
    s_waitcnt lgkmcnt(10)
    ds_read_b64_tr_b16 a[252:253], v113 offset:24896
    ds_read_b64_tr_b16 a[254:255], v113 offset:31040
    v_mfma_f32_16x16x32_bf16 v[180:183], a[228:231], a[20:23], v[180:183]
    buffer_load_dwordx4 a[148:151], v0, s[64:67], s31 offen offset:1024 sc1
    v_mfma_f32_16x16x32_bf16 v[176:179], a[228:231], a[16:19], v[176:179]
    v_mfma_f32_16x16x32_bf16 v[172:175], a[228:231], a[12:15], v[172:175]
    s_waitcnt lgkmcnt(10)
    buffer_load_dwordx4 a[152:155], v0, s[64:67], s31 offen offset:2048 sc1
    v_mfma_f32_16x16x32_bf16 v[184:187], a[232:235], a[12:15], v[184:187]
    s_add_u32 s31, s91, 3072
    v_mfma_f32_16x16x32_bf16 v[188:191], a[232:235], a[16:19], v[188:191]
    buffer_load_dwordx4 a[156:159], v0, s[64:67], s31 offen offset:0 sc1
    v_mfma_f32_16x16x32_bf16 v[192:195], a[232:235], a[20:23], v[192:195]
    s_waitcnt lgkmcnt(8)
    v_mfma_f32_16x16x32_bf16 v[204:207], a[236:239], a[20:23], v[204:207]
    buffer_load_dwordx4 a[160:163], v0, s[64:67], s31 offen offset:1024 sc1
    v_mfma_f32_16x16x32_bf16 v[200:203], a[236:239], a[16:19], v[200:203]
    v_mfma_f32_16x16x32_bf16 v[196:199], a[236:239], a[12:15], v[196:199]
    s_waitcnt lgkmcnt(6)
    v_mfma_f32_16x16x32_bf16 v[208:211], a[240:243], a[12:15], v[208:211]
    v_mfma_f32_16x16x32_bf16 v[212:215], a[240:243], a[16:19], v[212:215]
    s_waitcnt lgkmcnt(0)
    s_barrier
    v_mfma_f32_16x16x32_bf16 v[216:219], a[240:243], a[20:23], v[216:219]
    ds_read_b64_tr_b16 a[216:217], v120 offset:0
    ds_read_b64_tr_b16 a[218:219], v120 offset:6144
    v_mfma_f32_16x16x32_bf16 v[228:231], a[244:247], a[20:23], v[228:231]
    buffer_load_dwordx4 a[164:167], v0, s[64:67], s31 offen offset:2048 sc1
    v_mfma_f32_16x16x32_bf16 v[224:227], a[244:247], a[16:19], v[224:227]
    ds_read_b64_tr_b16 a[220:221], v121 offset:0
    ds_read_b64_tr_b16 a[222:223], v121 offset:6144
    v_mfma_f32_16x16x32_bf16 v[220:223], a[244:247], a[12:15], v[220:223]
    v_mfma_f32_16x16x32_bf16 v[232:235], a[248:251], a[12:15], v[232:235]
    ds_read_b64_tr_b16 a[224:225], v122 offset:0
    ds_read_b64_tr_b16 a[226:227], v122 offset:6144
    v_mfma_f32_16x16x32_bf16 v[236:239], a[248:251], a[16:19], v[236:239]
    s_waitcnt vmcnt(12)
    s_mov_b64 exec, 1
    buffer_store_dword v129, v7, s[80:83], 0 offen offset:4 sc1
    s_mov_b64 exec, -1
    v_mfma_f32_16x16x32_bf16 v[240:243], a[248:251], a[20:23], v[240:243]
    ds_read_b64_tr_b16 a[228:229], v123 offset:0
    ds_read_b64_tr_b16 a[230:231], v123 offset:6144
    v_mfma_f32_16x16x32_bf16 v[252:255], a[252:255], a[20:23], v[252:255]
    v_mfma_f32_16x16x32_bf16 v[248:251], a[252:255], a[16:19], v[248:251]
    ds_read_b64_tr_b16 a[232:233], v120 offset:128
    ds_read_b64_tr_b16 a[234:235], v120 offset:6272
    v_mfma_f32_16x16x32_bf16 v[244:247], a[252:255], a[12:15], v[244:247]
    s_waitcnt vmcnt(12) lgkmcnt(8)
    v_mfma_f32_16x16x32_bf16 v[136:139], a[216:219], a[72:75], v[136:139]
    s_waitcnt vmcnt(11)
    s_mov_b32 s38, 12288
    ds_read_b64_tr_b16 a[236:237], v121 offset:128
    ds_read_b64_tr_b16 a[238:239], v121 offset:6272
    v_mfma_f32_16x16x32_bf16 v[140:143], a[216:219], a[76:79], v[140:143]
    s_waitcnt vmcnt(10)
    buffer_store_dwordx4 v[100:103], v0, s[20:23], s38 offen offset:0 sc1
    v_mfma_f32_16x16x32_bf16 v[144:147], a[216:219], a[80:83], v[144:147]
    s_waitcnt lgkmcnt(8)
    ds_read_b64_tr_b16 a[240:241], v122 offset:128
    ds_read_b64_tr_b16 a[242:243], v122 offset:6272
    v_mfma_f32_16x16x32_bf16 v[156:159], a[220:223], a[80:83], v[156:159]
    v_mfma_f32_16x16x32_bf16 v[152:155], a[220:223], a[76:79], v[152:155]
    ds_read_b64_tr_b16 a[244:245], v123 offset:128
    ds_read_b64_tr_b16 a[246:247], v123 offset:6272
    v_mfma_f32_16x16x32_bf16 v[148:151], a[220:223], a[72:75], v[148:151]
    s_waitcnt lgkmcnt(10)
    buffer_store_dwordx4 v[104:107], v0, s[20:23], s38 offen offset:1024 sc1
    v_mfma_f32_16x16x32_bf16 v[160:163], a[224:227], a[72:75], v[160:163]
    ds_read_b64_tr_b16 a[248:249], v120 offset:256
    ds_read_b64_tr_b16 a[250:251], v120 offset:6400
    v_mfma_f32_16x16x32_bf16 v[164:167], a[224:227], a[76:79], v[164:167]
    v_mfma_f32_16x16x32_bf16 v[168:171], a[224:227], a[80:83], v[168:171]
    s_waitcnt lgkmcnt(10)
    ds_read_b64_tr_b16 a[252:253], v121 offset:256
    ds_read_b64_tr_b16 a[254:255], v121 offset:6400
    v_mfma_f32_16x16x32_bf16 v[180:183], a[228:231], a[80:83], v[180:183]
    buffer_store_dwordx4 v[108:111], v0, s[20:23], s38 offen offset:2048 sc1
    v_mfma_f32_16x16x32_bf16 v[176:179], a[228:231], a[76:79], v[176:179]
    s_mov_b32 s38, 15360
    v_mfma_f32_16x16x32_bf16 v[172:175], a[228:231], a[72:75], v[172:175]
    s_waitcnt lgkmcnt(10)
    buffer_store_dwordx4 v[40:43], v0, s[20:23], s38 offen offset:0 sc1
    v_mfma_f32_16x16x32_bf16 v[184:187], a[232:235], a[72:75], v[184:187]
    v_mfma_f32_16x16x32_bf16 v[188:191], a[232:235], a[76:79], v[188:191]
    buffer_store_dwordx4 v[44:47], v0, s[20:23], s38 offen offset:1024 sc1
    v_mfma_f32_16x16x32_bf16 v[192:195], a[232:235], a[80:83], v[192:195]
    s_waitcnt lgkmcnt(8)
    v_mfma_f32_16x16x32_bf16 v[204:207], a[236:239], a[80:83], v[204:207]
    buffer_store_dwordx4 v[48:51], v0, s[20:23], s38 offen offset:2048 sc1
    v_mfma_f32_16x16x32_bf16 v[200:203], a[236:239], a[76:79], v[200:203]
    v_mfma_f32_16x16x32_bf16 v[196:199], a[236:239], a[72:75], v[196:199]
    s_waitcnt lgkmcnt(6)
    v_mfma_f32_16x16x32_bf16 v[208:211], a[240:243], a[72:75], v[208:211]
    v_mfma_f32_16x16x32_bf16 v[212:215], a[240:243], a[76:79], v[212:215]
    s_waitcnt lgkmcnt(0)
    s_barrier
    v_mfma_f32_16x16x32_bf16 v[216:219], a[240:243], a[80:83], v[216:219]
    ds_read_b64_tr_b16 a[216:217], v112 offset:36960
    ds_read_b64_tr_b16 a[218:219], v112 offset:43104
    v_mfma_f32_16x16x32_bf16 v[228:231], a[244:247], a[80:83], v[228:231]
    v_mov_b32 v131, 1
    s_mov_b64 exec, 7
    v_mov_b32 v131, 0
    buffer_atomic_or v131, v125, s[80:83], 0 offen offset:4 sc0
    s_mov_b64 exec, -1
    v_mfma_f32_16x16x32_bf16 v[224:227], a[244:247], a[76:79], v[224:227]
    ds_read_b64_tr_b16 a[220:221], v113 offset:36960
    ds_read_b64_tr_b16 a[222:223], v113 offset:43104
    v_mfma_f32_16x16x32_bf16 v[220:223], a[244:247], a[72:75], v[220:223]
    s_add_u32 s39, s87, 122880
    v_mfma_f32_16x16x32_bf16 v[232:235], a[248:251], a[72:75], v[232:235]
    s_add_u32 m0, s34, 98560
    ds_read_b64_tr_b16 a[224:225], v114 offset:36960
    ds_read_b64_tr_b16 a[226:227], v114 offset:43104
    v_mfma_f32_16x16x32_bf16 v[236:239], a[248:251], a[76:79], v[236:239]
    buffer_load_dwordx4 v33, s[60:63], s39 offen offset:0  lds
    v_mfma_f32_16x16x32_bf16 v[240:243], a[248:251], a[80:83], v[240:243]
    ds_read_b64_tr_b16 a[228:229], v115 offset:36960
    ds_read_b64_tr_b16 a[230:231], v115 offset:43104
    v_mfma_f32_16x16x32_bf16 v[252:255], a[252:255], a[80:83], v[252:255]
    v_mfma_f32_16x16x32_bf16 v[248:251], a[252:255], a[76:79], v[248:251]
    ds_read_b64_tr_b16 a[232:233], v112 offset:37088
    ds_read_b64_tr_b16 a[234:235], v112 offset:43232
    v_mfma_f32_16x16x32_bf16 v[244:247], a[252:255], a[72:75], v[244:247]
    s_waitcnt vmcnt(17) lgkmcnt(8)
    v_mfma_f32_16x16x32_bf16 v[136:139], a[216:219], a[84:87], v[136:139]
    s_waitcnt vmcnt(16)
    ds_read_b64_tr_b16 a[236:237], v113 offset:37088
    ds_read_b64_tr_b16 a[238:239], v113 offset:43232
    v_mfma_f32_16x16x32_bf16 v[140:143], a[216:219], a[88:91], v[140:143]
    s_waitcnt vmcnt(15)
    buffer_load_dwordx4 v34, s[60:63], s39 offen offset:1024  lds
    v_mfma_f32_16x16x32_bf16 v[144:147], a[216:219], a[92:95], v[144:147]
    s_waitcnt lgkmcnt(8)
    ds_read_b64_tr_b16 a[240:241], v114 offset:37088
    ds_read_b64_tr_b16 a[242:243], v114 offset:43232
    v_mfma_f32_16x16x32_bf16 v[156:159], a[220:223], a[92:95], v[156:159]
    v_mfma_f32_16x16x32_bf16 v[152:155], a[220:223], a[88:91], v[152:155]
    ds_read_b64_tr_b16 a[244:245], v115 offset:37088
    ds_read_b64_tr_b16 a[246:247], v115 offset:43232
    v_mfma_f32_16x16x32_bf16 v[148:151], a[220:223], a[84:87], v[148:151]
    s_waitcnt lgkmcnt(10)
    buffer_load_dwordx4 v35, s[60:63], s39 offen offset:2048  lds
    v_mfma_f32_16x16x32_bf16 v[160:163], a[224:227], a[84:87], v[160:163]
    ds_read_b64_tr_b16 a[248:249], v112 offset:37216
    ds_read_b64_tr_b16 a[250:251], v112 offset:43360
    v_mfma_f32_16x16x32_bf16 v[164:167], a[224:227], a[88:91], v[164:167]
    s_add_u32 s39, s85, 163840
    v_mfma_f32_16x16x32_bf16 v[168:171], a[224:227], a[92:95], v[168:171]
    s_waitcnt lgkmcnt(10)
    s_add_u32 m0, s34, 12320
    ds_read_b64_tr_b16 a[252:253], v113 offset:37216
    ds_read_b64_tr_b16 a[254:255], v113 offset:43360
    v_mfma_f32_16x16x32_bf16 v[180:183], a[228:231], a[92:95], v[180:183]
    buffer_load_dwordx4 v33, s[60:63], s39 offen offset:0  lds
    v_mfma_f32_16x16x32_bf16 v[176:179], a[228:231], a[88:91], v[176:179]
    v_mfma_f32_16x16x32_bf16 v[172:175], a[228:231], a[84:87], v[172:175]
    s_waitcnt lgkmcnt(10)
    buffer_load_dwordx4 v34, s[60:63], s39 offen offset:1024  lds
    v_mfma_f32_16x16x32_bf16 v[184:187], a[232:235], a[84:87], v[184:187]
    v_mfma_f32_16x16x32_bf16 v[188:191], a[232:235], a[88:91], v[188:191]
    buffer_load_dwordx4 v35, s[60:63], s39 offen offset:2048  lds
    v_mfma_f32_16x16x32_bf16 v[192:195], a[232:235], a[92:95], v[192:195]
    s_waitcnt lgkmcnt(8)
    s_add_u32 s39, s85, 204800
    s_add_u32 m0, s34, 110880
    v_mfma_f32_16x16x32_bf16 v[204:207], a[236:239], a[92:95], v[204:207]
    buffer_load_dwordx4 v33, s[60:63], s39 offen offset:0  lds
    v_mfma_f32_16x16x32_bf16 v[200:203], a[236:239], a[88:91], v[200:203]
    v_mfma_f32_16x16x32_bf16 v[196:199], a[236:239], a[84:87], v[196:199]
    s_waitcnt lgkmcnt(6)
    v_mfma_f32_16x16x32_bf16 v[208:211], a[240:243], a[84:87], v[208:211]
    v_mfma_f32_16x16x32_bf16 v[212:215], a[240:243], a[88:91], v[212:215]
    s_waitcnt lgkmcnt(0)
    s_barrier
    v_mfma_f32_16x16x32_bf16 v[216:219], a[240:243], a[92:95], v[216:219]
    ds_read_b64_tr_b16 a[216:217], v120 offset:12320
    ds_read_b64_tr_b16 a[218:219], v120 offset:18464
    v_mfma_f32_16x16x32_bf16 v[228:231], a[244:247], a[92:95], v[228:231]
    s_waitcnt vmcnt(7)
    v_cmp_eq_u32 vcc, 1, v131
    s_nop 0
    s_cmp_eq_u64 vcc, exec
    s_cbranch_scc0 L_F1_1_SPIN
L_F1_1_OK:
    v_mfma_f32_16x16x32_bf16 v[224:227], a[244:247], a[88:91], v[224:227]
    ds_read_b64_tr_b16 a[220:221], v121 offset:12320
    ds_read_b64_tr_b16 a[222:223], v121 offset:18464
    v_mfma_f32_16x16x32_bf16 v[220:223], a[244:247], a[84:87], v[220:223]
    v_mfma_f32_16x16x32_bf16 v[232:235], a[248:251], a[84:87], v[232:235]
    s_add_u32 s31, s89, 6144
    ds_read_b64_tr_b16 a[224:225], v122 offset:12320
    ds_read_b64_tr_b16 a[226:227], v122 offset:18464
    v_mfma_f32_16x16x32_bf16 v[236:239], a[248:251], a[88:91], v[236:239]
    buffer_load_dwordx4 a[24:27], v0, s[64:67], s31 offen offset:0 sc1
    v_mfma_f32_16x16x32_bf16 v[240:243], a[248:251], a[92:95], v[240:243]
    ds_read_b64_tr_b16 a[228:229], v123 offset:12320
    ds_read_b64_tr_b16 a[230:231], v123 offset:18464
    v_mfma_f32_16x16x32_bf16 v[252:255], a[252:255], a[92:95], v[252:255]
    v_mfma_f32_16x16x32_bf16 v[248:251], a[252:255], a[88:91], v[248:251]
    ds_read_b64_tr_b16 a[232:233], v120 offset:12448
    ds_read_b64_tr_b16 a[234:235], v120 offset:18592
    v_mfma_f32_16x16x32_bf16 v[244:247], a[252:255], a[84:87], v[244:247]
    s_waitcnt lgkmcnt(8)
    v_mfma_f32_16x16x32_bf16 v[136:139], a[216:219], a[144:147], v[136:139]
    ds_read_b64_tr_b16 a[236:237], v121 offset:12448
    ds_read_b64_tr_b16 a[238:239], v121 offset:18592
    v_mfma_f32_16x16x32_bf16 v[140:143], a[216:219], a[148:151], v[140:143]
    buffer_load_dwordx4 a[28:31], v0, s[64:67], s31 offen offset:1024 sc1
    v_mfma_f32_16x16x32_bf16 v[144:147], a[216:219], a[152:155], v[144:147]
    s_waitcnt lgkmcnt(8)
    ds_read_b64_tr_b16 a[240:241], v122 offset:12448
    ds_read_b64_tr_b16 a[242:243], v122 offset:18592
    v_mfma_f32_16x16x32_bf16 v[156:159], a[220:223], a[152:155], v[156:159]
    v_mfma_f32_16x16x32_bf16 v[152:155], a[220:223], a[148:151], v[152:155]
    ds_read_b64_tr_b16 a[244:245], v123 offset:12448
    ds_read_b64_tr_b16 a[246:247], v123 offset:18592
    v_mfma_f32_16x16x32_bf16 v[148:151], a[220:223], a[144:147], v[148:151]
    s_waitcnt lgkmcnt(10)
    buffer_load_dwordx4 a[32:35], v0, s[64:67], s31 offen offset:2048 sc1
    v_mfma_f32_16x16x32_bf16 v[160:163], a[224:227], a[144:147], v[160:163]
    ds_read_b64_tr_b16 a[248:249], v120 offset:12576
    ds_read_b64_tr_b16 a[250:251], v120 offset:18720
    v_mfma_f32_16x16x32_bf16 v[164:167], a[224:227], a[148:151], v[164:167]
    v_mfma_f32_16x16x32_bf16 v[168:171], a[224:227], a[152:155], v[168:171]
    s_waitcnt lgkmcnt(10)
    s_add_u32 s31, s89, 9216
    ds_read_b64_tr_b16 a[252:253], v121 offset:12576
    ds_read_b64_tr_b16 a[254:255], v121 offset:18720
    v_mfma_f32_16x16x32_bf16 v[180:183], a[228:231], a[152:155], v[180:183]
    buffer_load_dwordx4 a[36:39], v0, s[64:67], s31 offen offset:0 sc1
    v_mfma_f32_16x16x32_bf16 v[176:179], a[228:231], a[148:151], v[176:179]
    v_mfma_f32_16x16x32_bf16 v[172:175], a[228:231], a[144:147], v[172:175]
    s_waitcnt lgkmcnt(10)
    buffer_load_dwordx4 a[40:43], v0, s[64:67], s31 offen offset:1024 sc1
    v_mfma_f32_16x16x32_bf16 v[184:187], a[232:235], a[144:147], v[184:187]
    v_mfma_f32_16x16x32_bf16 v[188:191], a[232:235], a[148:151], v[188:191]
    buffer_load_dwordx4 a[44:47], v0, s[64:67], s31 offen offset:2048 sc1
    v_mfma_f32_16x16x32_bf16 v[192:195], a[232:235], a[152:155], v[192:195]
    s_waitcnt lgkmcnt(8)
    v_mfma_f32_16x16x32_bf16 v[204:207], a[236:239], a[152:155], v[204:207]
    buffer_load_dwordx4 v34, s[60:63], s39 offen offset:1024  lds
    v_mfma_f32_16x16x32_bf16 v[200:203], a[236:239], a[148:151], v[200:203]
    v_mfma_f32_16x16x32_bf16 v[196:199], a[236:239], a[144:147], v[196:199]
    s_waitcnt lgkmcnt(6)
    v_mfma_f32_16x16x32_bf16 v[208:211], a[240:243], a[144:147], v[208:211]
    v_mfma_f32_16x16x32_bf16 v[212:215], a[240:243], a[148:151], v[212:215]
    s_waitcnt lgkmcnt(0)
    s_barrier
    v_mfma_f32_16x16x32_bf16 v[216:219], a[240:243], a[152:155], v[216:219]
    s_add_u32 s31, s90, 6144
    ds_read_b64_tr_b16 a[216:217], v120 offset:24640
    ds_read_b64_tr_b16 a[218:219], v120 offset:30784
    v_mfma_f32_16x16x32_bf16 v[228:231], a[244:247], a[152:155], v[228:231]
    buffer_load_dwordx4 a[96:99], v0, s[64:67], s31 offen offset:0 sc1
    v_mfma_f32_16x16x32_bf16 v[224:227], a[244:247], a[148:151], v[224:227]
    ds_read_b64_tr_b16 a[220:221], v121 offset:24640
    ds_read_b64_tr_b16 a[222:223], v121 offset:30784
    v_mfma_f32_16x16x32_bf16 v[220:223], a[244:247], a[144:147], v[220:223]
    v_mfma_f32_16x16x32_bf16 v[232:235], a[248:251], a[144:147], v[232:235]
    ds_read_b64_tr_b16 a[224:225], v122 offset:24640
    ds_read_b64_tr_b16 a[226:227], v122 offset:30784
    v_mfma_f32_16x16x32_bf16 v[236:239], a[248:251], a[148:151], v[236:239]
    buffer_load_dwordx4 a[100:103], v0, s[64:67], s31 offen offset:1024 sc1
    v_mfma_f32_16x16x32_bf16 v[240:243], a[248:251], a[152:155], v[240:243]
    ds_read_b64_tr_b16 a[228:229], v123 offset:24640
    ds_read_b64_tr_b16 a[230:231], v123 offset:30784
    v_mfma_f32_16x16x32_bf16 v[252:255], a[252:255], a[152:155], v[252:255]
    v_mfma_f32_16x16x32_bf16 v[248:251], a[252:255], a[148:151], v[248:251]
    ds_read_b64_tr_b16 a[232:233], v120 offset:24768
    ds_read_b64_tr_b16 a[234:235], v120 offset:30912
    v_mfma_f32_16x16x32_bf16 v[244:247], a[252:255], a[144:147], v[244:247]
    s_waitcnt lgkmcnt(8)
    v_mfma_f32_16x16x32_bf16 v[136:139], a[216:219], a[156:159], v[136:139]
    ds_read_b64_tr_b16 a[236:237], v121 offset:24768
    ds_read_b64_tr_b16 a[238:239], v121 offset:30912
    v_mfma_f32_16x16x32_bf16 v[140:143], a[216:219], a[160:163], v[140:143]
    buffer_load_dwordx4 a[104:107], v0, s[64:67], s31 offen offset:2048 sc1
    v_mfma_f32_16x16x32_bf16 v[144:147], a[216:219], a[164:167], v[144:147]
    s_waitcnt lgkmcnt(8)
    ds_read_b64_tr_b16 a[240:241], v122 offset:24768
    ds_read_b64_tr_b16 a[242:243], v122 offset:30912
    v_mfma_f32_16x16x32_bf16 v[156:159], a[220:223], a[164:167], v[156:159]
    v_mfma_f32_16x16x32_bf16 v[152:155], a[220:223], a[160:163], v[152:155]
    s_add_u32 s31, s90, 9216
    ds_read_b64_tr_b16 a[244:245], v123 offset:24768
    ds_read_b64_tr_b16 a[246:247], v123 offset:30912
    v_mfma_f32_16x16x32_bf16 v[148:151], a[220:223], a[156:159], v[148:151]
    s_waitcnt lgkmcnt(10)
    buffer_load_dwordx4 a[108:111], v0, s[64:67], s31 offen offset:0 sc1
    v_mfma_f32_16x16x32_bf16 v[160:163], a[224:227], a[156:159], v[160:163]
    ds_read_b64_tr_b16 a[248:249], v120 offset:24896
    ds_read_b64_tr_b16 a[250:251], v120 offset:31040
    v_mfma_f32_16x16x32_bf16 v[164:167], a[224:227], a[160:163], v[164:167]
    v_mfma_f32_16x16x32_bf16 v[168:171], a[224:227], a[164:167], v[168:171]
    s_waitcnt lgkmcnt(10)
    ds_read_b64_tr_b16 a[252:253], v121 offset:24896
    ds_read_b64_tr_b16 a[254:255], v121 offset:31040
    v_mfma_f32_16x16x32_bf16 v[180:183], a[228:231], a[164:167], v[180:183]
    buffer_load_dwordx4 a[112:115], v0, s[64:67], s31 offen offset:1024 sc1
    v_mfma_f32_16x16x32_bf16 v[176:179], a[228:231], a[160:163], v[176:179]
    v_mfma_f32_16x16x32_bf16 v[172:175], a[228:231], a[156:159], v[172:175]
    s_waitcnt lgkmcnt(10)
    buffer_load_dwordx4 a[116:119], v0, s[64:67], s31 offen offset:2048 sc1
    v_mfma_f32_16x16x32_bf16 v[184:187], a[232:235], a[156:159], v[184:187]
    v_mfma_f32_16x16x32_bf16 v[188:191], a[232:235], a[160:163], v[188:191]
    s_mov_b64 exec, 1
    buffer_store_dword v129, v7, s[80:83], 0 offen offset:8 sc1
    s_mov_b64 exec, -1
    v_mfma_f32_16x16x32_bf16 v[192:195], a[232:235], a[164:167], v[192:195]
    s_waitcnt lgkmcnt(8)
    v_mfma_f32_16x16x32_bf16 v[204:207], a[236:239], a[164:167], v[204:207]
    buffer_load_dwordx4 v35, s[60:63], s39 offen offset:2048  lds
    v_mfma_f32_16x16x32_bf16 v[200:203], a[236:239], a[160:163], v[200:203]
    v_mfma_f32_16x16x32_bf16 v[196:199], a[236:239], a[156:159], v[196:199]
    s_waitcnt lgkmcnt(6)
    v_mfma_f32_16x16x32_bf16 v[208:211], a[240:243], a[156:159], v[208:211]
    v_mfma_f32_16x16x32_bf16 v[212:215], a[240:243], a[160:163], v[212:215]
    s_waitcnt lgkmcnt(0)
    s_barrier
    v_mfma_f32_16x16x32_bf16 v[216:219], a[240:243], a[164:167], v[216:219]
    s_add_u32 s31, s91, 6144
    ds_read_b64_tr_b16 a[216:217], v116 offset:24640
    ds_read_b64_tr_b16 a[218:219], v116 offset:30784
    v_mfma_f32_16x16x32_bf16 v[228:231], a[244:247], a[164:167], v[228:231]
    buffer_load_dwordx4 a[168:171], v0, s[64:67], s31 offen offset:0 sc1
    v_mfma_f32_16x16x32_bf16 v[224:227], a[244:247], a[160:163], v[224:227]
    ds_read_b64_tr_b16 a[220:221], v117 offset:24640
    ds_read_b64_tr_b16 a[222:223], v117 offset:30784
    v_mfma_f32_16x16x32_bf16 v[220:223], a[244:247], a[156:159], v[220:223]
    v_mfma_f32_16x16x32_bf16 v[232:235], a[248:251], a[156:159], v[232:235]
    ds_read_b64_tr_b16 a[224:225], v118 offset:24640
    ds_read_b64_tr_b16 a[226:227], v118 offset:30784
    v_mfma_f32_16x16x32_bf16 v[236:239], a[248:251], a[160:163], v[236:239]
    buffer_load_dwordx4 a[172:175], v0, s[64:67], s31 offen offset:1024 sc1
    v_mfma_f32_16x16x32_bf16 v[240:243], a[248:251], a[164:167], v[240:243]
    ds_read_b64_tr_b16 a[228:229], v119 offset:24640
    ds_read_b64_tr_b16 a[230:231], v119 offset:30784
    v_mfma_f32_16x16x32_bf16 v[252:255], a[252:255], a[164:167], v[252:255]
    v_mfma_f32_16x16x32_bf16 v[248:251], a[252:255], a[160:163], v[248:251]
    ds_read_b64_tr_b16 a[232:233], v116 offset:24768
    ds_read_b64_tr_b16 a[234:235], v116 offset:30912
    v_mfma_f32_16x16x32_bf16 v[244:247], a[252:255], a[156:159], v[244:247]
    s_waitcnt vmcnt(16) lgkmcnt(8)
    v_mfma_f32_16x16x32_bf16 v[136:139], a[216:219], a[24:27], v[136:139]
    s_waitcnt vmcnt(15)
    ds_read_b64_tr_b16 a[236:237], v117 offset:24768
    ds_read_b64_tr_b16 a[238:239], v117 offset:30912
    v_mfma_f32_16x16x32_bf16 v[140:143], a[216:219], a[28:31], v[140:143]
    s_waitcnt vmcnt(14)
    buffer_load_dwordx4 a[176:179], v0, s[64:67], s31 offen offset:2048 sc1
    v_mfma_f32_16x16x32_bf16 v[144:147], a[216:219], a[32:35], v[144:147]
    s_waitcnt lgkmcnt(8)
    ds_read_b64_tr_b16 a[240:241], v118 offset:24768
    ds_read_b64_tr_b16 a[242:243], v118 offset:30912
    v_mfma_f32_16x16x32_bf16 v[156:159], a[220:223], a[32:35], v[156:159]
    v_mfma_f32_16x16x32_bf16 v[152:155], a[220:223], a[28:31], v[152:155]
    s_add_u32 s31, s91, 9216
    ds_read_b64_tr_b16 a[244:245], v119 offset:24768
    ds_read_b64_tr_b16 a[246:247], v119 offset:30912
    v_mfma_f32_16x16x32_bf16 v[148:151], a[220:223], a[24:27], v[148:151]
    s_waitcnt lgkmcnt(10)
    buffer_load_dwordx4 a[180:183], v0, s[64:67], s31 offen offset:0 sc1
    v_mfma_f32_16x16x32_bf16 v[160:163], a[224:227], a[24:27], v[160:163]
    ds_read_b64_tr_b16 a[248:249], v116 offset:24896
    ds_read_b64_tr_b16 a[250:251], v116 offset:31040
    v_mfma_f32_16x16x32_bf16 v[164:167], a[224:227], a[28:31], v[164:167]
    v_mfma_f32_16x16x32_bf16 v[168:171], a[224:227], a[32:35], v[168:171]
    s_waitcnt lgkmcnt(10)
    ds_read_b64_tr_b16 a[252:253], v117 offset:24896
    ds_read_b64_tr_b16 a[254:255], v117 offset:31040
    v_mfma_f32_16x16x32_bf16 v[180:183], a[228:231], a[32:35], v[180:183]
    buffer_load_dwordx4 a[184:187], v0, s[64:67], s31 offen offset:1024 sc1
    v_mfma_f32_16x16x32_bf16 v[176:179], a[228:231], a[28:31], v[176:179]
    v_mfma_f32_16x16x32_bf16 v[172:175], a[228:231], a[24:27], v[172:175]
    s_waitcnt lgkmcnt(10)
    buffer_load_dwordx4 a[188:191], v0, s[64:67], s31 offen offset:2048 sc1
    v_mfma_f32_16x16x32_bf16 v[184:187], a[232:235], a[24:27], v[184:187]
    s_add_u32 s39, s86, 163840
    s_add_u32 m0, s34, 24640
    v_mfma_f32_16x16x32_bf16 v[188:191], a[232:235], a[28:31], v[188:191]
    buffer_load_dwordx4 v33, s[60:63], s39 offen offset:0  lds
    v_mfma_f32_16x16x32_bf16 v[192:195], a[232:235], a[32:35], v[192:195]
    s_waitcnt lgkmcnt(8)
    v_mfma_f32_16x16x32_bf16 v[204:207], a[236:239], a[32:35], v[204:207]
    buffer_load_dwordx4 v34, s[60:63], s39 offen offset:1024  lds
    v_mfma_f32_16x16x32_bf16 v[200:203], a[236:239], a[28:31], v[200:203]
    v_mfma_f32_16x16x32_bf16 v[196:199], a[236:239], a[24:27], v[196:199]
    s_waitcnt lgkmcnt(6)
    v_mfma_f32_16x16x32_bf16 v[208:211], a[240:243], a[24:27], v[208:211]
    v_mfma_f32_16x16x32_bf16 v[212:215], a[240:243], a[28:31], v[212:215]
    s_waitcnt lgkmcnt(0)
    s_barrier
    v_mfma_f32_16x16x32_bf16 v[216:219], a[240:243], a[32:35], v[216:219]
    ds_read_b64_tr_b16 a[216:217], v116 offset:12320
    ds_read_b64_tr_b16 a[218:219], v116 offset:18464
    v_mfma_f32_16x16x32_bf16 v[228:231], a[244:247], a[32:35], v[228:231]
    v_mov_b32 v132, 1
    s_mov_b64 exec, 7
    v_mov_b32 v132, 0
    buffer_atomic_or v132, v125, s[80:83], 0 offen offset:8 sc0
    s_mov_b64 exec, -1
    v_mfma_f32_16x16x32_bf16 v[224:227], a[244:247], a[28:31], v[224:227]
    ds_read_b64_tr_b16 a[220:221], v117 offset:12320
    ds_read_b64_tr_b16 a[222:223], v117 offset:18464
    v_mfma_f32_16x16x32_bf16 v[220:223], a[244:247], a[24:27], v[220:223]
    v_mfma_f32_16x16x32_bf16 v[232:235], a[248:251], a[24:27], v[232:235]
    ds_read_b64_tr_b16 a[224:225], v118 offset:12320
    ds_read_b64_tr_b16 a[226:227], v118 offset:18464
    v_mfma_f32_16x16x32_bf16 v[236:239], a[248:251], a[28:31], v[236:239]
    buffer_load_dwordx4 v35, s[60:63], s39 offen offset:2048  lds
    v_mfma_f32_16x16x32_bf16 v[240:243], a[248:251], a[32:35], v[240:243]
    ds_read_b64_tr_b16 a[228:229], v119 offset:12320
    ds_read_b64_tr_b16 a[230:231], v119 offset:18464
    v_mfma_f32_16x16x32_bf16 v[252:255], a[252:255], a[32:35], v[252:255]
    v_mfma_f32_16x16x32_bf16 v[248:251], a[252:255], a[28:31], v[248:251]
    ds_read_b64_tr_b16 a[232:233], v116 offset:12448
    ds_read_b64_tr_b16 a[234:235], v116 offset:18592
    v_mfma_f32_16x16x32_bf16 v[244:247], a[252:255], a[24:27], v[244:247]
    s_waitcnt vmcnt(21) lgkmcnt(8)
    v_mfma_f32_16x16x32_bf16 v[136:139], a[216:219], a[36:39], v[136:139]
    s_waitcnt vmcnt(20)
    s_add_u32 s39, s86, 204800
    s_add_u32 m0, s34, 123200
    ds_read_b64_tr_b16 a[236:237], v117 offset:12448
    ds_read_b64_tr_b16 a[238:239], v117 offset:18592
    v_mfma_f32_16x16x32_bf16 v[140:143], a[216:219], a[40:43], v[140:143]
    s_waitcnt vmcnt(19)
    buffer_load_dwordx4 v33, s[60:63], s39 offen offset:0  lds
    v_mfma_f32_16x16x32_bf16 v[144:147], a[216:219], a[44:47], v[144:147]
    s_waitcnt lgkmcnt(8)
    ds_read_b64_tr_b16 a[240:241], v118 offset:12448
    ds_read_b64_tr_b16 a[242:243], v118 offset:18592
    v_mfma_f32_16x16x32_bf16 v[156:159], a[220:223], a[44:47], v[156:159]
    v_mfma_f32_16x16x32_bf16 v[152:155], a[220:223], a[40:43], v[152:155]
    ds_read_b64_tr_b16 a[244:245], v119 offset:12448
    ds_read_b64_tr_b16 a[246:247], v119 offset:18592
    v_mfma_f32_16x16x32_bf16 v[148:151], a[220:223], a[36:39], v[148:151]
    s_waitcnt lgkmcnt(10)
    buffer_load_dwordx4 v34, s[60:63], s39 offen offset:1024  lds
    v_mfma_f32_16x16x32_bf16 v[160:163], a[224:227], a[36:39], v[160:163]
    ds_read_b64_tr_b16 a[248:249], v116 offset:12576
    ds_read_b64_tr_b16 a[250:251], v116 offset:18720
    v_mfma_f32_16x16x32_bf16 v[164:167], a[224:227], a[40:43], v[164:167]
    v_mfma_f32_16x16x32_bf16 v[168:171], a[224:227], a[44:47], v[168:171]
    s_waitcnt lgkmcnt(10)
    ds_read_b64_tr_b16 a[252:253], v117 offset:12576
    ds_read_b64_tr_b16 a[254:255], v117 offset:18720
    v_mfma_f32_16x16x32_bf16 v[180:183], a[228:231], a[44:47], v[180:183]
    buffer_load_dwordx4 v35, s[60:63], s39 offen offset:2048  lds
    v_mfma_f32_16x16x32_bf16 v[176:179], a[228:231], a[40:43], v[176:179]
    s_add_u32 s39, s87, 163840
    s_add_u32 m0, s34, 36960
    v_mfma_f32_16x16x32_bf16 v[172:175], a[228:231], a[36:39], v[172:175]
    s_waitcnt lgkmcnt(10)
    buffer_load_dwordx4 v33, s[60:63], s39 offen offset:0  lds
    v_mfma_f32_16x16x32_bf16 v[184:187], a[232:235], a[36:39], v[184:187]
    v_mfma_f32_16x16x32_bf16 v[188:191], a[232:235], a[40:43], v[188:191]
    buffer_load_dwordx4 v34, s[60:63], s39 offen offset:1024  lds
    v_mfma_f32_16x16x32_bf16 v[192:195], a[232:235], a[44:47], v[192:195]
    s_waitcnt lgkmcnt(8)
    v_mfma_f32_16x16x32_bf16 v[204:207], a[236:239], a[44:47], v[204:207]
    buffer_load_dwordx4 v35, s[60:63], s39 offen offset:2048  lds
    v_mfma_f32_16x16x32_bf16 v[200:203], a[236:239], a[40:43], v[200:203]
    v_mfma_f32_16x16x32_bf16 v[196:199], a[236:239], a[36:39], v[196:199]
    s_waitcnt lgkmcnt(6)
    v_mfma_f32_16x16x32_bf16 v[208:211], a[240:243], a[36:39], v[208:211]
    v_mfma_f32_16x16x32_bf16 v[212:215], a[240:243], a[40:43], v[212:215]
    s_waitcnt lgkmcnt(0)
    s_barrier
    v_mfma_f32_16x16x32_bf16 v[216:219], a[240:243], a[44:47], v[216:219]
    ds_read_b64_tr_b16 a[216:217], v112 offset:49280
    ds_read_b64_tr_b16 a[218:219], v112 offset:55424
    v_mfma_f32_16x16x32_bf16 v[228:231], a[244:247], a[44:47], v[228:231]
    s_waitcnt vmcnt(7)
    v_cmp_eq_u32 vcc, 1, v132
    s_nop 0
    s_cmp_eq_u64 vcc, exec
    s_cbranch_scc0 L_F1_2_SPIN
L_F1_2_OK:
    v_mfma_f32_16x16x32_bf16 v[224:227], a[244:247], a[40:43], v[224:227]
    ds_read_b64_tr_b16 a[220:221], v113 offset:49280
    ds_read_b64_tr_b16 a[222:223], v113 offset:55424
    v_mfma_f32_16x16x32_bf16 v[220:223], a[244:247], a[36:39], v[220:223]
    v_mfma_f32_16x16x32_bf16 v[232:235], a[248:251], a[36:39], v[232:235]
    s_add_u32 s31, s89, 12288
    ds_read_b64_tr_b16 a[224:225], v114 offset:49280
    ds_read_b64_tr_b16 a[226:227], v114 offset:55424
    v_mfma_f32_16x16x32_bf16 v[236:239], a[248:251], a[40:43], v[236:239]
    buffer_load_dwordx4 a[48:51], v0, s[64:67], s31 offen offset:0 sc1
    v_mfma_f32_16x16x32_bf16 v[240:243], a[248:251], a[44:47], v[240:243]
    ds_read_b64_tr_b16 a[228:229], v115 offset:49280
    ds_read_b64_tr_b16 a[230:231], v115 offset:55424
    v_mfma_f32_16x16x32_bf16 v[252:255], a[252:255], a[44:47], v[252:255]
    v_mfma_f32_16x16x32_bf16 v[248:251], a[252:255], a[40:43], v[248:251]
    ds_read_b64_tr_b16 a[232:233], v112 offset:49408
    ds_read_b64_tr_b16 a[234:235], v112 offset:55552
    v_mfma_f32_16x16x32_bf16 v[244:247], a[252:255], a[36:39], v[244:247]
    s_waitcnt lgkmcnt(8)
    v_mfma_f32_16x16x32_bf16 v[136:139], a[216:219], a[96:99], v[136:139]
    ds_read_b64_tr_b16 a[236:237], v113 offset:49408
    ds_read_b64_tr_b16 a[238:239], v113 offset:55552
    v_mfma_f32_16x16x32_bf16 v[140:143], a[216:219], a[100:103], v[140:143]
    buffer_load_dwordx4 a[52:55], v0, s[64:67], s31 offen offset:1024 sc1
    v_mfma_f32_16x16x32_bf16 v[144:147], a[216:219], a[104:107], v[144:147]
    s_waitcnt lgkmcnt(8)
    ds_read_b64_tr_b16 a[240:241], v114 offset:49408
    ds_read_b64_tr_b16 a[242:243], v114 offset:55552
    v_mfma_f32_16x16x32_bf16 v[156:159], a[220:223], a[104:107], v[156:159]
    v_mfma_f32_16x16x32_bf16 v[152:155], a[220:223], a[100:103], v[152:155]
    ds_read_b64_tr_b16 a[244:245], v115 offset:49408
    ds_read_b64_tr_b16 a[246:247], v115 offset:55552
    v_mfma_f32_16x16x32_bf16 v[148:151], a[220:223], a[96:99], v[148:151]
    s_waitcnt lgkmcnt(10)
    buffer_load_dwordx4 a[56:59], v0, s[64:67], s31 offen offset:2048 sc1
    v_mfma_f32_16x16x32_bf16 v[160:163], a[224:227], a[96:99], v[160:163]
    ds_read_b64_tr_b16 a[248:249], v112 offset:49536
    ds_read_b64_tr_b16 a[250:251], v112 offset:55680
    v_mfma_f32_16x16x32_bf16 v[164:167], a[224:227], a[100:103], v[164:167]
    v_mfma_f32_16x16x32_bf16 v[168:171], a[224:227], a[104:107], v[168:171]
    s_waitcnt lgkmcnt(10)
    s_add_u32 s31, s89, 15360
    ds_read_b64_tr_b16 a[252:253], v113 offset:49536
    ds_read_b64_tr_b16 a[254:255], v113 offset:55680
    v_mfma_f32_16x16x32_bf16 v[180:183], a[228:231], a[104:107], v[180:183]
    buffer_load_dwordx4 a[60:63], v0, s[64:67], s31 offen offset:0 sc1
    v_mfma_f32_16x16x32_bf16 v[176:179], a[228:231], a[100:103], v[176:179]
    v_mfma_f32_16x16x32_bf16 v[172:175], a[228:231], a[96:99], v[172:175]
    s_waitcnt lgkmcnt(10)
    buffer_load_dwordx4 a[64:67], v0, s[64:67], s31 offen offset:1024 sc1
    v_mfma_f32_16x16x32_bf16 v[184:187], a[232:235], a[96:99], v[184:187]
    v_mfma_f32_16x16x32_bf16 v[188:191], a[232:235], a[100:103], v[188:191]
    buffer_load_dwordx4 a[68:71], v0, s[64:67], s31 offen offset:2048 sc1
    v_mfma_f32_16x16x32_bf16 v[192:195], a[232:235], a[104:107], v[192:195]
    s_waitcnt lgkmcnt(8)
    s_add_u32 s31, s90, 12288
    v_mfma_f32_16x16x32_bf16 v[204:207], a[236:239], a[104:107], v[204:207]
    buffer_load_dwordx4 a[120:123], v0, s[64:67], s31 offen offset:0 sc1
    v_mfma_f32_16x16x32_bf16 v[200:203], a[236:239], a[100:103], v[200:203]
    v_mfma_f32_16x16x32_bf16 v[196:199], a[236:239], a[96:99], v[196:199]
    s_waitcnt lgkmcnt(6)
    v_mfma_f32_16x16x32_bf16 v[208:211], a[240:243], a[96:99], v[208:211]
    v_mfma_f32_16x16x32_bf16 v[212:215], a[240:243], a[100:103], v[212:215]
    s_waitcnt lgkmcnt(0)
    s_barrier
    v_mfma_f32_16x16x32_bf16 v[216:219], a[240:243], a[104:107], v[216:219]
    ds_read_b64_tr_b16 a[216:217], v116 offset:0
    ds_read_b64_tr_b16 a[218:219], v116 offset:6144
    v_mfma_f32_16x16x32_bf16 v[228:231], a[244:247], a[104:107], v[228:231]
    buffer_load_dwordx4 a[124:127], v0, s[64:67], s31 offen offset:1024 sc1
    v_mfma_f32_16x16x32_bf16 v[224:227], a[244:247], a[100:103], v[224:227]
    ds_read_b64_tr_b16 a[220:221], v117 offset:0
    ds_read_b64_tr_b16 a[222:223], v117 offset:6144
    v_mfma_f32_16x16x32_bf16 v[220:223], a[244:247], a[96:99], v[220:223]
    v_mfma_f32_16x16x32_bf16 v[232:235], a[248:251], a[96:99], v[232:235]
    ds_read_b64_tr_b16 a[224:225], v118 offset:0
    ds_read_b64_tr_b16 a[226:227], v118 offset:6144
    v_mfma_f32_16x16x32_bf16 v[236:239], a[248:251], a[100:103], v[236:239]
    buffer_load_dwordx4 a[128:131], v0, s[64:67], s31 offen offset:2048 sc1
    v_mfma_f32_16x16x32_bf16 v[240:243], a[248:251], a[104:107], v[240:243]
    ds_read_b64_tr_b16 a[228:229], v119 offset:0
    ds_read_b64_tr_b16 a[230:231], v119 offset:6144
    v_mfma_f32_16x16x32_bf16 v[252:255], a[252:255], a[104:107], v[252:255]
    v_mfma_f32_16x16x32_bf16 v[248:251], a[252:255], a[100:103], v[248:251]
    ds_read_b64_tr_b16 a[232:233], v116 offset:128
    ds_read_b64_tr_b16 a[234:235], v116 offset:6272
    v_mfma_f32_16x16x32_bf16 v[244:247], a[252:255], a[96:99], v[244:247]
    s_waitcnt lgkmcnt(8)
    v_mfma_f32_16x16x32_bf16 v[136:139], a[216:219], a[108:111], v[136:139]
    s_add_u32 s39, s87, 204800
    s_add_u32 m0, s34, 135520
    ds_read_b64_tr_b16 a[236:237], v117 offset:128
    ds_read_b64_tr_b16 a[238:239], v117 offset:6272
    v_mfma_f32_16x16x32_bf16 v[140:143], a[216:219], a[112:115], v[140:143]
    buffer_load_dwordx4 v33, s[60:63], s39 offen offset:0  lds
    v_mfma_f32_16x16x32_bf16 v[144:147], a[216:219], a[116:119], v[144:147]
    s_waitcnt lgkmcnt(8)
    ds_read_b64_tr_b16 a[240:241], v118 offset:128
    ds_read_b64_tr_b16 a[242:243], v118 offset:6272
    v_mfma_f32_16x16x32_bf16 v[156:159], a[220:223], a[116:119], v[156:159]
    v_mfma_f32_16x16x32_bf16 v[152:155], a[220:223], a[112:115], v[152:155]
    ds_read_b64_tr_b16 a[244:245], v119 offset:128
    ds_read_b64_tr_b16 a[246:247], v119 offset:6272
    v_mfma_f32_16x16x32_bf16 v[148:151], a[220:223], a[108:111], v[148:151]
    s_waitcnt lgkmcnt(10)
    buffer_load_dwordx4 v34, s[60:63], s39 offen offset:1024  lds
    v_mfma_f32_16x16x32_bf16 v[160:163], a[224:227], a[108:111], v[160:163]
    ds_read_b64_tr_b16 a[248:249], v116 offset:256
    ds_read_b64_tr_b16 a[250:251], v116 offset:6400
    v_mfma_f32_16x16x32_bf16 v[164:167], a[224:227], a[112:115], v[164:167]
    v_mfma_f32_16x16x32_bf16 v[168:171], a[224:227], a[116:119], v[168:171]
    s_waitcnt lgkmcnt(10)
    ds_read_b64_tr_b16 a[252:253], v117 offset:256
    ds_read_b64_tr_b16 a[254:255], v117 offset:6400
    v_mfma_f32_16x16x32_bf16 v[180:183], a[228:231], a[116:119], v[180:183]
    buffer_load_dwordx4 v35, s[60:63], s39 offen offset:2048  lds
    v_mfma_f32_16x16x32_bf16 v[176:179], a[228:231], a[112:115], v[176:179]
    s_add_u32 s31, s90, 15360
    v_mfma_f32_16x16x32_bf16 v[172:175], a[228:231], a[108:111], v[172:175]
    s_waitcnt lgkmcnt(10)
    buffer_load_dwordx4 a[132:135], v0, s[64:67], s31 offen offset:0 sc1
    v_mfma_f32_16x16x32_bf16 v[184:187], a[232:235], a[108:111], v[184:187]
    v_mfma_f32_16x16x32_bf16 v[188:191], a[232:235], a[112:115], v[188:191]
    buffer_load_dwordx4 a[136:139], v0, s[64:67], s31 offen offset:1024 sc1
    v_mfma_f32_16x16x32_bf16 v[192:195], a[232:235], a[116:119], v[192:195]
    s_waitcnt lgkmcnt(8)
    v_mfma_f32_16x16x32_bf16 v[204:207], a[236:239], a[116:119], v[204:207]
    buffer_load_dwordx4 a[140:143], v0, s[64:67], s31 offen offset:2048 sc1
    v_mfma_f32_16x16x32_bf16 v[200:203], a[236:239], a[112:115], v[200:203]
    v_mfma_f32_16x16x32_bf16 v[196:199], a[236:239], a[108:111], v[196:199]
    s_waitcnt lgkmcnt(6)
    v_mfma_f32_16x16x32_bf16 v[208:211], a[240:243], a[108:111], v[208:211]
    v_mfma_f32_16x16x32_bf16 v[212:215], a[240:243], a[112:115], v[212:215]
    s_waitcnt lgkmcnt(0)
    s_barrier
    v_mfma_f32_16x16x32_bf16 v[216:219], a[240:243], a[116:119], v[216:219]
    s_add_u32 s31, s91, 12288
    ds_read_b64_tr_b16 a[216:217], v112 offset:0
    ds_read_b64_tr_b16 a[218:219], v112 offset:6144
    v_mfma_f32_16x16x32_bf16 v[228:231], a[244:247], a[116:119], v[228:231]
    buffer_load_dwordx4 a[192:195], v0, s[64:67], s31 offen offset:0 sc1
    v_mfma_f32_16x16x32_bf16 v[224:227], a[244:247], a[112:115], v[224:227]
    ds_read_b64_tr_b16 a[220:221], v113 offset:0
    ds_read_b64_tr_b16 a[222:223], v113 offset:6144
    v_mfma_f32_16x16x32_bf16 v[220:223], a[244:247], a[108:111], v[220:223]
    v_mfma_f32_16x16x32_bf16 v[232:235], a[248:251], a[108:111], v[232:235]
    ds_read_b64_tr_b16 a[224:225], v114 offset:0
    ds_read_b64_tr_b16 a[226:227], v114 offset:6144
    v_mfma_f32_16x16x32_bf16 v[236:239], a[248:251], a[112:115], v[236:239]
    buffer_load_dwordx4 a[196:199], v0, s[64:67], s31 offen offset:1024 sc1
    v_mfma_f32_16x16x32_bf16 v[240:243], a[248:251], a[116:119], v[240:243]
    ds_read_b64_tr_b16 a[228:229], v115 offset:0
    ds_read_b64_tr_b16 a[230:231], v115 offset:6144
    v_mfma_f32_16x16x32_bf16 v[252:255], a[252:255], a[116:119], v[252:255]
    v_mfma_f32_16x16x32_bf16 v[248:251], a[252:255], a[112:115], v[248:251]
    ds_read_b64_tr_b16 a[232:233], v112 offset:128
    ds_read_b64_tr_b16 a[234:235], v112 offset:6272
    v_mfma_f32_16x16x32_bf16 v[244:247], a[252:255], a[108:111], v[244:247]
    s_waitcnt lgkmcnt(8)
    v_mfma_f32_16x16x32_bf16 v[136:139], a[216:219], a[168:171], v[136:139]
    ds_read_b64_tr_b16 a[236:237], v113 offset:128
    ds_read_b64_tr_b16 a[238:239], v113 offset:6272
    v_mfma_f32_16x16x32_bf16 v[140:143], a[216:219], a[172:175], v[140:143]
    buffer_load_dwordx4 a[200:203], v0, s[64:67], s31 offen offset:2048 sc1
    v_mfma_f32_16x16x32_bf16 v[144:147], a[216:219], a[176:179], v[144:147]
    s_waitcnt lgkmcnt(8)
    ds_read_b64_tr_b16 a[240:241], v114 offset:128
    ds_read_b64_tr_b16 a[242:243], v114 offset:6272
    v_mfma_f32_16x16x32_bf16 v[156:159], a[220:223], a[176:179], v[156:159]
    v_mfma_f32_16x16x32_bf16 v[152:155], a[220:223], a[172:175], v[152:155]
    ds_read_b64_tr_b16 a[244:245], v115 offset:128
    ds_read_b64_tr_b16 a[246:247], v115 offset:6272
    v_mfma_f32_16x16x32_bf16 v[148:151], a[220:223], a[168:171], v[148:151]
    s_waitcnt lgkmcnt(10)
    v_mfma_f32_16x16x32_bf16 v[160:163], a[224:227], a[168:171], v[160:163]
    s_add_u32 s31, s91, 15360
    ds_read_b64_tr_b16 a[248:249], v112 offset:256
    ds_read_b64_tr_b16 a[250:251], v112 offset:6400
    v_mfma_f32_16x16x32_bf16 v[164:167], a[224:227], a[172:175], v[164:167]
    buffer_load_dwordx4 a[204:207], v0, s[64:67], s31 offen offset:0 sc1
    v_mfma_f32_16x16x32_bf16 v[168:171], a[224:227], a[176:179], v[168:171]
    s_waitcnt lgkmcnt(10)
    ds_read_b64_tr_b16 a[252:253], v113 offset:256
    ds_read_b64_tr_b16 a[254:255], v113 offset:6400
    v_mfma_f32_16x16x32_bf16 v[180:183], a[228:231], a[176:179], v[180:183]
    v_mfma_f32_16x16x32_bf16 v[176:179], a[228:231], a[172:175], v[176:179]
    v_mfma_f32_16x16x32_bf16 v[172:175], a[228:231], a[168:171], v[172:175]
    s_waitcnt lgkmcnt(10)
    buffer_load_dwordx4 a[208:211], v0, s[64:67], s31 offen offset:1024 sc1
    v_mfma_f32_16x16x32_bf16 v[184:187], a[232:235], a[168:171], v[184:187]
    v_mfma_f32_16x16x32_bf16 v[188:191], a[232:235], a[172:175], v[188:191]
    v_mfma_f32_16x16x32_bf16 v[192:195], a[232:235], a[176:179], v[192:195]
    s_waitcnt lgkmcnt(8)
    buffer_load_dwordx4 a[212:215], v0, s[64:67], s31 offen offset:2048 sc1
    v_mfma_f32_16x16x32_bf16 v[204:207], a[236:239], a[176:179], v[204:207]
    v_mfma_f32_16x16x32_bf16 v[200:203], a[236:239], a[172:175], v[200:203]
    v_mfma_f32_16x16x32_bf16 v[196:199], a[236:239], a[168:171], v[196:199]
    s_waitcnt lgkmcnt(6)
    v_mfma_f32_16x16x32_bf16 v[208:211], a[240:243], a[168:171], v[208:211]
    v_mfma_f32_16x16x32_bf16 v[212:215], a[240:243], a[172:175], v[212:215]
    s_waitcnt lgkmcnt(0)
    s_barrier
    v_mfma_f32_16x16x32_bf16 v[216:219], a[240:243], a[176:179], v[216:219]
    ds_read_b64_tr_b16 a[216:217], v116 offset:36960
    ds_read_b64_tr_b16 a[218:219], v116 offset:43104
    v_mfma_f32_16x16x32_bf16 v[228:231], a[244:247], a[176:179], v[228:231]
    v_mfma_f32_16x16x32_bf16 v[224:227], a[244:247], a[172:175], v[224:227]
    ds_read_b64_tr_b16 a[220:221], v117 offset:36960
    ds_read_b64_tr_b16 a[222:223], v117 offset:43104
    v_mfma_f32_16x16x32_bf16 v[220:223], a[244:247], a[168:171], v[220:223]
    v_mfma_f32_16x16x32_bf16 v[232:235], a[248:251], a[168:171], v[232:235]
    ds_read_b64_tr_b16 a[224:225], v118 offset:36960
    ds_read_b64_tr_b16 a[226:227], v118 offset:43104
    v_mfma_f32_16x16x32_bf16 v[236:239], a[248:251], a[172:175], v[236:239]
    v_mfma_f32_16x16x32_bf16 v[240:243], a[248:251], a[176:179], v[240:243]
    ds_read_b64_tr_b16 a[228:229], v119 offset:36960
    ds_read_b64_tr_b16 a[230:231], v119 offset:43104
    v_mfma_f32_16x16x32_bf16 v[252:255], a[252:255], a[176:179], v[252:255]
    v_mfma_f32_16x16x32_bf16 v[248:251], a[252:255], a[172:175], v[248:251]
    ds_read_b64_tr_b16 a[232:233], v116 offset:37088
    ds_read_b64_tr_b16 a[234:235], v116 offset:43232
    v_mfma_f32_16x16x32_bf16 v[244:247], a[252:255], a[168:171], v[244:247]
    s_waitcnt lgkmcnt(8)
    v_mfma_f32_16x16x32_bf16 v[136:139], a[216:219], a[180:183], v[136:139]
    ds_read_b64_tr_b16 a[236:237], v117 offset:37088
    ds_read_b64_tr_b16 a[238:239], v117 offset:43232
    v_mfma_f32_16x16x32_bf16 v[140:143], a[216:219], a[184:187], v[140:143]
    v_mfma_f32_16x16x32_bf16 v[144:147], a[216:219], a[188:191], v[144:147]
    s_waitcnt lgkmcnt(8)
    ds_read_b64_tr_b16 a[240:241], v118 offset:37088
    ds_read_b64_tr_b16 a[242:243], v118 offset:43232
    v_mfma_f32_16x16x32_bf16 v[156:159], a[220:223], a[188:191], v[156:159]
    v_mfma_f32_16x16x32_bf16 v[152:155], a[220:223], a[184:187], v[152:155]
    ds_read_b64_tr_b16 a[244:245], v119 offset:37088
    ds_read_b64_tr_b16 a[246:247], v119 offset:43232
    v_mfma_f32_16x16x32_bf16 v[148:151], a[220:223], a[180:183], v[148:151]
    s_waitcnt lgkmcnt(10)
    v_mfma_f32_16x16x32_bf16 v[160:163], a[224:227], a[180:183], v[160:163]
    ds_read_b64_tr_b16 a[248:249], v116 offset:37216
    ds_read_b64_tr_b16 a[250:251], v116 offset:43360
    v_mfma_f32_16x16x32_bf16 v[164:167], a[224:227], a[184:187], v[164:167]
    v_mfma_f32_16x16x32_bf16 v[168:171], a[224:227], a[188:191], v[168:171]
    s_waitcnt lgkmcnt(10)
    ds_read_b64_tr_b16 a[252:253], v117 offset:37216
    ds_read_b64_tr_b16 a[254:255], v117 offset:43360
    v_mfma_f32_16x16x32_bf16 v[180:183], a[228:231], a[188:191], v[180:183]
    v_mfma_f32_16x16x32_bf16 v[176:179], a[228:231], a[184:187], v[176:179]
    v_mfma_f32_16x16x32_bf16 v[172:175], a[228:231], a[180:183], v[172:175]
    s_waitcnt lgkmcnt(10)
    v_mfma_f32_16x16x32_bf16 v[184:187], a[232:235], a[180:183], v[184:187]
    v_mfma_f32_16x16x32_bf16 v[188:191], a[232:235], a[184:187], v[188:191]
    v_mfma_f32_16x16x32_bf16 v[192:195], a[232:235], a[188:191], v[192:195]
    s_waitcnt lgkmcnt(8)
    v_mfma_f32_16x16x32_bf16 v[204:207], a[236:239], a[188:191], v[204:207]
    v_mfma_f32_16x16x32_bf16 v[200:203], a[236:239], a[184:187], v[200:203]
    v_mfma_f32_16x16x32_bf16 v[196:199], a[236:239], a[180:183], v[196:199]
    s_waitcnt lgkmcnt(6)
    v_mfma_f32_16x16x32_bf16 v[208:211], a[240:243], a[180:183], v[208:211]
    v_mfma_f32_16x16x32_bf16 v[212:215], a[240:243], a[184:187], v[212:215]
    s_waitcnt vmcnt(9) lgkmcnt(0)
    s_barrier
    v_mfma_f32_16x16x32_bf16 v[216:219], a[240:243], a[188:191], v[216:219]
    ds_read_b64_tr_b16 a[216:217], v112 offset:12320
    ds_read_b64_tr_b16 a[218:219], v112 offset:18464
    v_mfma_f32_16x16x32_bf16 v[228:231], a[244:247], a[188:191], v[228:231]
    v_mfma_f32_16x16x32_bf16 v[224:227], a[244:247], a[184:187], v[224:227]
    ds_read_b64_tr_b16 a[220:221], v113 offset:12320
    ds_read_b64_tr_b16 a[222:223], v113 offset:18464
    v_mfma_f32_16x16x32_bf16 v[220:223], a[244:247], a[180:183], v[220:223]
    v_mfma_f32_16x16x32_bf16 v[232:235], a[248:251], a[180:183], v[232:235]
    ds_read_b64_tr_b16 a[224:225], v116 offset:49280
    ds_read_b64_tr_b16 a[226:227], v116 offset:55424
    v_mfma_f32_16x16x32_bf16 v[236:239], a[248:251], a[184:187], v[236:239]
    v_mfma_f32_16x16x32_bf16 v[240:243], a[248:251], a[188:191], v[240:243]
    v_mfma_f32_16x16x32_bf16 v[252:255], a[252:255], a[188:191], v[252:255]
    v_mfma_f32_16x16x32_bf16 v[248:251], a[252:255], a[184:187], v[248:251]
    v_mfma_f32_16x16x32_bf16 v[244:247], a[252:255], a[180:183], v[244:247]
    s_waitcnt lgkmcnt(4)
    v_mfma_f32_16x16x32_bf16 v[136:139], a[216:219], a[48:51], v[136:139]
    ds_read_b64_tr_b16 a[228:229], v117 offset:49280
    ds_read_b64_tr_b16 a[230:231], v117 offset:55424
    v_mfma_f32_16x16x32_bf16 v[140:143], a[216:219], a[52:55], v[140:143]
    v_mfma_f32_16x16x32_bf16 v[144:147], a[216:219], a[56:59], v[144:147]
    s_waitcnt lgkmcnt(4)
    v_mfma_f32_16x16x32_bf16 v[156:159], a[220:223], a[56:59], v[156:159]
    ds_read_b64_tr_b16 a[232:233], v112 offset:24640
    ds_read_b64_tr_b16 a[234:235], v112 offset:30784
    v_mfma_f32_16x16x32_bf16 v[152:155], a[220:223], a[52:55], v[152:155]
    v_mfma_f32_16x16x32_bf16 v[148:151], a[220:223], a[48:51], v[148:151]
    s_waitcnt lgkmcnt(4)
    v_mfma_f32_16x16x32_bf16 v[136:139], a[224:227], a[60:63], v[136:139]
    ds_read_b64_tr_b16 a[236:237], v113 offset:24640
    ds_read_b64_tr_b16 a[238:239], v113 offset:30784
    v_mfma_f32_16x16x32_bf16 v[140:143], a[224:227], a[64:67], v[140:143]
    v_mfma_f32_16x16x32_bf16 v[144:147], a[224:227], a[68:71], v[144:147]
    s_waitcnt lgkmcnt(4)
    v_mfma_f32_16x16x32_bf16 v[156:159], a[228:231], a[68:71], v[156:159]
    ds_read_b64_tr_b16 a[240:241], v120 offset:0
    ds_read_b64_tr_b16 a[242:243], v120 offset:6144
    v_mfma_f32_16x16x32_bf16 v[152:155], a[228:231], a[64:67], v[152:155]
    v_mfma_f32_16x16x32_bf16 v[148:151], a[228:231], a[60:63], v[148:151]
    s_waitcnt lgkmcnt(4)
    v_mfma_f32_16x16x32_bf16 v[136:139], a[232:235], a[120:123], v[136:139]
    ds_read_b64_tr_b16 a[244:245], v121 offset:0
    ds_read_b64_tr_b16 a[246:247], v121 offset:6144
    v_mfma_f32_16x16x32_bf16 v[140:143], a[232:235], a[124:127], v[140:143]
    v_mfma_f32_16x16x32_bf16 v[144:147], a[232:235], a[128:131], v[144:147]
    s_waitcnt lgkmcnt(4)
    v_mfma_f32_16x16x32_bf16 v[156:159], a[236:239], a[128:131], v[156:159]
    ds_read_b64_tr_b16 a[248:249], v112 offset:36960
    ds_read_b64_tr_b16 a[250:251], v112 offset:43104
    v_mfma_f32_16x16x32_bf16 v[152:155], a[236:239], a[124:127], v[152:155]
    v_mfma_f32_16x16x32_bf16 v[148:151], a[236:239], a[120:123], v[148:151]
    s_waitcnt vmcnt(8) lgkmcnt(4)
    v_mfma_f32_16x16x32_bf16 v[136:139], a[240:243], a[132:135], v[136:139]
    s_waitcnt vmcnt(7)
    ds_read_b64_tr_b16 a[252:253], v113 offset:36960
    ds_read_b64_tr_b16 a[254:255], v113 offset:43104
    v_mfma_f32_16x16x32_bf16 v[140:143], a[240:243], a[136:139], v[140:143]
    s_waitcnt vmcnt(6)
    v_mfma_f32_16x16x32_bf16 v[144:147], a[240:243], a[140:143], v[144:147]
    s_waitcnt lgkmcnt(4)
    v_mfma_f32_16x16x32_bf16 v[156:159], a[244:247], a[140:143], v[156:159]
    ds_read_b64_tr_b16 a[216:217], v120 offset:12320
    ds_read_b64_tr_b16 a[218:219], v120 offset:18464
    v_mfma_f32_16x16x32_bf16 v[152:155], a[244:247], a[136:139], v[152:155]
    v_mfma_f32_16x16x32_bf16 v[148:151], a[244:247], a[132:135], v[148:151]
    s_waitcnt vmcnt(5) lgkmcnt(4)
    v_mfma_f32_16x16x32_bf16 v[136:139], a[248:251], a[192:195], v[136:139]
    s_waitcnt vmcnt(4)
    ds_read_b64_tr_b16 a[220:221], v121 offset:12320
    ds_read_b64_tr_b16 a[222:223], v121 offset:18464
    v_mfma_f32_16x16x32_bf16 v[140:143], a[248:251], a[196:199], v[140:143]
    s_waitcnt vmcnt(3)
    v_mfma_f32_16x16x32_bf16 v[144:147], a[248:251], a[200:203], v[144:147]
    s_waitcnt lgkmcnt(4)
    v_mfma_f32_16x16x32_bf16 v[156:159], a[252:255], a[200:203], v[156:159]
    ds_read_b64_tr_b16 a[224:225], v114 offset:12320
    ds_read_b64_tr_b16 a[226:227], v114 offset:18464
    v_mfma_f32_16x16x32_bf16 v[152:155], a[252:255], a[196:199], v[152:155]
    v_mfma_f32_16x16x32_bf16 v[148:151], a[252:255], a[192:195], v[148:151]
    s_waitcnt vmcnt(2) lgkmcnt(4)
    v_mfma_f32_16x16x32_bf16 v[136:139], a[216:219], a[204:207], v[136:139]
    s_waitcnt vmcnt(1)
    ds_read_b64_tr_b16 a[228:229], v115 offset:12320
    ds_read_b64_tr_b16 a[230:231], v115 offset:18464
    v_mfma_f32_16x16x32_bf16 v[140:143], a[216:219], a[208:211], v[140:143]
    s_waitcnt vmcnt(0)
    v_mfma_f32_16x16x32_bf16 v[144:147], a[216:219], a[212:215], v[144:147]
    s_waitcnt lgkmcnt(4)
    v_mfma_f32_16x16x32_bf16 v[156:159], a[220:223], a[212:215], v[156:159]
    ds_read_b64_tr_b16 a[232:233], v118 offset:49280
    ds_read_b64_tr_b16 a[234:235], v118 offset:55424
    v_mfma_f32_16x16x32_bf16 v[152:155], a[220:223], a[208:211], v[152:155]
    v_mfma_f32_16x16x32_bf16 v[148:151], a[220:223], a[204:207], v[148:151]
    s_waitcnt lgkmcnt(4)
    v_mfma_f32_16x16x32_bf16 v[160:163], a[224:227], a[48:51], v[160:163]
    ds_read_b64_tr_b16 a[236:237], v119 offset:49280
    ds_read_b64_tr_b16 a[238:239], v119 offset:55424
    v_mfma_f32_16x16x32_bf16 v[164:167], a[224:227], a[52:55], v[164:167]
    v_mfma_f32_16x16x32_bf16 v[168:171], a[224:227], a[56:59], v[168:171]
    s_waitcnt lgkmcnt(4)
    v_mfma_f32_16x16x32_bf16 v[180:183], a[228:231], a[56:59], v[180:183]
    ds_read_b64_tr_b16 a[240:241], v114 offset:24640
    ds_read_b64_tr_b16 a[242:243], v114 offset:30784
    v_mfma_f32_16x16x32_bf16 v[176:179], a[228:231], a[52:55], v[176:179]
    v_cvt_pk_bf16_f32 v40, v136, v137
    v_cvt_pk_bf16_f32 v41, v138, v139
    v_mfma_f32_16x16x32_bf16 v[172:175], a[228:231], a[48:51], v[172:175]
    s_waitcnt lgkmcnt(4)
    v_cvt_pk_bf16_f32 v42, v148, v149
    v_cvt_pk_bf16_f32 v43, v150, v151
    v_mfma_f32_16x16x32_bf16 v[160:163], a[232:235], a[60:63], v[160:163]
    s_mov_b32 s38, 0
    ds_read_b64_tr_b16 a[244:245], v115 offset:24640
    ds_read_b64_tr_b16 a[246:247], v115 offset:30784
    v_mfma_f32_16x16x32_bf16 v[164:167], a[232:235], a[64:67], v[164:167]
    s_cmp_eq_u32 s28, 0
    s_cbranch_scc1 L_PST0
    buffer_store_dwordx4 v[40:43], v0, s[68:71], s38 offen offset:0 sc1
L_PST0:
    v_mfma_f32_16x16x32_bf16 v[168:171], a[232:235], a[68:71], v[168:171]
    s_waitcnt lgkmcnt(4)
    v_cvt_pk_bf16_f32 v44, v140, v141
    v_cvt_pk_bf16_f32 v45, v142, v143
    v_mfma_f32_16x16x32_bf16 v[180:183], a[236:239], a[68:71], v[180:183]
    ds_read_b64_tr_b16 a[248:249], v122 offset:0
    ds_read_b64_tr_b16 a[250:251], v122 offset:6144
    v_mfma_f32_16x16x32_bf16 v[176:179], a[236:239], a[64:67], v[176:179]
    s_mov_b32 s38, 0
    v_cvt_pk_bf16_f32 v46, v152, v153
    v_cvt_pk_bf16_f32 v47, v154, v155
    v_mfma_f32_16x16x32_bf16 v[172:175], a[236:239], a[60:63], v[172:175]
    s_waitcnt lgkmcnt(4)
    s_cmp_eq_u32 s28, 0
    s_cbranch_scc1 L_PST1
    buffer_store_dwordx4 v[44:47], v0, s[68:71], s38 offen offset:1024 sc1
L_PST1:
    v_mfma_f32_16x16x32_bf16 v[160:163], a[240:243], a[120:123], v[160:163]
    ds_read_b64_tr_b16 a[252:253], v123 offset:0
    ds_read_b64_tr_b16 a[254:255], v123 offset:6144
    v_mfma_f32_16x16x32_bf16 v[164:167], a[240:243], a[124:127], v[164:167]
    v_cvt_pk_bf16_f32 v48, v144, v145
    v_cvt_pk_bf16_f32 v49, v146, v147
    v_mfma_f32_16x16x32_bf16 v[168:171], a[240:243], a[128:131], v[168:171]
    s_waitcnt lgkmcnt(4)
    v_cvt_pk_bf16_f32 v50, v156, v157
    v_cvt_pk_bf16_f32 v51, v158, v159
    v_mfma_f32_16x16x32_bf16 v[180:183], a[244:247], a[128:131], v[180:183]
    s_mov_b32 s38, 0
    ds_read_b64_tr_b16 a[216:217], v114 offset:36960
    ds_read_b64_tr_b16 a[218:219], v114 offset:43104
    v_mfma_f32_16x16x32_bf16 v[176:179], a[244:247], a[124:127], v[176:179]
    s_cmp_eq_u32 s28, 1
    s_cbranch_scc1 L_PST2
    buffer_store_dwordx4 v[48:51], v0, s[68:71], s38 offen offset:2048 sc1
L_PST2:
    v_mfma_f32_16x16x32_bf16 v[172:175], a[244:247], a[120:123], v[172:175]
    s_waitcnt lgkmcnt(4)
    v_mfma_f32_16x16x32_bf16 v[160:163], a[248:251], a[132:135], v[160:163]
    ds_read_b64_tr_b16 a[220:221], v115 offset:36960
    ds_read_b64_tr_b16 a[222:223], v115 offset:43104
    v_mfma_f32_16x16x32_bf16 v[164:167], a[248:251], a[136:139], v[164:167]
    v_mfma_f32_16x16x32_bf16 v[168:171], a[248:251], a[140:143], v[168:171]
    s_waitcnt lgkmcnt(4)
    v_mfma_f32_16x16x32_bf16 v[180:183], a[252:255], a[140:143], v[180:183]
    ds_read_b64_tr_b16 a[224:225], v122 offset:12320
    ds_read_b64_tr_b16 a[226:227], v122 offset:18464
    v_mfma_f32_16x16x32_bf16 v[176:179], a[252:255], a[136:139], v[176:179]
    v_mfma_f32_16x16x32_bf16 v[172:175], a[252:255], a[132:135], v[172:175]
    s_waitcnt lgkmcnt(4)
    v_mfma_f32_16x16x32_bf16 v[160:163], a[216:219], a[192:195], v[160:163]
    ds_read_b64_tr_b16 a[228:229], v123 offset:12320
    ds_read_b64_tr_b16 a[230:231], v123 offset:18464
    v_mfma_f32_16x16x32_bf16 v[164:167], a[216:219], a[196:199], v[164:167]
    v_mfma_f32_16x16x32_bf16 v[168:171], a[216:219], a[200:203], v[168:171]
    s_waitcnt lgkmcnt(4)
    v_mfma_f32_16x16x32_bf16 v[180:183], a[220:223], a[200:203], v[180:183]
    ds_read_b64_tr_b16 a[232:233], v112 offset:12448
    ds_read_b64_tr_b16 a[234:235], v112 offset:18592
    v_mfma_f32_16x16x32_bf16 v[176:179], a[220:223], a[196:199], v[176:179]
    v_mfma_f32_16x16x32_bf16 v[172:175], a[220:223], a[192:195], v[172:175]
    s_waitcnt lgkmcnt(4)
    v_mfma_f32_16x16x32_bf16 v[160:163], a[224:227], a[204:207], v[160:163]
    ds_read_b64_tr_b16 a[236:237], v113 offset:12448
    ds_read_b64_tr_b16 a[238:239], v113 offset:18592
    v_mfma_f32_16x16x32_bf16 v[164:167], a[224:227], a[208:211], v[164:167]
    v_mfma_f32_16x16x32_bf16 v[168:171], a[224:227], a[212:215], v[168:171]
    s_waitcnt lgkmcnt(4)
    v_mfma_f32_16x16x32_bf16 v[180:183], a[228:231], a[212:215], v[180:183]
    ds_read_b64_tr_b16 a[240:241], v116 offset:49408
    ds_read_b64_tr_b16 a[242:243], v116 offset:55552
    v_mfma_f32_16x16x32_bf16 v[176:179], a[228:231], a[208:211], v[176:179]
    v_mfma_f32_16x16x32_bf16 v[172:175], a[228:231], a[204:207], v[172:175]
    s_waitcnt lgkmcnt(4)
    v_mfma_f32_16x16x32_bf16 v[184:187], a[232:235], a[48:51], v[184:187]
    ds_read_b64_tr_b16 a[244:245], v117 offset:49408
    ds_read_b64_tr_b16 a[246:247], v117 offset:55552
    v_mfma_f32_16x16x32_bf16 v[188:191], a[232:235], a[52:55], v[188:191]
    v_mfma_f32_16x16x32_bf16 v[192:195], a[232:235], a[56:59], v[192:195]
    s_waitcnt lgkmcnt(4)
    v_mfma_f32_16x16x32_bf16 v[204:207], a[236:239], a[56:59], v[204:207]
    ds_read_b64_tr_b16 a[248:249], v112 offset:24768
    ds_read_b64_tr_b16 a[250:251], v112 offset:30912
    v_mfma_f32_16x16x32_bf16 v[200:203], a[236:239], a[52:55], v[200:203]
    v_cvt_pk_bf16_f32 v52, v160, v161
    v_cvt_pk_bf16_f32 v53, v162, v163
    v_mfma_f32_16x16x32_bf16 v[196:199], a[236:239], a[48:51], v[196:199]
    s_waitcnt lgkmcnt(4)
    v_cvt_pk_bf16_f32 v54, v172, v173
    v_cvt_pk_bf16_f32 v55, v174, v175
    v_mfma_f32_16x16x32_bf16 v[184:187], a[240:243], a[60:63], v[184:187]
    s_mov_b32 s38, 3072
    ds_read_b64_tr_b16 a[252:253], v113 offset:24768
    ds_read_b64_tr_b16 a[254:255], v113 offset:30912
    v_mfma_f32_16x16x32_bf16 v[188:191], a[240:243], a[64:67], v[188:191]
    s_cmp_eq_u32 s28, 1
    s_cbranch_scc1 L_PST3
    buffer_store_dwordx4 v[52:55], v0, s[68:71], s38 offen offset:0 sc1
L_PST3:
    v_mfma_f32_16x16x32_bf16 v[192:195], a[240:243], a[68:71], v[192:195]
    s_waitcnt lgkmcnt(4)
    v_cvt_pk_bf16_f32 v56, v164, v165
    v_cvt_pk_bf16_f32 v57, v166, v167
    v_mfma_f32_16x16x32_bf16 v[204:207], a[244:247], a[68:71], v[204:207]
    ds_read_b64_tr_b16 a[216:217], v120 offset:128
    ds_read_b64_tr_b16 a[218:219], v120 offset:6272
    v_mfma_f32_16x16x32_bf16 v[200:203], a[244:247], a[64:67], v[200:203]
    s_mov_b32 s38, 3072
    v_cvt_pk_bf16_f32 v58, v176, v177
    v_cvt_pk_bf16_f32 v59, v178, v179
    v_mfma_f32_16x16x32_bf16 v[196:199], a[244:247], a[60:63], v[196:199]
    s_waitcnt lgkmcnt(4)
    s_cmp_eq_u32 s28, 2
    s_cbranch_scc1 L_PST4
    buffer_store_dwordx4 v[56:59], v0, s[68:71], s38 offen offset:1024 sc1
L_PST4:
    v_mfma_f32_16x16x32_bf16 v[184:187], a[248:251], a[120:123], v[184:187]
    ds_read_b64_tr_b16 a[220:221], v121 offset:128
    ds_read_b64_tr_b16 a[222:223], v121 offset:6272
    v_mfma_f32_16x16x32_bf16 v[188:191], a[248:251], a[124:127], v[188:191]
    v_cvt_pk_bf16_f32 v60, v168, v169
    v_cvt_pk_bf16_f32 v61, v170, v171
    v_mfma_f32_16x16x32_bf16 v[192:195], a[248:251], a[128:131], v[192:195]
    s_waitcnt lgkmcnt(4)
    v_cvt_pk_bf16_f32 v62, v180, v181
    v_cvt_pk_bf16_f32 v63, v182, v183
    v_mfma_f32_16x16x32_bf16 v[204:207], a[252:255], a[128:131], v[204:207]
    s_mov_b32 s38, 3072
    ds_read_b64_tr_b16 a[224:225], v112 offset:37088
    ds_read_b64_tr_b16 a[226:227], v112 offset:43232
    v_mfma_f32_16x16x32_bf16 v[200:203], a[252:255], a[124:127], v[200:203]
    s_cmp_eq_u32 s28, 2
    s_cbranch_scc1 L_PST5
    buffer_store_dwordx4 v[60:63], v0, s[68:71], s38 offen offset:2048 sc1
L_PST5:
    v_mfma_f32_16x16x32_bf16 v[196:199], a[252:255], a[120:123], v[196:199]
    s_waitcnt lgkmcnt(4)
    v_mfma_f32_16x16x32_bf16 v[184:187], a[216:219], a[132:135], v[184:187]
    ds_read_b64_tr_b16 a[228:229], v113 offset:37088
    ds_read_b64_tr_b16 a[230:231], v113 offset:43232
    v_mfma_f32_16x16x32_bf16 v[188:191], a[216:219], a[136:139], v[188:191]
    v_mfma_f32_16x16x32_bf16 v[192:195], a[216:219], a[140:143], v[192:195]
    s_waitcnt lgkmcnt(4)
    v_mfma_f32_16x16x32_bf16 v[204:207], a[220:223], a[140:143], v[204:207]
    ds_read_b64_tr_b16 a[232:233], v120 offset:12448
    ds_read_b64_tr_b16 a[234:235], v120 offset:18592
    v_mfma_f32_16x16x32_bf16 v[200:203], a[220:223], a[136:139], v[200:203]
    v_mfma_f32_16x16x32_bf16 v[196:199], a[220:223], a[132:135], v[196:199]
    s_waitcnt lgkmcnt(4)
    v_mfma_f32_16x16x32_bf16 v[184:187], a[224:227], a[192:195], v[184:187]
    ds_read_b64_tr_b16 a[236:237], v121 offset:12448
    ds_read_b64_tr_b16 a[238:239], v121 offset:18592
    v_mfma_f32_16x16x32_bf16 v[188:191], a[224:227], a[196:199], v[188:191]
    v_mfma_f32_16x16x32_bf16 v[192:195], a[224:227], a[200:203], v[192:195]
    s_waitcnt lgkmcnt(4)
    v_mfma_f32_16x16x32_bf16 v[204:207], a[228:231], a[200:203], v[204:207]
    ds_read_b64_tr_b16 a[240:241], v114 offset:12448
    ds_read_b64_tr_b16 a[242:243], v114 offset:18592
    v_mfma_f32_16x16x32_bf16 v[200:203], a[228:231], a[196:199], v[200:203]
    v_mfma_f32_16x16x32_bf16 v[196:199], a[228:231], a[192:195], v[196:199]
    s_waitcnt lgkmcnt(4)
    v_mfma_f32_16x16x32_bf16 v[184:187], a[232:235], a[204:207], v[184:187]
    ds_read_b64_tr_b16 a[244:245], v115 offset:12448
    ds_read_b64_tr_b16 a[246:247], v115 offset:18592
    v_mfma_f32_16x16x32_bf16 v[188:191], a[232:235], a[208:211], v[188:191]
    v_mfma_f32_16x16x32_bf16 v[192:195], a[232:235], a[212:215], v[192:195]
    s_waitcnt lgkmcnt(4)
    v_mfma_f32_16x16x32_bf16 v[204:207], a[236:239], a[212:215], v[204:207]
    ds_read_b64_tr_b16 a[248:249], v118 offset:49408
    ds_read_b64_tr_b16 a[250:251], v118 offset:55552
    v_mfma_f32_16x16x32_bf16 v[200:203], a[236:239], a[208:211], v[200:203]
    v_mfma_f32_16x16x32_bf16 v[196:199], a[236:239], a[204:207], v[196:199]
    s_waitcnt lgkmcnt(4)
    v_mfma_f32_16x16x32_bf16 v[208:211], a[240:243], a[48:51], v[208:211]
    ds_read_b64_tr_b16 a[252:253], v119 offset:49408
    ds_read_b64_tr_b16 a[254:255], v119 offset:55552
    v_mfma_f32_16x16x32_bf16 v[212:215], a[240:243], a[52:55], v[212:215]
    v_mfma_f32_16x16x32_bf16 v[216:219], a[240:243], a[56:59], v[216:219]
    s_waitcnt lgkmcnt(4)
    v_mfma_f32_16x16x32_bf16 v[228:231], a[244:247], a[56:59], v[228:231]
    ds_read_b64_tr_b16 a[216:217], v114 offset:24768
    ds_read_b64_tr_b16 a[218:219], v114 offset:30912
    v_mfma_f32_16x16x32_bf16 v[224:227], a[244:247], a[52:55], v[224:227]
    v_cvt_pk_bf16_f32 v64, v184, v185
    v_cvt_pk_bf16_f32 v65, v186, v187
    v_mfma_f32_16x16x32_bf16 v[220:223], a[244:247], a[48:51], v[220:223]
    s_waitcnt lgkmcnt(4)
    v_cvt_pk_bf16_f32 v66, v196, v197
    v_cvt_pk_bf16_f32 v67, v198, v199
    v_mfma_f32_16x16x32_bf16 v[208:211], a[248:251], a[60:63], v[208:211]
    s_mov_b32 s38, 6144
    ds_read_b64_tr_b16 a[220:221], v115 offset:24768
    ds_read_b64_tr_b16 a[222:223], v115 offset:30912
    v_mfma_f32_16x16x32_bf16 v[212:215], a[248:251], a[64:67], v[212:215]
    s_cmp_eq_u32 s28, 3
    s_cbranch_scc1 L_PST6
    buffer_store_dwordx4 v[64:67], v0, s[68:71], s38 offen offset:0 sc1
L_PST6:
    v_mfma_f32_16x16x32_bf16 v[216:219], a[248:251], a[68:71], v[216:219]
    s_waitcnt lgkmcnt(4)
    v_cvt_pk_bf16_f32 v68, v188, v189
    v_cvt_pk_bf16_f32 v69, v190, v191
    v_mfma_f32_16x16x32_bf16 v[228:231], a[252:255], a[68:71], v[228:231]
    ds_read_b64_tr_b16 a[224:225], v122 offset:128
    ds_read_b64_tr_b16 a[226:227], v122 offset:6272
    v_mfma_f32_16x16x32_bf16 v[224:227], a[252:255], a[64:67], v[224:227]
    s_mov_b32 s38, 6144
    v_cvt_pk_bf16_f32 v70, v200, v201
    v_cvt_pk_bf16_f32 v71, v202, v203
    v_mfma_f32_16x16x32_bf16 v[220:223], a[252:255], a[60:63], v[220:223]
    s_waitcnt lgkmcnt(4)
    s_cmp_eq_u32 s28, 3
    s_cbranch_scc1 L_PST7
    buffer_store_dwordx4 v[68:71], v0, s[68:71], s38 offen offset:1024 sc1
L_PST7:
    v_mfma_f32_16x16x32_bf16 v[208:211], a[216:219], a[120:123], v[208:211]
    ds_read_b64_tr_b16 a[228:229], v123 offset:128
    ds_read_b64_tr_b16 a[230:231], v123 offset:6272
    v_mfma_f32_16x16x32_bf16 v[212:215], a[216:219], a[124:127], v[212:215]
    v_cvt_pk_bf16_f32 v72, v192, v193
    v_cvt_pk_bf16_f32 v73, v194, v195
    v_mfma_f32_16x16x32_bf16 v[216:219], a[216:219], a[128:131], v[216:219]
    s_waitcnt lgkmcnt(4)
    v_cvt_pk_bf16_f32 v74, v204, v205
    v_cvt_pk_bf16_f32 v75, v206, v207
    v_mfma_f32_16x16x32_bf16 v[228:231], a[220:223], a[128:131], v[228:231]
    s_mov_b32 s38, 6144
    ds_read_b64_tr_b16 a[232:233], v114 offset:37088
    ds_read_b64_tr_b16 a[234:235], v114 offset:43232
    v_mfma_f32_16x16x32_bf16 v[224:227], a[220:223], a[124:127], v[224:227]
    s_cmp_eq_u32 s28, 4
    s_cbranch_scc1 L_PST8
    buffer_store_dwordx4 v[72:75], v0, s[68:71], s38 offen offset:2048 sc1
L_PST8:
    v_mfma_f32_16x16x32_bf16 v[220:223], a[220:223], a[120:123], v[220:223]
    s_waitcnt lgkmcnt(4)
    v_mfma_f32_16x16x32_bf16 v[208:211], a[224:227], a[132:135], v[208:211]
    ds_read_b64_tr_b16 a[236:237], v115 offset:37088
    ds_read_b64_tr_b16 a[238:239], v115 offset:43232
    v_mfma_f32_16x16x32_bf16 v[212:215], a[224:227], a[136:139], v[212:215]
    v_mfma_f32_16x16x32_bf16 v[216:219], a[224:227], a[140:143], v[216:219]
    s_waitcnt lgkmcnt(4)
    v_mfma_f32_16x16x32_bf16 v[228:231], a[228:231], a[140:143], v[228:231]
    ds_read_b64_tr_b16 a[240:241], v122 offset:12448
    ds_read_b64_tr_b16 a[242:243], v122 offset:18592
    v_mfma_f32_16x16x32_bf16 v[224:227], a[228:231], a[136:139], v[224:227]
    v_mfma_f32_16x16x32_bf16 v[220:223], a[228:231], a[132:135], v[220:223]
    s_waitcnt lgkmcnt(4)
    v_mfma_f32_16x16x32_bf16 v[208:211], a[232:235], a[192:195], v[208:211]
    ds_read_b64_tr_b16 a[244:245], v123 offset:12448
    ds_read_b64_tr_b16 a[246:247], v123 offset:18592
    v_mfma_f32_16x16x32_bf16 v[212:215], a[232:235], a[196:199], v[212:215]
    v_mfma_f32_16x16x32_bf16 v[216:219], a[232:235], a[200:203], v[216:219]
    s_waitcnt lgkmcnt(4)
    v_mfma_f32_16x16x32_bf16 v[228:231], a[236:239], a[200:203], v[228:231]
    ds_read_b64_tr_b16 a[248:249], v112 offset:12576
    ds_read_b64_tr_b16 a[250:251], v112 offset:18720
    v_mfma_f32_16x16x32_bf16 v[224:227], a[236:239], a[196:199], v[224:227]
    v_mfma_f32_16x16x32_bf16 v[220:223], a[236:239], a[192:195], v[220:223]
    s_waitcnt lgkmcnt(4)
    v_mfma_f32_16x16x32_bf16 v[208:211], a[240:243], a[204:207], v[208:211]
    ds_read_b64_tr_b16 a[252:253], v113 offset:12576
    ds_read_b64_tr_b16 a[254:255], v113 offset:18720
    v_mfma_f32_16x16x32_bf16 v[212:215], a[240:243], a[208:211], v[212:215]
    v_mfma_f32_16x16x32_bf16 v[216:219], a[240:243], a[212:215], v[216:219]
    s_waitcnt lgkmcnt(4)
    v_mfma_f32_16x16x32_bf16 v[228:231], a[244:247], a[212:215], v[228:231]
    ds_read_b64_tr_b16 a[216:217], v116 offset:49536
    ds_read_b64_tr_b16 a[218:219], v116 offset:55680
    v_mfma_f32_16x16x32_bf16 v[224:227], a[244:247], a[208:211], v[224:227]
    v_mfma_f32_16x16x32_bf16 v[220:223], a[244:247], a[204:207], v[220:223]
    s_waitcnt lgkmcnt(4)
    v_mfma_f32_16x16x32_bf16 v[232:235], a[248:251], a[48:51], v[232:235]
    ds_read_b64_tr_b16 a[220:221], v117 offset:49536
    ds_read_b64_tr_b16 a[222:223], v117 offset:55680
    v_mfma_f32_16x16x32_bf16 v[236:239], a[248:251], a[52:55], v[236:239]
    v_mfma_f32_16x16x32_bf16 v[240:243], a[248:251], a[56:59], v[240:243]
    s_waitcnt lgkmcnt(4)
    v_mfma_f32_16x16x32_bf16 v[252:255], a[252:255], a[56:59], v[252:255]
    ds_read_b64_tr_b16 a[224:225], v112 offset:24896
    ds_read_b64_tr_b16 a[226:227], v112 offset:31040
    v_mfma_f32_16x16x32_bf16 v[248:251], a[252:255], a[52:55], v[248:251]
    v_cvt_pk_bf16_f32 v76, v208, v209
    v_cvt_pk_bf16_f32 v77, v210, v211
    v_mfma_f32_16x16x32_bf16 v[244:247], a[252:255], a[48:51], v[244:247]
    s_waitcnt lgkmcnt(4)
    v_cvt_pk_bf16_f32 v78, v220, v221
    v_cvt_pk_bf16_f32 v79, v222, v223
    v_mfma_f32_16x16x32_bf16 v[232:235], a[216:219], a[60:63], v[232:235]
    s_mov_b32 s38, 9216
    ds_read_b64_tr_b16 a[228:229], v113 offset:24896
    ds_read_b64_tr_b16 a[230:231], v113 offset:31040
    v_mfma_f32_16x16x32_bf16 v[236:239], a[216:219], a[64:67], v[236:239]
    s_cmp_eq_u32 s28, 4
    s_cbranch_scc1 L_PST9
    buffer_store_dwordx4 v[76:79], v0, s[68:71], s38 offen offset:0 sc1
L_PST9:
    v_mfma_f32_16x16x32_bf16 v[240:243], a[216:219], a[68:71], v[240:243]
    s_waitcnt lgkmcnt(4)
    v_cvt_pk_bf16_f32 v80, v212, v213
    v_cvt_pk_bf16_f32 v81, v214, v215
    v_mfma_f32_16x16x32_bf16 v[252:255], a[220:223], a[68:71], v[252:255]
    ds_read_b64_tr_b16 a[232:233], v120 offset:256
    ds_read_b64_tr_b16 a[234:235], v120 offset:6400
    v_mfma_f32_16x16x32_bf16 v[248:251], a[220:223], a[64:67], v[248:251]
    s_mov_b32 s38, 9216
    v_cvt_pk_bf16_f32 v82, v224, v225
    v_cvt_pk_bf16_f32 v83, v226, v227
    v_mfma_f32_16x16x32_bf16 v[244:247], a[220:223], a[60:63], v[244:247]
    s_waitcnt lgkmcnt(4)
    s_cmp_eq_u32 s28, 5
    s_cbranch_scc1 L_PST10
    buffer_store_dwordx4 v[80:83], v0, s[68:71], s38 offen offset:1024 sc1
L_PST10:
    v_mfma_f32_16x16x32_bf16 v[232:235], a[224:227], a[120:123], v[232:235]
    ds_read_b64_tr_b16 a[236:237], v121 offset:256
    ds_read_b64_tr_b16 a[238:239], v121 offset:6400
    v_mfma_f32_16x16x32_bf16 v[236:239], a[224:227], a[124:127], v[236:239]
    v_cvt_pk_bf16_f32 v84, v216, v217
    v_cvt_pk_bf16_f32 v85, v218, v219
    v_mfma_f32_16x16x32_bf16 v[240:243], a[224:227], a[128:131], v[240:243]
    s_waitcnt lgkmcnt(4)
    v_cvt_pk_bf16_f32 v86, v228, v229
    v_cvt_pk_bf16_f32 v87, v230, v231
    v_mfma_f32_16x16x32_bf16 v[252:255], a[228:231], a[128:131], v[252:255]
    s_mov_b32 s38, 9216
    ds_read_b64_tr_b16 a[240:241], v112 offset:37216
    ds_read_b64_tr_b16 a[242:243], v112 offset:43360
    v_mfma_f32_16x16x32_bf16 v[248:251], a[228:231], a[124:127], v[248:251]
    s_cmp_eq_u32 s28, 5
    s_cbranch_scc1 L_PST11
    buffer_store_dwordx4 v[84:87], v0, s[68:71], s38 offen offset:2048 sc1
L_PST11:
    v_mfma_f32_16x16x32_bf16 v[244:247], a[228:231], a[120:123], v[244:247]
    s_waitcnt lgkmcnt(4)
    v_mfma_f32_16x16x32_bf16 v[232:235], a[232:235], a[132:135], v[232:235]
    ds_read_b64_tr_b16 a[244:245], v113 offset:37216
    ds_read_b64_tr_b16 a[246:247], v113 offset:43360
    v_mfma_f32_16x16x32_bf16 v[236:239], a[232:235], a[136:139], v[236:239]
    v_mfma_f32_16x16x32_bf16 v[240:243], a[232:235], a[140:143], v[240:243]
    s_waitcnt lgkmcnt(4)
    v_mfma_f32_16x16x32_bf16 v[252:255], a[236:239], a[140:143], v[252:255]
    ds_read_b64_tr_b16 a[248:249], v120 offset:12576
    ds_read_b64_tr_b16 a[250:251], v120 offset:18720
    v_mfma_f32_16x16x32_bf16 v[248:251], a[236:239], a[136:139], v[248:251]
    v_mfma_f32_16x16x32_bf16 v[244:247], a[236:239], a[132:135], v[244:247]
    s_waitcnt lgkmcnt(4)
    v_mfma_f32_16x16x32_bf16 v[232:235], a[240:243], a[192:195], v[232:235]
    ds_read_b64_tr_b16 a[252:253], v121 offset:12576
    ds_read_b64_tr_b16 a[254:255], v121 offset:18720
    v_mfma_f32_16x16x32_bf16 v[236:239], a[240:243], a[196:199], v[236:239]
    v_mfma_f32_16x16x32_bf16 v[240:243], a[240:243], a[200:203], v[240:243]
    s_waitcnt lgkmcnt(4)
    v_mfma_f32_16x16x32_bf16 v[252:255], a[244:247], a[200:203], v[252:255]
    v_mfma_f32_16x16x32_bf16 v[248:251], a[244:247], a[196:199], v[248:251]
    v_mfma_f32_16x16x32_bf16 v[244:247], a[244:247], a[192:195], v[244:247]
    s_waitcnt lgkmcnt(2)
    v_mfma_f32_16x16x32_bf16 v[232:235], a[248:251], a[204:207], v[232:235]
    v_mfma_f32_16x16x32_bf16 v[236:239], a[248:251], a[208:211], v[236:239]
    v_mfma_f32_16x16x32_bf16 v[240:243], a[248:251], a[212:215], v[240:243]
    s_waitcnt lgkmcnt(0)
    v_mfma_f32_16x16x32_bf16 v[252:255], a[252:255], a[212:215], v[252:255]
    v_mfma_f32_16x16x32_bf16 v[248:251], a[252:255], a[208:211], v[248:251]
    v_mfma_f32_16x16x32_bf16 v[244:247], a[252:255], a[204:207], v[244:247]
    s_mov_b32 s38, 12288
    s_nop 0
    v_cvt_pk_bf16_f32 v88, v232, v233
    v_cvt_pk_bf16_f32 v89, v234, v235
    s_nop 3
    v_cvt_pk_bf16_f32 v90, v244, v245
    v_cvt_pk_bf16_f32 v91, v246, v247
    s_cmp_eq_u32 s28, 6
    s_cbranch_scc1 L_PST12
    buffer_store_dwordx4 v[88:91], v0, s[68:71], s38 offen offset:0 sc1
L_PST12:
    v_cvt_pk_bf16_f32 v92, v236, v237
    v_cvt_pk_bf16_f32 v93, v238, v239
    v_cvt_pk_bf16_f32 v94, v248, v249
    v_cvt_pk_bf16_f32 v95, v250, v251
    s_cmp_eq_u32 s28, 6
    s_cbranch_scc1 L_PST13
    buffer_store_dwordx4 v[92:95], v0, s[68:71], s38 offen offset:1024 sc1
L_PST13:
    v_cvt_pk_bf16_f32 v96, v240, v241
    v_cvt_pk_bf16_f32 v97, v242, v243
    v_cvt_pk_bf16_f32 v98, v252, v253
    v_cvt_pk_bf16_f32 v99, v254, v255
    s_cmp_eq_u32 s28, 7
    s_cbranch_scc1 L_PST14
    buffer_store_dwordx4 v[96:99], v0, s[68:71], s38 offen offset:2048 sc1
L_PST14:
    s_lshl_b32 s29, s28, 1
    s_mul_i32 s31, s29, 21846
    s_lshr_b32 s31, s31, 16
    s_lshl_b32 s96, s31, 6
    s_mul_i32 s31, s31, 3
    s_sub_u32 s30, s29, s31
    s_mul_i32 s30, s30, 20480
    s_add_u32 s96, s96, s30
    s_mul_i32 s30, s24, 61440
    s_add_u32 s96, s96, s30
    s_mul_i32 s30, s25, 245760
    s_add_u32 s96, s96, s30
    s_mul_i32 s30, s27, 320
    s_add_u32 s96, s96, s30
    s_lshl_b32 s29, s28, 1
    s_add_u32 s29, s29, 1
    s_mul_i32 s31, s29, 21846
    s_lshr_b32 s31, s31, 16
    s_lshl_b32 s97, s31, 6
    s_mul_i32 s31, s31, 3
    s_sub_u32 s30, s29, s31
    s_mul_i32 s30, s30, 20480
    s_add_u32 s97, s97, s30
    s_mul_i32 s30, s24, 61440
    s_add_u32 s97, s97, s30
    s_mul_i32 s30, s25, 245760
    s_add_u32 s97, s97, s30
    s_mul_i32 s30, s27, 320
    s_add_u32 s97, s97, s30
    v_and_b32 v126, 7, v1
    s_and_b32 s29, s2, 0xf8
    v_add_u32 v126, s29, v126
    v_lshlrev_b32 v126, 2, v126
    v_add_u32 v126, s24, v126
    v_lshlrev_b32 v126, 7, v126
    v_mul_u32_u24 v127, 0x500, v3
    v_lshl_add_u32 v127, v2, 4, v127
    s_cmp_lg_u32 s28, 0
    s_cbranch_scc1 L_OWN0
    v_mov_b32 v136, v40
    v_mov_b32 v137, v41
    v_mov_b32 v138, v42
    v_mov_b32 v139, v43
    v_mov_b32 v140, v44
    v_mov_b32 v141, v45
    v_mov_b32 v142, v46
    v_mov_b32 v143, v47
L_OWN0:
    s_cmp_lg_u32 s28, 1
    s_cbranch_scc1 L_OWN1
    v_mov_b32 v144, v48
    v_mov_b32 v145, v49
    v_mov_b32 v146, v50
    v_mov_b32 v147, v51
    v_mov_b32 v148, v52
    v_mov_b32 v149, v53
    v_mov_b32 v150, v54
    v_mov_b32 v151, v55
L_OWN1:
    s_cmp_lg_u32 s28, 2
    s_cbranch_scc1 L_OWN2
    v_mov_b32 v152, v56
    v_mov_b32 v153, v57
    v_mov_b32 v154, v58
    v_mov_b32 v155, v59
    v_mov_b32 v156, v60
    v_mov_b32 v157, v61
    v_mov_b32 v158, v62
    v_mov_b32 v159, v63
L_OWN2:
    s_cmp_lg_u32 s28, 3
    s_cbranch_scc1 L_OWN3
    v_mov_b32 v160, v64
    v_mov_b32 v161, v65
    v_mov_b32 v162, v66
    v_mov_b32 v163, v67
    v_mov_b32 v164, v68
    v_mov_b32 v165, v69
    v_mov_b32 v166, v70
    v_mov_b32 v167, v71
L_OWN3:
    s_cmp_lg_u32 s28, 4
    s_cbranch_scc1 L_OWN4
    v_mov_b32 v168, v72
    v_mov_b32 v169, v73
    v_mov_b32 v170, v74
    v_mov_b32 v171, v75
    v_mov_b32 v172, v76
    v_mov_b32 v173, v77
    v_mov_b32 v174, v78
    v_mov_b32 v175, v79
L_OWN4:
    s_cmp_lg_u32 s28, 5
    s_cbranch_scc1 L_OWN5
    v_mov_b32 v176, v80
    v_mov_b32 v177, v81
    v_mov_b32 v178, v82
    v_mov_b32 v179, v83
    v_mov_b32 v180, v84
    v_mov_b32 v181, v85
    v_mov_b32 v182, v86
    v_mov_b32 v183, v87
L_OWN5:
    s_cmp_lg_u32 s28, 6
    s_cbranch_scc1 L_OWN6
    v_mov_b32 v184, v88
    v_mov_b32 v185, v89
    v_mov_b32 v186, v90
    v_mov_b32 v187, v91
    v_mov_b32 v188, v92
    v_mov_b32 v189, v93
    v_mov_b32 v190, v94
    v_mov_b32 v191, v95
L_OWN6:
    s_cmp_lg_u32 s28, 7
    s_cbranch_scc1 L_OWN7
    v_mov_b32 v192, v96
    v_mov_b32 v193, v97
    v_mov_b32 v194, v98
    v_mov_b32 v195, v99
L_OWN7:
    s_lshl_b32 s90, 1, s28
    s_mov_b32 s89, s90
    s_mov_b32 s59, 0x40000
    s_waitcnt vmcnt(0)
    s_mov_b64 exec, 1
    buffer_store_dword v129, v7, s[80:83], 0 offen offset:12 sc1
    s_mov_b64 exec, -1
L_F2:
    s_cmp_eq_u32 s90, 0xff
    s_cbranch_scc1 L_F2_NOPOLL
    v_mov_b32 v130, 1
    s_mov_b64 exec, 255
    v_mov_b32 v130, 0
    buffer_atomic_or v130, v126, s[80:83], 0 offen offset:12 sc0
    s_mov_b64 exec, -1
L_F2_NOPOLL:
    s_waitcnt vmcnt(0)
    s_bitcmp1_b32 s89, 0
    s_cbranch_scc0 L_UP0
    v_lshlrev_b32 v40, 16, v136
    v_and_b32 v41, 0xffff0000, v136
    v_lshlrev_b32 v42, 16, v137
    v_and_b32 v43, 0xffff0000, v137
    v_lshlrev_b32 v44, 16, v138
    v_and_b32 v45, 0xffff0000, v138
    v_lshlrev_b32 v46, 16, v139
    v_and_b32 v47, 0xffff0000, v139
    v_lshlrev_b32 v48, 16, v140
    v_and_b32 v49, 0xffff0000, v140
    v_lshlrev_b32 v50, 16, v141
    v_and_b32 v51, 0xffff0000, v141
    v_lshlrev_b32 v52, 16, v142
    v_and_b32 v53, 0xffff0000, v142
    v_lshlrev_b32 v54, 16, v143
    v_and_b32 v55, 0xffff0000, v143
L_UP0:
    s_bitcmp1_b32 s89, 1
    s_cbranch_scc0 L_UP1
    v_lshlrev_b32 v56, 16, v144
    v_and_b32 v57, 0xffff0000, v144
    v_lshlrev_b32 v58, 16, v145
    v_and_b32 v59, 0xffff0000, v145
    v_lshlrev_b32 v60, 16, v146
    v_and_b32 v61, 0xffff0000, v146
    v_lshlrev_b32 v62, 16, v147
    v_and_b32 v63, 0xffff0000, v147
    v_lshlrev_b32 v64, 16, v148
    v_and_b32 v65, 0xffff0000, v148
    v_lshlrev_b32 v66, 16, v149
    v_and_b32 v67, 0xffff0000, v149
    v_lshlrev_b32 v68, 16, v150
    v_and_b32 v69, 0xffff0000, v150
    v_lshlrev_b32 v70, 16, v151
    v_and_b32 v71, 0xffff0000, v151
L_UP1:
    s_bitcmp1_b32 s89, 2
    s_cbranch_scc0 L_UP2
    v_lshlrev_b32 v72, 16, v152
    v_and_b32 v73, 0xffff0000, v152
    v_lshlrev_b32 v74, 16, v153
    v_and_b32 v75, 0xffff0000, v153
    v_lshlrev_b32 v76, 16, v154
    v_and_b32 v77, 0xffff0000, v154
    v_lshlrev_b32 v78, 16, v155
    v_and_b32 v79, 0xffff0000, v155
    v_lshlrev_b32 v80, 16, v156
    v_and_b32 v81, 0xffff0000, v156
    v_lshlrev_b32 v82, 16, v157
    v_and_b32 v83, 0xffff0000, v157
    v_lshlrev_b32 v84, 16, v158
    v_and_b32 v85, 0xffff0000, v158
    v_lshlrev_b32 v86, 16, v159
    v_and_b32 v87, 0xffff0000, v159
L_UP2:
    s_bitcmp1_b32 s89, 3
    s_cbranch_scc0 L_UP3
    v_lshlrev_b32 v88, 16, v160
    v_and_b32 v89, 0xffff0000, v160
    v_lshlrev_b32 v90, 16, v161
    v_and_b32 v91, 0xffff0000, v161
    v_lshlrev_b32 v92, 16, v162
    v_and_b32 v93, 0xffff0000, v162
    v_lshlrev_b32 v94, 16, v163
    v_and_b32 v95, 0xffff0000, v163
    v_lshlrev_b32 v96, 16, v164
    v_and_b32 v97, 0xffff0000, v164
    v_lshlrev_b32 v98, 16, v165
    v_and_b32 v99, 0xffff0000, v165
    v_lshlrev_b32 v100, 16, v166
    v_and_b32 v101, 0xffff0000, v166
    v_lshlrev_b32 v102, 16, v167
    v_and_b32 v103, 0xffff0000, v167
L_UP3:
    s_bitcmp1_b32 s89, 4
    s_cbranch_scc0 L_UP4
    v_lshlrev_b32 v200, 16, v168
    v_and_b32 v201, 0xffff0000, v168
    v_lshlrev_b32 v202, 16, v169
    v_and_b32 v203, 0xffff0000, v169
    v_lshlrev_b32 v204, 16, v170
    v_and_b32 v205, 0xffff0000, v170
    v_lshlrev_b32 v206, 16, v171
    v_and_b32 v207, 0xffff0000, v171
    v_lshlrev_b32 v208, 16, v172
    v_and_b32 v209, 0xffff0000, v172
    v_lshlrev_b32 v210, 16, v173
    v_and_b32 v211, 0xffff0000, v173
    v_lshlrev_b32 v212, 16, v174
    v_and_b32 v213, 0xffff0000, v174
    v_lshlrev_b32 v214, 16, v175
    v_and_b32 v215, 0xffff0000, v175
L_UP4:
    s_bitcmp1_b32 s89, 5
    s_cbranch_scc0 L_UP5
    v_lshlrev_b32 v216, 16, v176
    v_and_b32 v217, 0xffff0000, v176
    v_lshlrev_b32 v218, 16, v177
    v_and_b32 v219, 0xffff0000, v177
    v_lshlrev_b32 v220, 16, v178
    v_and_b32 v221, 0xffff0000, v178
    v_lshlrev_b32 v222, 16, v179
    v_and_b32 v223, 0xffff0000, v179
    v_lshlrev_b32 v224, 16, v180
    v_and_b32 v225, 0xffff0000, v180
    v_lshlrev_b32 v226, 16, v181
    v_and_b32 v227, 0xffff0000, v181
    v_lshlrev_b32 v228, 16, v182
    v_and_b32 v229, 0xffff0000, v182
    v_lshlrev_b32 v230, 16, v183
    v_and_b32 v231, 0xffff0000, v183
L_UP5:
    s_bitcmp1_b32 s89, 6
    s_cbranch_scc0 L_UP6
    v_lshlrev_b32 v232, 16, v184
    v_and_b32 v233, 0xffff0000, v184
    v_lshlrev_b32 v234, 16, v185
    v_and_b32 v235, 0xffff0000, v185
    v_lshlrev_b32 v236, 16, v186
    v_and_b32 v237, 0xffff0000, v186
    v_lshlrev_b32 v238, 16, v187
    v_and_b32 v239, 0xffff0000, v187
    v_lshlrev_b32 v240, 16, v188
    v_and_b32 v241, 0xffff0000, v188
    v_lshlrev_b32 v242, 16, v189
    v_and_b32 v243, 0xffff0000, v189
    v_lshlrev_b32 v244, 16, v190
    v_and_b32 v245, 0xffff0000, v190
    v_lshlrev_b32 v246, 16, v191
    v_and_b32 v247, 0xffff0000, v191
L_UP6:
    s_bitcmp1_b32 s89, 7
    s_cbranch_scc0 L_UP7
    v_lshlrev_b32 v104, 16, v192
    v_and_b32 v105, 0xffff0000, v192
    v_lshlrev_b32 v106, 16, v193
    v_and_b32 v107, 0xffff0000, v193
    v_lshlrev_b32 v108, 16, v194
    v_and_b32 v109, 0xffff0000, v194
    v_lshlrev_b32 v110, 16, v195
    v_and_b32 v111, 0xffff0000, v195
    v_lshlrev_b32 v248, 16, v196
    v_and_b32 v249, 0xffff0000, v196
    v_lshlrev_b32 v250, 16, v197
    v_and_b32 v251, 0xffff0000, v197
    v_lshlrev_b32 v252, 16, v198
    v_and_b32 v253, 0xffff0000, v198
    v_lshlrev_b32 v254, 16, v199
    v_and_b32 v255, 0xffff0000, v199
L_UP7:
    s_cmp_eq_u32 s90, 0xff
    s_cbranch_scc1 L_F2_DONE
    v_cmp_eq_u32 vcc, 1, v130
    s_sub_u32 s59, s59, 1
    s_and_b32 s91, vcc_lo, 0xff
    s_cmp_eq_u32 s59, 0
    s_cselect_b32 s91, 0xff, s91
    s_andn2_b32 s89, s91, s90
    s_cbranch_scc0 L_F2_NONE
    s_or_b32 s90, s90, s89
    s_bitcmp1_b32 s89, 0
    s_cbranch_scc0 L_F2_S0
    s_mov_b32 s38, 0
    buffer_load_dwordx4 v[136:139], v0, s[72:75], s38 offen offset:0 sc1
    buffer_load_dwordx4 v[140:143], v0, s[72:75], s38 offen offset:1024 sc1
L_F2_S0:
    s_bitcmp1_b32 s89, 1
    s_cbranch_scc0 L_F2_S1
    s_mov_b32 s38, 61440
    buffer_load_dwordx4 v[144:147], v0, s[72:75], s38 offen offset:0 sc1
    buffer_load_dwordx4 v[148:151], v0, s[72:75], s38 offen offset:1024 sc1
L_F2_S1:
    s_bitcmp1_b32 s89, 2
    s_cbranch_scc0 L_F2_S2
    s_mov_b32 s38, 122880
    buffer_load_dwordx4 v[152:155], v0, s[72:75], s38 offen offset:0 sc1
    buffer_load_dwordx4 v[156:159], v0, s[72:75], s38 offen offset:1024 sc1
L_F2_S2:
    s_bitcmp1_b32 s89, 3
    s_cbranch_scc0 L_F2_S3
    s_mov_b32 s38, 184320
    buffer_load_dwordx4 v[160:163], v0, s[72:75], s38 offen offset:0 sc1
    buffer_load_dwordx4 v[164:167], v0, s[72:75], s38 offen offset:1024 sc1
L_F2_S3:
    s_bitcmp1_b32 s89, 4
    s_cbranch_scc0 L_F2_S4
    s_mov_b32 s38, 245760
    buffer_load_dwordx4 v[168:171], v0, s[72:75], s38 offen offset:0 sc1
    buffer_load_dwordx4 v[172:175], v0, s[72:75], s38 offen offset:1024 sc1
L_F2_S4:
    s_bitcmp1_b32 s89, 5
    s_cbranch_scc0 L_F2_S5
    s_mov_b32 s38, 307200
    buffer_load_dwordx4 v[176:179], v0, s[72:75], s38 offen offset:0 sc1
    buffer_load_dwordx4 v[180:183], v0, s[72:75], s38 offen offset:1024 sc1
L_F2_S5:
    s_bitcmp1_b32 s89, 6
    s_cbranch_scc0 L_F2_S6
    s_mov_b32 s38, 368640
    buffer_load_dwordx4 v[184:187], v0, s[72:75], s38 offen offset:0 sc1
    buffer_load_dwordx4 v[188:191], v0, s[72:75], s38 offen offset:1024 sc1
L_F2_S6:
    s_bitcmp1_b32 s89, 7
    s_cbranch_scc0 L_F2_S7
    s_mov_b32 s38, 430080
    buffer_load_dwordx4 v[192:195], v0, s[72:75], s38 offen offset:0 sc1
    buffer_load_dwordx4 v[196:199], v0, s[72:75], s38 offen offset:1024 sc1
L_F2_S7:
    s_branch L_F2
L_F2_NONE:
    s_sleep 8
    s_branch L_F2
L_F2_DONE:
    v_pk_add_f32 v[40:41], v[40:41], v[56:57]
    v_pk_add_f32 v[42:43], v[42:43], v[58:59]
    v_pk_add_f32 v[44:45], v[44:45], v[60:61]
    v_pk_add_f32 v[46:47], v[46:47], v[62:63]
    v_pk_add_f32 v[48:49], v[48:49], v[64:65]
    v_pk_add_f32 v[50:51], v[50:51], v[66:67]
    v_pk_add_f32 v[52:53], v[52:53], v[68:69]
    v_pk_add_f32 v[54:55], v[54:55], v[70:71]
    v_pk_add_f32 v[40:41], v[40:41], v[72:73]
    v_pk_add_f32 v[42:43], v[42:43], v[74:75]
    v_pk_add_f32 v[44:45], v[44:45], v[76:77]
    v_pk_add_f32 v[46:47], v[46:47], v[78:79]
    v_pk_add_f32 v[48:49], v[48:49], v[80:81]
    v_pk_add_f32 v[50:51], v[50:51], v[82:83]
    v_pk_add_f32 v[52:53], v[52:53], v[84:85]
    v_pk_add_f32 v[54:55], v[54:55], v[86:87]
    v_pk_add_f32 v[40:41], v[40:41], v[88:89]
    v_pk_add_f32 v[42:43], v[42:43], v[90:91]
    v_pk_add_f32 v[44:45], v[44:45], v[92:93]
    v_pk_add_f32 v[46:47], v[46:47], v[94:95]
    v_pk_add_f32 v[48:49], v[48:49], v[96:97]
    v_pk_add_f32 v[50:51], v[50:51], v[98:99]
    v_pk_add_f32 v[52:53], v[52:53], v[100:101]
    v_pk_add_f32 v[54:55], v[54:55], v[102:103]
    v_pk_add_f32 v[40:41], v[40:41], v[200:201]
    v_pk_add_f32 v[42:43], v[42:43], v[202:203]
    v_pk_add_f32 v[44:45], v[44:45], v[204:205]
    v_pk_add_f32 v[46:47], v[46:47], v[206:207]
    v_pk_add_f32 v[48:49], v[48:49], v[208:209]
    v_pk_add_f32 v[50:51], v[50:51], v[210:211]
    v_pk_add_f32 v[52:53], v[52:53], v[212:213]
    v_pk_add_f32 v[54:55], v[54:55], v[214:215]
    v_pk_add_f32 v[40:41], v[40:41], v[216:217]
    v_pk_add_f32 v[42:43], v[42:43], v[218:219]
    v_pk_add_f32 v[44:45], v[44:45], v[220:221]
    v_pk_add_f32 v[46:47], v[46:47], v[222:223]
    v_pk_add_f32 v[48:49], v[48:49], v[224:225]
    v_pk_add_f32 v[50:51], v[50:51], v[226:227]
    v_pk_add_f32 v[52:53], v[52:53], v[228:229]
    v_pk_add_f32 v[54:55], v[54:55], v[230:231]
    v_pk_add_f32 v[40:41], v[40:41], v[232:233]
    v_pk_add_f32 v[42:43], v[42:43], v[234:235]
    v_pk_add_f32 v[44:45], v[44:45], v[236:237]
    v_pk_add_f32 v[46:47], v[46:47], v[238:239]
    v_pk_add_f32 v[48:49], v[48:49], v[240:241]
    v_pk_add_f32 v[50:51], v[50:51], v[242:243]
    v_pk_add_f32 v[52:53], v[52:53], v[244:245]
    v_pk_add_f32 v[54:55], v[54:55], v[246:247]
    v_pk_add_f32 v[40:41], v[40:41], v[104:105]
    v_pk_add_f32 v[42:43], v[42:43], v[106:107]
    v_pk_add_f32 v[44:45], v[44:45], v[108:109]
    v_pk_add_f32 v[46:47], v[46:47], v[110:111]
    v_pk_add_f32 v[48:49], v[48:49], v[248:249]
    v_pk_add_f32 v[50:51], v[50:51], v[250:251]
    v_pk_add_f32 v[52:53], v[52:53], v[252:253]
    v_pk_add_f32 v[54:55], v[54:55], v[254:255]
    v_cvt_pk_bf16_f32 v136, v40, v41
    v_cvt_pk_bf16_f32 v137, v42, v43
    v_cvt_pk_bf16_f32 v138, v44, v45
    v_cvt_pk_bf16_f32 v139, v46, v47
    v_cvt_pk_bf16_f32 v140, v48, v49
    v_cvt_pk_bf16_f32 v141, v50, v51
    v_cvt_pk_bf16_f32 v142, v52, v53
    v_cvt_pk_bf16_f32 v143, v54, v55
    v_permlane32_swap_b32 v136, v138
    v_permlane32_swap_b32 v137, v139
    v_permlane32_swap_b32 v140, v142
    v_permlane32_swap_b32 v141, v143
    v_permlane16_swap_b32 v136, v138
    v_permlane16_swap_b32 v137, v139
    v_permlane16_swap_b32 v140, v142
    v_permlane16_swap_b32 v141, v143
    buffer_store_dwordx4 v[136:139], v127, s[76:79], s96 offen
    s_cmp_eq_u32 s28, 7
    s_cbranch_scc1 L_FIN
    buffer_store_dwordx4 v[140:143], v127, s[76:79], s97 offen
L_FIN:
L_END:
    s_endpgm
L_INIT_SPIN:
    v_mov_b32 v130, s98
    s_mov_b32 s59, 0x40000
L_INIT:
    global_load_dword v36, v130, s[52:53] sc1
    s_waitcnt vmcnt(0)
    v_readfirstlane_b32 s29, v36
    s_nop 0
    s_cmp_ge_u32 s29, 32
    s_cbranch_scc1 L_INIT_DONE
    s_sleep 8
    s_sub_u32 s59, s59, 1
    s_cmp_lg_u32 s59, 0
    s_cbranch_scc1 L_INIT
L_INIT_DONE:
    s_branch L_INIT_OK
L_F1_0_SPIN:
    s_mov_b32 s59, 0x40000
L_F1_0:
    v_mov_b32 v130, 1
    s_mov_b64 exec, 7
    v_mov_b32 v130, 0
    buffer_atomic_or v130, v125, s[80:83], 0 offen offset:0 sc0
    s_mov_b64 exec, -1
    s_waitcnt vmcnt(0)
    v_cmp_eq_u32 vcc, 1, v130
    s_nop 0
    s_cmp_eq_u64 vcc, exec
    s_cbranch_scc1 L_F1_0_DONE
    s_sleep 8
    s_sub_u32 s59, s59, 1
    s_cmp_lg_u32 s59, 0
    s_cbranch_scc1 L_F1_0
L_F1_0_DONE:
    s_branch L_F1_0_OK
L_F1_1_SPIN:
    s_mov_b32 s59, 0x40000
L_F1_1:
    v_mov_b32 v131, 1
    s_mov_b64 exec, 7
    v_mov_b32 v131, 0
    buffer_atomic_or v131, v125, s[80:83], 0 offen offset:4 sc0
    s_mov_b64 exec, -1
    s_waitcnt vmcnt(0)
    v_cmp_eq_u32 vcc, 1, v131
    s_nop 0
    s_cmp_eq_u64 vcc, exec
    s_cbranch_scc1 L_F1_1_DONE
    s_sleep 8
    s_sub_u32 s59, s59, 1
    s_cmp_lg_u32 s59, 0
    s_cbranch_scc1 L_F1_1
L_F1_1_DONE:
    s_branch L_F1_1_OK
L_F1_2_SPIN:
    s_mov_b32 s59, 0x40000
L_F1_2:
    v_mov_b32 v132, 1
    s_mov_b64 exec, 7
    v_mov_b32 v132, 0
    buffer_atomic_or v132, v125, s[80:83], 0 offen offset:8 sc0
    s_mov_b64 exec, -1
    s_waitcnt vmcnt(0)
    v_cmp_eq_u32 vcc, 1, v132
    s_nop 0
    s_cmp_eq_u64 vcc, exec
    s_cbranch_scc1 L_F1_2_DONE
    s_sleep 8
    s_sub_u32 s59, s59, 1
    s_cmp_lg_u32 s59, 0
    s_cbranch_scc1 L_F1_2
L_F1_2_DONE:
    s_branch L_F1_2_OK
L_TOUCH_END:
L_FALLBACK:
    s_mov_b32 s35, 1
    s_mov_b32 s29, 0
    v_lshrrev_b32 v29, 1, v3
    v_xor_b32 v29, v2, v29
    v_lshlrev_b32 v29, 4, v29
    v_mul_u32_u24 v30, 0x180, v3
    v_add_u32 v8, v30, v29
    v_xor_b32 v9, 64, v8
    v_add_u32 v10, 36960, v8
    v_add_u32 v11, 36960, v9
L_FB_LOOP:
    s_waitcnt vmcnt(0) lgkmcnt(0)
    s_barrier
    s_add_u32 m0, s34, 0
    s_add_u32 s39, s34, s29
    buffer_load_dwordx4 v20, s[12:15], s39 offen offset:0 lds
    buffer_load_dwordx4 v21, s[12:15], s39 offen offset:1024 lds
    buffer_load_dwordx4 v22, s[12:15], s39 offen offset:2048 lds
    s_waitcnt vmcnt(0)
    s_barrier
    ds_read_b128 a[72:75], v8 offset:0
    ds_read_b128 a[76:79], v9 offset:0
    ds_read_b128 a[80:83], v8 offset:128
    ds_read_b128 a[84:87], v9 offset:128
    ds_read_b128 a[88:91], v8 offset:256
    ds_read_b128 a[92:95], v9 offset:256
    ds_read_b128 a[96:99], v8 offset:6144
    ds_read_b128 a[100:103], v9 offset:6144
    ds_read_b128 a[104:107], v8 offset:6272
    ds_read_b128 a[108:111], v9 offset:6272
    ds_read_b128 a[112:115], v8 offset:6400
    ds_read_b128 a[116:119], v9 offset:6400
    s_waitcnt lgkmcnt(11)
    v_mfma_f32_16x16x32_bf16 v[64:67], a[72:75], a[0:3], 0
    v_mfma_f32_16x16x32_bf16 v[68:71], a[72:75], a[4:7], 0
    v_mfma_f32_16x16x32_bf16 v[72:75], a[72:75], a[8:11], 0
    s_waitcnt lgkmcnt(10)
    v_mfma_f32_16x16x32_bf16 v[64:67], a[76:79], a[12:15], v[64:67]
    v_mfma_f32_16x16x32_bf16 v[68:71], a[76:79], a[16:19], v[68:71]
    v_mfma_f32_16x16x32_bf16 v[72:75], a[76:79], a[20:23], v[72:75]
    s_waitcnt lgkmcnt(9)
    v_mfma_f32_16x16x32_bf16 v[64:67], a[80:83], a[24:27], v[64:67]
    v_mfma_f32_16x16x32_bf16 v[68:71], a[80:83], a[28:31], v[68:71]
    v_mfma_f32_16x16x32_bf16 v[72:75], a[80:83], a[32:35], v[72:75]
    s_waitcnt lgkmcnt(8)
    v_mfma_f32_16x16x32_bf16 v[64:67], a[84:87], a[36:39], v[64:67]
    v_mfma_f32_16x16x32_bf16 v[68:71], a[84:87], a[40:43], v[68:71]
    v_mfma_f32_16x16x32_bf16 v[72:75], a[84:87], a[44:47], v[72:75]
    s_waitcnt lgkmcnt(7)
    v_mfma_f32_16x16x32_bf16 v[64:67], a[88:91], a[48:51], v[64:67]
    v_mfma_f32_16x16x32_bf16 v[68:71], a[88:91], a[52:55], v[68:71]
    v_mfma_f32_16x16x32_bf16 v[72:75], a[88:91], a[56:59], v[72:75]
    s_waitcnt lgkmcnt(6)
    v_mfma_f32_16x16x32_bf16 v[64:67], a[92:95], a[60:63], v[64:67]
    v_mfma_f32_16x16x32_bf16 v[68:71], a[92:95], a[64:67], v[68:71]
    v_mfma_f32_16x16x32_bf16 v[72:75], a[92:95], a[68:71], v[72:75]
    s_waitcnt lgkmcnt(5)
    v_mfma_f32_16x16x32_bf16 v[76:79], a[96:99], a[0:3], 0
    v_mfma_f32_16x16x32_bf16 v[80:83], a[96:99], a[4:7], 0
    v_mfma_f32_16x16x32_bf16 v[84:87], a[96:99], a[8:11], 0
    s_waitcnt lgkmcnt(4)
    v_mfma_f32_16x16x32_bf16 v[76:79], a[100:103], a[12:15], v[76:79]
    v_mfma_f32_16x16x32_bf16 v[80:83], a[100:103], a[16:19], v[80:83]
    v_mfma_f32_16x16x32_bf16 v[84:87], a[100:103], a[20:23], v[84:87]
    s_waitcnt lgkmcnt(3)
    v_mfma_f32_16x16x32_bf16 v[76:79], a[104:107], a[24:27], v[76:79]
    v_mfma_f32_16x16x32_bf16 v[80:83], a[104:107], a[28:31], v[80:83]
    v_mfma_f32_16x16x32_bf16 v[84:87], a[104:107], a[32:35], v[84:87]
    s_waitcnt lgkmcnt(2)
    v_mfma_f32_16x16x32_bf16 v[76:79], a[108:111], a[36:39], v[76:79]
    v_mfma_f32_16x16x32_bf16 v[80:83], a[108:111], a[40:43], v[80:83]
    v_mfma_f32_16x16x32_bf16 v[84:87], a[108:111], a[44:47], v[84:87]
    s_waitcnt lgkmcnt(1)
    v_mfma_f32_16x16x32_bf16 v[76:79], a[112:115], a[48:51], v[76:79]
    v_mfma_f32_16x16x32_bf16 v[80:83], a[112:115], a[52:55], v[80:83]
    v_mfma_f32_16x16x32_bf16 v[84:87], a[112:115], a[56:59], v[84:87]
    s_waitcnt lgkmcnt(0)
    v_mfma_f32_16x16x32_bf16 v[76:79], a[116:119], a[60:63], v[76:79]
    v_mfma_f32_16x16x32_bf16 v[80:83], a[116:119], a[64:67], v[80:83]
    v_mfma_f32_16x16x32_bf16 v[84:87], a[116:119], a[68:71], v[84:87]
    v_max3_f32 v26, v64, v65, v26
    v_max3_f32 v26, v66, v67, v26
    s_nop 3
    v_max3_f32 v26, v76, v77, v26
    v_max3_f32 v26, v78, v79, v26
    v_max3_f32 v27, v68, v69, v27
    v_max3_f32 v27, v70, v71, v27
    v_max3_f32 v27, v80, v81, v27
    v_max3_f32 v27, v82, v83, v27
    v_max3_f32 v28, v72, v73, v28
    v_max3_f32 v28, v74, v75, v28
    v_max3_f32 v28, v84, v85, v28
    v_max3_f32 v28, v86, v87, v28
    s_add_u32 s29, s29, 12288
    s_cmp_lt_u32 s29, 196608
    s_cbranch_scc1 L_FB_LOOP
    s_waitcnt vmcnt(0) lgkmcnt(0)
    s_barrier
    s_add_u32 s39, s34, 0
    s_add_u32 m0, s34, 0
    s_nop 0
    buffer_load_dwordx4 v20, s[12:15], s39 offen offset:0 nt lds
    buffer_load_dwordx4 v21, s[12:15], s39 offen offset:1024 nt lds
    buffer_load_dwordx4 v22, s[12:15], s39 offen offset:2048 nt lds
    s_add_u32 s39, s34, 0
    s_add_u32 m0, s34, 123200
    s_nop 0
    buffer_load_dwordx4 v23, s[16:19], s39 offen offset:0 nt lds
    buffer_load_dwordx4 v24, s[16:19], s39 offen offset:1024 nt lds
    buffer_load_dwordx4 v25, s[16:19], s39 offen offset:2048 nt lds
    s_add_u32 s39, s34, 12288
    s_add_u32 m0, s34, 12320
    s_nop 0
    buffer_load_dwordx4 v20, s[12:15], s39 offen offset:0 nt lds
    buffer_load_dwordx4 v21, s[12:15], s39 offen offset:1024 nt lds
    buffer_load_dwordx4 v22, s[12:15], s39 offen offset:2048 nt lds
    s_add_u32 s39, s34, 12288
    s_add_u32 m0, s34, 135520
    s_nop 0
    buffer_load_dwordx4 v23, s[16:19], s39 offen offset:0 nt lds
    buffer_load_dwordx4 v24, s[16:19], s39 offen offset:1024 nt lds
    buffer_load_dwordx4 v25, s[16:19], s39 offen offset:2048 nt lds
    s_add_u32 s39, s34, 24576
    s_add_u32 m0, s34, 24640
    s_nop 0
    buffer_load_dwordx4 v20, s[12:15], s39 offen offset:0 nt lds
    buffer_load_dwordx4 v21, s[12:15], s39 offen offset:1024 nt lds
    buffer_load_dwordx4 v22, s[12:15], s39 offen offset:2048 nt lds
    s_add_u32 s39, s34, 24576
    s_add_u32 m0, s34, 147840
    s_nop 0
    buffer_load_dwordx4 v23, s[16:19], s39 offen offset:0 nt lds
    buffer_load_dwordx4 v24, s[16:19], s39 offen offset:1024 nt lds
    buffer_load_dwordx4 v25, s[16:19], s39 offen offset:2048 nt lds
    s_add_u32 s39, s34, 36864
    s_add_u32 m0, s34, 36960
    s_nop 0
    buffer_load_dwordx4 v20, s[12:15], s39 offen offset:0 nt lds
    buffer_load_dwordx4 v21, s[12:15], s39 offen offset:1024 nt lds
    buffer_load_dwordx4 v22, s[12:15], s39 offen offset:2048 nt lds
    s_add_u32 s39, s34, 36864
    s_add_u32 m0, s34, 86240
    s_nop 0
    buffer_load_dwordx4 v23, s[16:19], s39 offen offset:0 nt lds
    buffer_load_dwordx4 v24, s[16:19], s39 offen offset:1024 nt lds
    buffer_load_dwordx4 v25, s[16:19], s39 offen offset:2048 nt lds
    s_add_u32 s39, s34, 49152
    s_add_u32 m0, s34, 49280
    s_nop 0
    buffer_load_dwordx4 v20, s[12:15], s39 offen offset:0 nt lds
    buffer_load_dwordx4 v21, s[12:15], s39 offen offset:1024 nt lds
    buffer_load_dwordx4 v22, s[12:15], s39 offen offset:2048 nt lds
    s_add_u32 s39, s34, 49152
    s_add_u32 m0, s34, 98560
    s_nop 0
    buffer_load_dwordx4 v23, s[16:19], s39 offen offset:0 nt lds
    buffer_load_dwordx4 v24, s[16:19], s39 offen offset:1024 nt lds
    buffer_load_dwordx4 v25, s[16:19], s39 offen offset:2048 nt lds
    s_add_u32 s39, s34, 61440
    s_add_u32 m0, s34, 61600
    s_nop 0
    buffer_load_dwordx4 v20, s[12:15], s39 offen offset:0 nt lds
    buffer_load_dwordx4 v21, s[12:15], s39 offen offset:1024 nt lds
    buffer_load_dwordx4 v22, s[12:15], s39 offen offset:2048 nt lds
    s_add_u32 s39, s34, 61440
    s_add_u32 m0, s34, 110880
    s_nop 0
    buffer_load_dwordx4 v23, s[16:19], s39 offen offset:0 nt lds
    buffer_load_dwordx4 v24, s[16:19], s39 offen offset:1024 nt lds
    buffer_load_dwordx4 v25, s[16:19], s39 offen offset:2048 nt lds
    s_waitcnt vmcnt(0)
    s_nop 15
    s_branch L_P2
L_RELOAD:
    s_add_u32 s38, s34, 73728
    buffer_load_dwordx4 a[240:243], v20, s[12:15], s38 offen offset:0 nt
    s_add_u32 s38, s34, 73728
    buffer_load_dwordx4 a[244:247], v21, s[12:15], s38 offen offset:1024 nt
    s_add_u32 s38, s34, 73728
    buffer_load_dwordx4 a[248:251], v22, s[12:15], s38 offen offset:2048 nt
    s_add_u32 s38, s34, 86016
    buffer_load_dwordx4 a[168:171], v20, s[12:15], s38 offen offset:0 nt
    s_add_u32 s38, s34, 86016
    buffer_load_dwordx4 a[172:175], v21, s[12:15], s38 offen offset:1024 nt
    s_add_u32 s38, s34, 86016
    buffer_load_dwordx4 a[176:179], v22, s[12:15], s38 offen offset:2048 nt
    s_add_u32 s38, s34, 73728
    buffer_load_dwordx4 a[180:183], v23, s[16:19], s38 offen offset:0 nt
    s_add_u32 s38, s34, 73728
    buffer_load_dwordx4 a[184:187], v24, s[16:19], s38 offen offset:1024 nt
    s_add_u32 s38, s34, 73728
    buffer_load_dwordx4 a[188:191], v25, s[16:19], s38 offen offset:2048 nt
    s_add_u32 s38, s34, 98304
    buffer_load_dwordx4 a[192:195], v20, s[12:15], s38 offen offset:0 nt
    s_add_u32 s38, s34, 98304
    buffer_load_dwordx4 a[196:199], v21, s[12:15], s38 offen offset:1024 nt
    s_add_u32 s38, s34, 98304
    buffer_load_dwordx4 a[200:203], v22, s[12:15], s38 offen offset:2048 nt
    s_add_u32 s38, s34, 86016
    buffer_load_dwordx4 a[204:207], v23, s[16:19], s38 offen offset:0 nt
    s_add_u32 s38, s34, 86016
    buffer_load_dwordx4 a[208:211], v24, s[16:19], s38 offen offset:1024 nt
    s_add_u32 s38, s34, 86016
    buffer_load_dwordx4 a[212:215], v25, s[16:19], s38 offen offset:2048 nt
    s_waitcnt vmcnt(0)
    s_branch L_RELOADED
.section .rodata,"a"
.p2align 6
.amdhsa_kernel standalone__gqa_block_cached__near_ridge_kernel
  .amdhsa_next_free_vgpr 512
  .amdhsa_next_free_sgpr 102
  .amdhsa_accum_offset 256
  .amdhsa_group_segment_fixed_size 0
  .amdhsa_kernarg_size 64
  .amdhsa_user_sgpr_count 2
  .amdhsa_user_sgpr_kernarg_segment_ptr 1
  .amdhsa_system_sgpr_workgroup_id_x 1
  .amdhsa_float_denorm_mode_32 3
.end_amdhsa_kernel
```
